```python
import torch

def _softmax(x, axis=-1):
    return torch.softmax(x, dim=axis)
def _gelu(x):
    return torch.nn.functional.gelu(x, approximate="tanh")
def _silu(x):
    return torch.nn.functional.silu(x)
def _sigmoid(x):
    return torch.sigmoid(x)
def _layernorm(x, axis=-1, eps=1e-5):
    m = x.mean(dim=axis, keepdim=True)
    v = x.var(dim=axis, keepdim=True, unbiased=False)
    return (x - m) / torch.sqrt(v + eps)
def _scatter_add(tgt, idx, src, axis=0):
    return tgt.clone().index_add_(axis, idx, src)
def _segment_sum(src, seg, n):
    out = torch.zeros((n,) + src.shape[1:], dtype=src.dtype)
    return out.index_add_(0, seg, src)
def _pad(x, pw):
    flat = tuple(v for pair in reversed(pw) for v in pair)
    return torch.nn.functional.pad(x, flat)

kernel_name = 'sequential_preLN__compressed_kv_cla__glu_gated_reglu__prompt'

def setup_inputs():

    _w = (lambda a: (lambda t: t.to(torch.bfloat16) if t.is_floating_point() else t)(torch.as_tensor(a)))
    def _A_setup():
        B, H, Sq, Sk, D, M = 1, 32, 2048, 2048, 128, 512
        Dc = 4 * D
        return {
            "x": _w((lambda *s: torch.randn(*s, dtype=torch.bfloat16) * 0.05)(B, Sq, M)),
            "c_kv": _w((lambda *s: torch.randn(*s, dtype=torch.bfloat16) * 0.4)(B, Sk, Dc)),
            "w_q": _w((lambda *s: torch.randn(*s, dtype=torch.bfloat16) * 1.6)(M, H, D) * (M ** -0.5)),
            "w_uk": _w((lambda *s: torch.randn(*s, dtype=torch.bfloat16) * 1.6)(Dc, H, D) * (Dc ** -0.5)),
            "w_uv": _w((lambda *s: torch.randn(*s, dtype=torch.bfloat16) * 0.4)(Dc, H, D) * (Dc ** -0.5)),
            "w_o": _w((lambda *s: torch.randn(*s, dtype=torch.bfloat16) * 0.4)(H, D, M) * ((H * D) ** -0.5)),
        }
    _A_in = _A_setup()

    def _B_setup():
        B, S, D, F = 1, 2048, 512, 1376
        return {
            "x": _w((lambda *s: torch.randn(*s, dtype=torch.bfloat16) * 0.05)(B, S, D)),
            "W_gate": _w((lambda *s: torch.randn(*s, dtype=torch.bfloat16) * 0.2)(D, F) * (2.0 / D) ** 0.5),
            "W_up": _w((lambda *s: torch.randn(*s, dtype=torch.bfloat16) * 0.2)(D, F) * (2.0 / D) ** 0.5),
            "W_down": _w((lambda *s: torch.randn(*s, dtype=torch.bfloat16) * 0.2)(F, D) * (1.0 / F) ** 0.5),
        }
    _B_in = _B_setup()

    return {
        "A_x": _A_in["x"],
        "A_c_kv": _A_in["c_kv"],
        "A_w_q": _A_in["w_q"],
        "A_w_uk": _A_in["w_uk"],
        "A_w_uv": _A_in["w_uv"],
        "A_w_o": _A_in["w_o"],
        "B_x": _B_in["x"],
        "B_W_gate": _B_in["W_gate"],
        "B_W_up": _B_in["W_up"],
        "B_W_down": _B_in["W_down"],
    }

def reference(A_x, A_c_kv, A_w_q, A_w_uk, A_w_uv, A_w_o, B_x, B_W_gate, B_W_up, B_W_down):
    def _A_ref(x, c_kv, w_q, w_uk, w_uv, w_o):
        B, Sq, M = x.shape[0], x.shape[1], x.shape[2]
        Sk = c_kv.shape[1]
        H, D = w_q.shape[1], w_q.shape[2]
        q = torch.einsum("bqm,mhd->bhqd", x, w_q)
        k = torch.einsum("bkc,chd->bhkd", c_kv, w_uk)
        v = torch.einsum("bkc,chd->bhkd", c_kv, w_uv)
        scores = torch.einsum("bhqd,bhkd->bhqk", q, k) * (D ** -0.5)
        off = Sk - Sq
        qi = torch.arange(Sq)[:, None]
        kj = torch.arange(Sk)[None, :]
        cmask = kj <= (qi + off)
        scores = torch.where(cmask[None, None], scores, -1e9)
        p = _softmax(scores, axis=-1)
        ctx = torch.einsum("bhqk,bhkd->bhqd", p, v)
        return torch.einsum("bhqd,hdm->bqm", ctx, w_o)

    def _B_ref(x, W_gate, W_up, W_down):
        gate = torch.einsum("bsd,df->bsf", x, W_gate)
        up = torch.einsum("bsd,df->bsf", x, W_up)
        gate = gate * (lambda x, dt: x.to(dt))(gate > 0, gate.dtype)
        h = gate * up
        return torch.einsum("bsf,fd->bsd", h, W_down)

    x = A_x
    h = x + _A_ref(_layernorm(x, axis=-1), A_c_kv, A_w_q, A_w_uk, A_w_uv, A_w_o)
    h2 = h + _B_ref(_layernorm(h, axis=-1), B_W_gate, B_W_up, B_W_down)
    return h2
```

```asm
; @launch kernel=front_kernel grid=(256,1,1) block=(512,1,1) lds=163840
; @launch kernel=tail_kernel grid=(256,1,1) block=(256,1,1) lds=163840
.amdgcn_target "amdgcn-amd-amdhsa--gfx950"
.text
.globl front_kernel
.p2align 8
.type front_kernel,@function
front_kernel:
s_cmp_ge_u32 s2, 256
s_cbranch_scc1 L_k2_end
s_load_dwordx4 s[52:55], s[0:1], 0
s_load_dwordx4 s[56:59], s[0:1], 24
s_load_dwordx2 s[60:61], s[0:1], 16
s_load_dwordx2 s[30:31], s[0:1], 96
s_load_dwordx2 s[62:63], s[0:1], 88
s_load_dwordx2 s[84:85], s[0:1], 40
s_load_dwordx4 s[88:91], s[0:1], 56
s_load_dwordx2 s[86:87], s[0:1], 72
v_and_b32 v14, 63, v0
v_lshrrev_b32 v15, 6, v0
v_lshlrev_b32 v1, 4, v14
v_readfirstlane_b32 s12, v15
s_and_b32 s21, s2, 7
s_lshr_b32 s22, s2, 3
s_lshl_b32 s14, s21, 2
s_and_b32 s21, s22, 3
s_add_u32 s14, s14, s21
s_lshr_b32 s15, s22, 2
s_lshl_b32 s48, s14, 8
s_lshl_b32 s49, s12, 11
s_lshl_b32 s21, s15, 3
s_add_u32 s21, s21, s12
s_lshl_b32 s50, s21, 15
s_lshl_b32 s27, s21, 14
s_lshl_b32 s51, s12, 14
s_add_u32 s51, s51, 32768
v_lshrrev_b32 v10, 3, v14
v_and_b32 v11, 7, v14
v_bfe_u32 v12, v14, 4, 1
v_lshlrev_b32 v12, 2, v12
v_xor_b32 v11, v11, v12
v_lshlrev_b32 v11, 4, v11
v_lshl_add_u32 v11, v10, 13, v11
s_lshl_b32 s21, s12, 17
v_add_u32 v4, s21, v11
v_add_u32 v5, 0xfc00, v4
v_lshrrev_b32 v10, 4, v14
v_and_b32 v11, 15, v14
v_add_u32 v12, 0, v10
v_xor_b32 v12, v12, v11
v_lshlrev_b32 v12, 4, v12
v_lshl_add_u32 v12, v10, 10, v12
v_add_u32 v6, 0, v12
v_add_u32 v12, 4, v10
v_xor_b32 v12, v12, v11
v_lshlrev_b32 v12, 4, v12
v_lshl_add_u32 v12, v10, 10, v12
v_add_u32 v7, 3072, v12
v_add_u32 v12, 8, v10
v_xor_b32 v12, v12, v11
v_lshlrev_b32 v12, 4, v12
v_lshl_add_u32 v12, v10, 10, v12
v_add_u32 v8, 6144, v12
v_add_u32 v12, 12, v10
v_xor_b32 v12, v12, v11
v_lshlrev_b32 v12, 4, v12
v_lshl_add_u32 v12, v10, 10, v12
v_add_u32 v9, 9216, v12
s_waitcnt lgkmcnt(0)
s_mov_b32 s32, s54
s_mov_b32 s33, s55
s_mov_b32 s34, 0x200000
s_mov_b32 s35, 0x00020000
s_mov_b32 s36, s56
s_mov_b32 s37, s57
s_mov_b32 s38, 0x400000
s_mov_b32 s39, 0x00020000
s_add_u32 s21, s48, 0x0
s_add_u32 m0, s49, 0x0
s_nop 0
buffer_load_dwordx4 v4, s[36:39], s21 offen lds
buffer_load_dwordx4 v5, s[36:39], s21 offen offset:1024 lds
s_add_u32 s22, s50, 0x0
s_add_u32 m0, s51, 0x0
s_nop 0
buffer_load_dwordx4 v6, s[32:35], s22 offen lds
buffer_load_dwordx4 v7, s[32:35], s22 offen offset:1024 lds
buffer_load_dwordx4 v8, s[32:35], s22 offen offset:2048 lds
buffer_load_dwordx4 v9, s[32:35], s22 offen offset:3072 lds
s_add_u32 s22, s50, 0x4000
s_add_u32 m0, s51, 0x1000
s_nop 0
buffer_load_dwordx4 v6, s[32:35], s22 offen lds
buffer_load_dwordx4 v7, s[32:35], s22 offen offset:1024 lds
buffer_load_dwordx4 v8, s[32:35], s22 offen offset:2048 lds
buffer_load_dwordx4 v9, s[32:35], s22 offen offset:3072 lds
s_mov_b32 s40, s58
s_mov_b32 s41, s59
s_mov_b32 s42, 0x400000
s_mov_b32 s43, 0x00020000
s_mov_b32 s44, s52
s_mov_b32 s45, s53
s_mov_b32 s46, 0x200000
s_mov_b32 s47, 0x00020000
s_mov_b32 s8, s60
s_mov_b32 s9, s61
s_mov_b32 s10, 0x400000
s_mov_b32 s11, 0x00020000
s_mov_b32 s4, s30
s_mov_b32 s5, s31
s_mov_b32 s6, 0x10000000
s_mov_b32 s7, 0x00020000
s_mul_i32 s20, s14, 0x100000
s_add_u32 s20, s20, 0x200000
s_add_u32 s52, s20, s27
s_or_b32 s54, s12, s2
s_cmp_lg_u32 s54, 0
s_cbranch_scc1 L_f_nononce
s_memrealtime s[54:55]
s_waitcnt lgkmcnt(0)
s_or_b32 s54, s54, 1
v_mov_b32 v119, 0
v_mov_b32 v116, s54
global_store_dword v119, v116, s[62:63] sc1
v_lshlrev_b32 v10, 2, v1
v_mov_b32 v24, 0
v_mov_b32 v25, 0
v_mov_b32 v26, 0
v_mov_b32 v27, 0
s_mov_b32 s55, 0x3f00000
buffer_store_dwordx4 v[24:27], v10, s[4:7], s55 offen offset:0 sc1
buffer_store_dwordx4 v[24:27], v10, s[4:7], s55 offen offset:16 sc1
buffer_store_dwordx4 v[24:27], v10, s[4:7], s55 offen offset:32 sc1
buffer_store_dwordx4 v[24:27], v10, s[4:7], s55 offen offset:48 sc1
L_f_nononce:
s_and_b32 s13, s12, 3
s_lshr_b32 s25, s12, 2
s_sub_u32 s21, 15, s15
s_cmp_eq_u32 s25, 0
s_cselect_b32 s22, s21, s15
s_lshl_b32 s16, s22, 2
s_add_u32 s16, s16, s13
s_add_u32 s18, s21, 1
s_lshl_b32 s18, s18, 1
s_lshl_b32 s29, s16, 15
s_add_u32 s29, s29, 0x0
s_lshl_b32 s21, s25, 14
s_add_u32 s27, s20, s21
s_lshl_b32 s21, s13, 11
s_add_u32 s27, s27, s21
s_lshr_b32 s21, s13, 1
s_lshl_b32 s21, s21, 14
s_add_u32 s20, s20, s21
s_and_b32 s21, s13, 1
s_lshl_b32 s21, s21, 12
s_add_u32 s20, s20, s21
s_sub_u32 s21, s18, 1
s_lshl_b32 s21, s21, 15
s_add_u32 s30, s20, s21
s_add_u32 s31, s30, 8192
s_add_u32 s23, s20, 40960
s_add_u32 s20, s20, 65536
s_lshl_b32 s24, s13, 12
s_add_u32 s24, s24, 65536
s_lshl_b32 s28, s16, 5
s_add_u32 s28, s28, s14
s_lshl_b32 s28, s28, 13
s_add_u32 s28, s28, 0x2600000
v_and_b32 v11, 15, v14
v_lshrrev_b32 v13, 5, v14
v_lshrrev_b32 v12, 2, v11
v_lshl_add_u32 v12, v13, 3, v12
v_lshlrev_b32 v12, 7, v12
v_bfe_u32 v15, v14, 4, 1
v_lshlrev_b32 v15, 1, v15
v_bfe_u32 v10, v11, 1, 1
v_add_u32 v15, v15, v10
v_lshrrev_b32 v10, 3, v11
v_lshlrev_b32 v10, 2, v10
v_xor_b32 v15, v15, v10
v_lshl_add_u32 v12, v15, 4, v12
v_and_b32 v10, 1, v11
v_lshl_add_u32 v2, v10, 3, v12
v_xor_b32 v3, 64, v2
v_and_b32 v12, 31, v14
v_and_b32 v15, 15, v12
v_xor_b32 v15, v15, v13
v_lshlrev_b32 v15, 4, v15
v_lshl_add_u32 v15, v12, 8, v15
v_xor_b32 v10, 0, v15
v_add_u32 v16, s51, v10
v_xor_b32 v10, 32, v15
v_add_u32 v17, s51, v10
v_xor_b32 v10, 64, v15
v_add_u32 v18, s51, v10
v_xor_b32 v10, 96, v15
v_add_u32 v19, s51, v10
v_xor_b32 v10, 128, v15
v_add_u32 v20, s51, v10
v_xor_b32 v10, 160, v15
v_add_u32 v21, s51, v10
v_xor_b32 v10, 192, v15
v_add_u32 v22, s51, v10
v_xor_b32 v10, 224, v15
v_add_u32 v23, s51, v10
v_lshrrev_b32 v12, 2, v11
v_lshl_add_u32 v15, v13, 3, v12
v_lshlrev_b32 v15, 8, v15
v_bfe_u32 v10, v14, 4, 1
v_lshlrev_b32 v10, 1, v10
v_bfe_u32 v13, v11, 1, 1
v_add_u32 v10, v10, v13
v_lshlrev_b32 v12, 2, v12
v_xor_b32 v10, v10, v12
v_lshl_add_u32 v15, v10, 4, v15
v_and_b32 v13, 1, v11
v_lshl_add_u32 v10, v13, 3, v15
s_add_u32 s21, s48, 0x100000
s_add_u32 m0, s49, 0x4000
s_nop 0
buffer_load_dwordx4 v4, s[36:39], s21 offen lds
buffer_load_dwordx4 v5, s[36:39], s21 offen offset:1024 lds
s_add_u32 s22, s50, 0x100
s_add_u32 m0, s51, 0x2000
s_nop 0
buffer_load_dwordx4 v6, s[32:35], s22 offen lds
buffer_load_dwordx4 v7, s[32:35], s22 offen offset:1024 lds
buffer_load_dwordx4 v8, s[32:35], s22 offen offset:2048 lds
buffer_load_dwordx4 v9, s[32:35], s22 offen offset:3072 lds
s_add_u32 s22, s50, 0x4100
s_add_u32 m0, s51, 0x3000
s_nop 0
buffer_load_dwordx4 v6, s[32:35], s22 offen lds
buffer_load_dwordx4 v7, s[32:35], s22 offen offset:1024 lds
buffer_load_dwordx4 v8, s[32:35], s22 offen offset:2048 lds
buffer_load_dwordx4 v9, s[32:35], s22 offen offset:3072 lds
s_getpc_b64 s[54:55]
L_f_pc:
s_sub_u32 s54, s54, L_f_pc-front_kernel
s_subb_u32 s55, s55, 0
s_lshr_b32 s22, s2, 3
s_cmp_lt_u32 s22, (L_text_end-front_kernel)/8192
s_cbranch_scc0 L_f_nocode
s_cmp_eq_u32 s12, 1
s_cbranch_scc0 L_f_nocode
s_lshl_b32 s21, s22, 13
v_lshlrev_b32 v15, 7, v14
v_add_u32 v15, s21, v15
global_load_dword v120, v15, s[54:55]
L_f_nocode:
s_waitcnt vmcnt(10)
s_barrier
ds_read_b128 v[128:131], v16 offset:0
ds_read_b128 v[132:135], v17 offset:0
ds_read_b128 v[136:139], v18 offset:0
ds_read_b128 v[140:143], v19 offset:0
ds_read_b128 v[144:147], v20 offset:0
ds_read_b128 v[148:151], v21 offset:0
ds_read_b128 v[152:155], v22 offset:0
ds_read_b128 v[156:159], v23 offset:0
ds_read_b64_tr_b16 v[32:33], v2 offset:0
ds_read_b64_tr_b16 v[34:35], v2 offset:512
ds_read_b64_tr_b16 v[36:37], v3 offset:0
ds_read_b64_tr_b16 v[38:39], v3 offset:512
ds_read_b64_tr_b16 v[40:41], v2 offset:2048
ds_read_b64_tr_b16 v[42:43], v2 offset:2560
ds_read_b64_tr_b16 v[44:45], v3 offset:2048
ds_read_b64_tr_b16 v[46:47], v3 offset:2560
ds_read_b64_tr_b16 v[48:49], v2 offset:4096
ds_read_b64_tr_b16 v[50:51], v2 offset:4608
ds_read_b64_tr_b16 v[52:53], v3 offset:4096
ds_read_b64_tr_b16 v[54:55], v3 offset:4608
s_waitcnt lgkmcnt(8)
v_mfma_f32_32x32x16_bf16 v[64:79], v[32:35], v[128:131], 0
ds_read_b64_tr_b16 v[56:57], v2 offset:6144
ds_read_b64_tr_b16 v[58:59], v2 offset:6656
s_add_u32 s22, s50, 0x200
s_add_u32 m0, s51, 0x0
s_nop 0
buffer_load_dwordx4 v6, s[32:35], s22 offen lds
s_add_u32 s22, s50, 0x200
s_add_u32 m0, s51, 0x0
s_nop 0
buffer_load_dwordx4 v7, s[32:35], s22 offen offset:1024 lds
v_mfma_f32_32x32x16_bf16 v[80:95], v[36:39], v[128:131], 0
ds_read_b64_tr_b16 v[60:61], v3 offset:6144
ds_read_b64_tr_b16 v[62:63], v3 offset:6656
s_add_u32 s22, s50, 0x200
s_add_u32 m0, s51, 0x0
s_nop 0
buffer_load_dwordx4 v8, s[32:35], s22 offen offset:2048 lds
s_add_u32 s22, s50, 0x200
s_add_u32 m0, s51, 0x0
s_nop 0
buffer_load_dwordx4 v9, s[32:35], s22 offen offset:3072 lds
s_waitcnt lgkmcnt(8)
v_mfma_f32_32x32x16_bf16 v[64:79], v[40:43], v[132:135], v[64:79]
ds_read_b64_tr_b16 v[32:33], v2 offset:8192
ds_read_b64_tr_b16 v[34:35], v2 offset:8704
s_add_u32 s22, s50, 0x4200
s_add_u32 m0, s51, 0x1000
s_nop 0
buffer_load_dwordx4 v6, s[32:35], s22 offen lds
s_add_u32 s22, s50, 0x4200
s_add_u32 m0, s51, 0x1000
s_nop 0
buffer_load_dwordx4 v7, s[32:35], s22 offen offset:1024 lds
v_mfma_f32_32x32x16_bf16 v[80:95], v[44:47], v[132:135], v[80:95]
ds_read_b64_tr_b16 v[36:37], v3 offset:8192
ds_read_b64_tr_b16 v[38:39], v3 offset:8704
s_add_u32 s22, s50, 0x4200
s_add_u32 m0, s51, 0x1000
s_nop 0
buffer_load_dwordx4 v8, s[32:35], s22 offen offset:2048 lds
s_add_u32 s22, s50, 0x4200
s_add_u32 m0, s51, 0x1000
s_nop 0
buffer_load_dwordx4 v9, s[32:35], s22 offen offset:3072 lds
s_waitcnt lgkmcnt(8)
v_mfma_f32_32x32x16_bf16 v[64:79], v[48:51], v[136:139], v[64:79]
ds_read_b64_tr_b16 v[40:41], v2 offset:10240
ds_read_b64_tr_b16 v[42:43], v2 offset:10752
s_lshl_b32 s54, s2, 3
s_add_u32 s54, s54, s12
s_lshl_b32 s54, s54, 10
buffer_load_dwordx4 v[96:99], v1, s[44:47], s54 offen
v_mfma_f32_32x32x16_bf16 v[80:95], v[52:55], v[136:139], v[80:95]
ds_read_b64_tr_b16 v[44:45], v3 offset:10240
ds_read_b64_tr_b16 v[46:47], v3 offset:10752
s_waitcnt lgkmcnt(8)
v_mfma_f32_32x32x16_bf16 v[64:79], v[56:59], v[140:143], v[64:79]
ds_read_b64_tr_b16 v[48:49], v2 offset:12288
ds_read_b64_tr_b16 v[50:51], v2 offset:12800
v_mfma_f32_32x32x16_bf16 v[80:95], v[60:63], v[140:143], v[80:95]
ds_read_b64_tr_b16 v[52:53], v3 offset:12288
ds_read_b64_tr_b16 v[54:55], v3 offset:12800
s_waitcnt lgkmcnt(8)
v_mfma_f32_32x32x16_bf16 v[64:79], v[32:35], v[144:147], v[64:79]
ds_read_b64_tr_b16 v[56:57], v2 offset:14336
ds_read_b64_tr_b16 v[58:59], v2 offset:14848
v_mfma_f32_32x32x16_bf16 v[80:95], v[36:39], v[144:147], v[80:95]
ds_read_b64_tr_b16 v[60:61], v3 offset:14336
ds_read_b64_tr_b16 v[62:63], v3 offset:14848
s_waitcnt vmcnt(9)
s_waitcnt lgkmcnt(0)
s_barrier
v_add_u32 v2, 0x4000, v2
v_add_u32 v3, 0x4000, v3
s_waitcnt lgkmcnt(8)
v_mfma_f32_32x32x16_bf16 v[64:79], v[40:43], v[148:151], v[64:79]
ds_read_b64_tr_b16 v[32:33], v2 offset:0
ds_read_b64_tr_b16 v[34:35], v2 offset:512
ds_read_b128 v[160:163], v16 offset:8192
v_mfma_f32_32x32x16_bf16 v[80:95], v[44:47], v[148:151], v[80:95]
ds_read_b64_tr_b16 v[36:37], v3 offset:0
ds_read_b64_tr_b16 v[38:39], v3 offset:512
ds_read_b128 v[164:167], v17 offset:8192
s_waitcnt lgkmcnt(10)
v_mfma_f32_32x32x16_bf16 v[64:79], v[48:51], v[152:155], v[64:79]
ds_read_b64_tr_b16 v[40:41], v2 offset:2048
ds_read_b64_tr_b16 v[42:43], v2 offset:2560
ds_read_b128 v[168:171], v18 offset:8192
ds_read_b128 v[176:179], v20 offset:8192
s_add_u32 s21, s48, 0x200000
s_add_u32 m0, s49, 0x0
s_nop 0
buffer_load_dwordx4 v4, s[36:39], s21 offen lds
s_waitcnt vmcnt(1)
v_lshlrev_b32 v100, 16, v96
v_and_b32 v101, 0xffff0000, v96
v_mfma_f32_32x32x16_bf16 v[80:95], v[52:55], v[152:155], v[80:95]
ds_read_b64_tr_b16 v[44:45], v3 offset:2048
ds_read_b64_tr_b16 v[46:47], v3 offset:2560
ds_read_b128 v[172:175], v19 offset:8192
v_lshlrev_b32 v102, 16, v97
v_and_b32 v103, 0xffff0000, v97
v_lshlrev_b32 v104, 16, v98
s_waitcnt lgkmcnt(13)
v_mfma_f32_32x32x16_bf16 v[64:79], v[56:59], v[156:159], v[64:79]
ds_read_b64_tr_b16 v[48:49], v2 offset:4096
ds_read_b64_tr_b16 v[50:51], v2 offset:4608
ds_read_b128 v[180:183], v21 offset:8192
ds_read_b128 v[188:191], v23 offset:8192
s_add_u32 s21, s48, 0x200000
s_add_u32 m0, s49, 0x0
s_nop 0
buffer_load_dwordx4 v5, s[36:39], s21 offen offset:1024 lds
v_and_b32 v105, 0xffff0000, v98
v_lshlrev_b32 v106, 16, v99
v_and_b32 v107, 0xffff0000, v99
v_mfma_f32_32x32x16_bf16 v[80:95], v[60:63], v[156:159], v[80:95]
ds_read_b64_tr_b16 v[52:53], v3 offset:4096
ds_read_b64_tr_b16 v[54:55], v3 offset:4608
ds_read_b128 v[184:187], v22 offset:8192
v_add_f32 v108, v100, v101
v_add_f32 v108, v108, v102
v_add_f32 v108, v108, v103
s_waitcnt lgkmcnt(0)
v_mfma_f32_32x32x16_bf16 v[64:79], v[32:35], v[160:163], v[64:79]
ds_read_b64_tr_b16 v[56:57], v2 offset:6144
ds_read_b64_tr_b16 v[58:59], v2 offset:6656
s_add_u32 s22, s50, 0x300
s_add_u32 m0, s51, 0x2000
s_nop 0
buffer_load_dwordx4 v6, s[32:35], s22 offen lds
s_add_u32 s22, s50, 0x300
s_add_u32 m0, s51, 0x2000
s_nop 0
buffer_load_dwordx4 v7, s[32:35], s22 offen offset:1024 lds
v_add_f32 v108, v108, v104
v_add_f32 v108, v108, v105
v_add_f32 v108, v108, v106
v_mfma_f32_32x32x16_bf16 v[80:95], v[36:39], v[160:163], v[80:95]
ds_read_b64_tr_b16 v[60:61], v3 offset:6144
ds_read_b64_tr_b16 v[62:63], v3 offset:6656
s_add_u32 s22, s50, 0x300
s_add_u32 m0, s51, 0x2000
s_nop 0
buffer_load_dwordx4 v8, s[32:35], s22 offen offset:2048 lds
s_add_u32 s22, s50, 0x300
s_add_u32 m0, s51, 0x2000
s_nop 0
buffer_load_dwordx4 v9, s[32:35], s22 offen offset:3072 lds
v_add_f32 v108, v108, v107
s_nop 1
v_add_f32_dpp v108, v108, v108 row_ror:8 row_mask:0xf bank_mask:0xf
s_waitcnt lgkmcnt(12)
v_mfma_f32_32x32x16_bf16 v[64:79], v[40:43], v[164:167], v[64:79]
ds_read_b64_tr_b16 v[32:33], v2 offset:8192
ds_read_b64_tr_b16 v[34:35], v2 offset:8704
s_add_u32 s22, s50, 0x4300
s_add_u32 m0, s51, 0x3000
s_nop 0
buffer_load_dwordx4 v6, s[32:35], s22 offen lds
s_add_u32 s22, s50, 0x4300
s_add_u32 m0, s51, 0x3000
s_nop 0
buffer_load_dwordx4 v7, s[32:35], s22 offen offset:1024 lds
s_nop 1
v_add_f32_dpp v108, v108, v108 row_ror:4 row_mask:0xf bank_mask:0xf
s_nop 1
v_mfma_f32_32x32x16_bf16 v[80:95], v[44:47], v[164:167], v[80:95]
ds_read_b64_tr_b16 v[36:37], v3 offset:8192
ds_read_b64_tr_b16 v[38:39], v3 offset:8704
s_add_u32 s22, s50, 0x4300
s_add_u32 m0, s51, 0x3000
s_nop 0
buffer_load_dwordx4 v8, s[32:35], s22 offen offset:2048 lds
s_add_u32 s22, s50, 0x4300
s_add_u32 m0, s51, 0x3000
s_nop 0
buffer_load_dwordx4 v9, s[32:35], s22 offen offset:3072 lds
v_add_f32_dpp v108, v108, v108 row_ror:2 row_mask:0xf bank_mask:0xf
s_nop 1
v_add_f32_dpp v108, v108, v108 row_ror:1 row_mask:0xf bank_mask:0xf
s_waitcnt lgkmcnt(9)
v_mfma_f32_32x32x16_bf16 v[64:79], v[48:51], v[168:171], v[64:79]
ds_read_b64_tr_b16 v[40:41], v2 offset:10240
ds_read_b64_tr_b16 v[42:43], v2 offset:10752
s_add_u32 s54, s15, 5
s_cmp_gt_u32 s54, 15
s_cbranch_scc1 L_wt_5
s_cmp_gt_u32 s12, 1
s_cbranch_scc1 L_wt_5
s_and_b32 s55, s54, 3
s_lshl_b32 s55, s55, 1
s_add_u32 s55, s55, s12
s_lshl_b32 s55, s55, 19
s_add_u32 s55, s55, s48
s_bitcmp1_b32 s54, 2
s_cselect_b32 s53, 128, 0
s_add_u32 s55, s55, s53
v_lshlrev_b32 v12, 13, v14
s_cmp_lt_u32 s54, 8
s_cbranch_scc0 L_wt_5v
buffer_load_dword v11, v12, s[36:39], s55 offen
s_branch L_wt_5
L_wt_5v:
buffer_load_dword v11, v12, s[40:43], s55 offen
L_wt_5:
ds_swizzle_b32 v109, v108 offset:0x401F
s_waitcnt lgkmcnt(0)
v_add_f32 v108, v108, v109
v_mfma_f32_32x32x16_bf16 v[80:95], v[52:55], v[168:171], v[80:95]
ds_read_b64_tr_b16 v[44:45], v3 offset:10240
ds_read_b64_tr_b16 v[46:47], v3 offset:10752
v_mov_b32 v109, v108
s_nop 1
v_permlane32_swap_b32 v108, v109
s_waitcnt lgkmcnt(9)
v_mfma_f32_32x32x16_bf16 v[64:79], v[56:59], v[172:175], v[64:79]
ds_read_b64_tr_b16 v[48:49], v2 offset:12288
ds_read_b64_tr_b16 v[50:51], v2 offset:12800
s_nop 1
v_add_f32 v108, v108, v109
v_mul_f32 v108, 0x3b000000, v108
v_mfma_f32_32x32x16_bf16 v[80:95], v[60:63], v[172:175], v[80:95]
ds_read_b64_tr_b16 v[52:53], v3 offset:12288
ds_read_b64_tr_b16 v[54:55], v3 offset:12800
v_sub_f32 v110, v100, v108
v_mul_f32 v111, v110, v110
v_sub_f32 v110, v101, v108
s_waitcnt lgkmcnt(9)
v_mfma_f32_32x32x16_bf16 v[64:79], v[32:35], v[176:179], v[64:79]
ds_read_b64_tr_b16 v[56:57], v2 offset:14336
ds_read_b64_tr_b16 v[58:59], v2 offset:14848
v_fmac_f32 v111, v110, v110
v_sub_f32 v110, v102, v108
v_fmac_f32 v111, v110, v110
v_mfma_f32_32x32x16_bf16 v[80:95], v[36:39], v[176:179], v[80:95]
ds_read_b64_tr_b16 v[60:61], v3 offset:14336
ds_read_b64_tr_b16 v[62:63], v3 offset:14848
v_sub_f32 v110, v103, v108
v_fmac_f32 v111, v110, v110
v_sub_f32 v110, v104, v108
s_waitcnt vmcnt(8)
s_waitcnt lgkmcnt(0)
s_barrier
v_add_u32 v2, 0xffffc000, v2
v_add_u32 v3, 0xffffc000, v3
s_waitcnt lgkmcnt(8)
v_mfma_f32_32x32x16_bf16 v[64:79], v[40:43], v[180:183], v[64:79]
ds_read_b64_tr_b16 v[32:33], v2 offset:0
ds_read_b64_tr_b16 v[34:35], v2 offset:512
ds_read_b128 v[192:195], v16 offset:0
v_fmac_f32 v111, v110, v110
v_sub_f32 v110, v105, v108
v_fmac_f32 v111, v110, v110
v_mfma_f32_32x32x16_bf16 v[80:95], v[44:47], v[180:183], v[80:95]
ds_read_b64_tr_b16 v[36:37], v3 offset:0
ds_read_b64_tr_b16 v[38:39], v3 offset:512
ds_read_b128 v[196:199], v17 offset:0
v_sub_f32 v110, v106, v108
v_fmac_f32 v111, v110, v110
v_sub_f32 v110, v107, v108
s_waitcnt lgkmcnt(10)
v_mfma_f32_32x32x16_bf16 v[64:79], v[48:51], v[184:187], v[64:79]
ds_read_b64_tr_b16 v[40:41], v2 offset:2048
ds_read_b64_tr_b16 v[42:43], v2 offset:2560
ds_read_b128 v[200:203], v18 offset:0
ds_read_b128 v[208:211], v20 offset:0
s_add_u32 s21, s48, 0x300000
s_add_u32 m0, s49, 0x4000
s_nop 0
buffer_load_dwordx4 v4, s[36:39], s21 offen lds
v_fmac_f32 v111, v110, v110
s_nop 1
v_add_f32_dpp v111, v111, v111 row_ror:8 row_mask:0xf bank_mask:0xf
v_mfma_f32_32x32x16_bf16 v[80:95], v[52:55], v[184:187], v[80:95]
ds_read_b64_tr_b16 v[44:45], v3 offset:2048
ds_read_b64_tr_b16 v[46:47], v3 offset:2560
ds_read_b128 v[204:207], v19 offset:0
s_nop 1
v_add_f32_dpp v111, v111, v111 row_ror:4 row_mask:0xf bank_mask:0xf
s_nop 1
s_waitcnt lgkmcnt(13)
v_mfma_f32_32x32x16_bf16 v[64:79], v[56:59], v[188:191], v[64:79]
ds_read_b64_tr_b16 v[48:49], v2 offset:4096
ds_read_b64_tr_b16 v[50:51], v2 offset:4608
ds_read_b128 v[212:215], v21 offset:0
ds_read_b128 v[220:223], v23 offset:0
s_add_u32 s21, s48, 0x300000
s_add_u32 m0, s49, 0x4000
s_nop 0
buffer_load_dwordx4 v5, s[36:39], s21 offen offset:1024 lds
v_add_f32_dpp v111, v111, v111 row_ror:2 row_mask:0xf bank_mask:0xf
s_nop 1
v_add_f32_dpp v111, v111, v111 row_ror:1 row_mask:0xf bank_mask:0xf
v_mfma_f32_32x32x16_bf16 v[80:95], v[60:63], v[188:191], v[80:95]
ds_read_b64_tr_b16 v[52:53], v3 offset:4096
ds_read_b64_tr_b16 v[54:55], v3 offset:4608
ds_read_b128 v[216:219], v22 offset:0
ds_swizzle_b32 v109, v111 offset:0x401F
s_waitcnt lgkmcnt(0)
v_add_f32 v111, v111, v109
s_waitcnt lgkmcnt(1)
v_mfma_f32_32x32x16_bf16 v[64:79], v[32:35], v[192:195], v[64:79]
ds_read_b64_tr_b16 v[56:57], v2 offset:6144
ds_read_b64_tr_b16 v[58:59], v2 offset:6656
v_mov_b32 v109, v111
s_nop 1
v_permlane32_swap_b32 v111, v109
v_mfma_f32_32x32x16_bf16 v[80:95], v[36:39], v[192:195], v[80:95]
ds_read_b64_tr_b16 v[60:61], v3 offset:6144
ds_read_b64_tr_b16 v[62:63], v3 offset:6656
s_nop 1
v_add_f32 v111, v111, v109
v_mul_f32 v111, 0x3b000000, v111
s_waitcnt lgkmcnt(13)
v_mfma_f32_32x32x16_bf16 v[64:79], v[40:43], v[196:199], v[64:79]
ds_read_b64_tr_b16 v[32:33], v2 offset:8192
ds_read_b64_tr_b16 v[34:35], v2 offset:8704
v_cvt_pk_bf16_f32 v108, v108, v108
v_cvt_pk_bf16_f32 v111, v111, v111
v_lshlrev_b32 v108, 16, v108
v_mfma_f32_32x32x16_bf16 v[80:95], v[44:47], v[196:199], v[80:95]
ds_read_b64_tr_b16 v[36:37], v3 offset:8192
ds_read_b64_tr_b16 v[38:39], v3 offset:8704
v_lshlrev_b32 v111, 16, v111
v_add_f32 v111, 0x3727c5ac, v111
v_cvt_pk_bf16_f32 v111, v111, v111
s_waitcnt lgkmcnt(10)
v_mfma_f32_32x32x16_bf16 v[64:79], v[48:51], v[200:203], v[64:79]
ds_read_b64_tr_b16 v[40:41], v2 offset:10240
ds_read_b64_tr_b16 v[42:43], v2 offset:10752
v_lshlrev_b32 v111, 16, v111
v_sqrt_f32 v111, v111
s_nop 0
v_mfma_f32_32x32x16_bf16 v[80:95], v[52:55], v[200:203], v[80:95]
ds_read_b64_tr_b16 v[44:45], v3 offset:10240
ds_read_b64_tr_b16 v[46:47], v3 offset:10752
v_cvt_pk_bf16_f32 v111, v111, v111
v_lshlrev_b32 v111, 16, v111
v_rcp_f32 v111, v111
s_waitcnt lgkmcnt(8)
v_mfma_f32_32x32x16_bf16 v[64:79], v[56:59], v[204:207], v[64:79]
ds_read_b64_tr_b16 v[48:49], v2 offset:12288
ds_read_b64_tr_b16 v[50:51], v2 offset:12800
s_nop 0
v_mul_f32 v111, 0x3e0293ee, v111
v_sub_f32 v100, v100, v108
v_mfma_f32_32x32x16_bf16 v[80:95], v[60:63], v[204:207], v[80:95]
ds_read_b64_tr_b16 v[52:53], v3 offset:12288
ds_read_b64_tr_b16 v[54:55], v3 offset:12800
v_sub_f32 v101, v101, v108
v_sub_f32 v102, v102, v108
v_sub_f32 v103, v103, v108
s_waitcnt lgkmcnt(8)
v_mfma_f32_32x32x16_bf16 v[64:79], v[32:35], v[208:211], v[64:79]
ds_read_b64_tr_b16 v[56:57], v2 offset:14336
ds_read_b64_tr_b16 v[58:59], v2 offset:14848
v_sub_f32 v104, v104, v108
v_sub_f32 v105, v105, v108
v_sub_f32 v106, v106, v108
v_mfma_f32_32x32x16_bf16 v[80:95], v[36:39], v[208:211], v[80:95]
ds_read_b64_tr_b16 v[60:61], v3 offset:14336
ds_read_b64_tr_b16 v[62:63], v3 offset:14848
v_sub_f32 v107, v107, v108
v_cvt_pk_bf16_f32 v96, v100, v101
v_cvt_pk_bf16_f32 v97, v102, v103
s_waitcnt vmcnt(0)
s_waitcnt lgkmcnt(0)
s_barrier
v_add_u32 v2, 0x4000, v2
v_add_u32 v3, 0x4000, v3
s_waitcnt lgkmcnt(8)
v_mfma_f32_32x32x16_bf16 v[64:79], v[40:43], v[212:215], v[64:79]
ds_read_b64_tr_b16 v[32:33], v2 offset:0
ds_read_b64_tr_b16 v[34:35], v2 offset:512
ds_read_b128 v[224:227], v16 offset:8192
v_cvt_pk_bf16_f32 v98, v104, v105
v_cvt_pk_bf16_f32 v99, v106, v107
v_lshlrev_b32 v100, 16, v96
v_mfma_f32_32x32x16_bf16 v[80:95], v[44:47], v[212:215], v[80:95]
ds_read_b64_tr_b16 v[36:37], v3 offset:0
ds_read_b64_tr_b16 v[38:39], v3 offset:512
ds_read_b128 v[228:231], v17 offset:8192
v_and_b32 v101, 0xffff0000, v96
v_lshlrev_b32 v102, 16, v97
v_and_b32 v103, 0xffff0000, v97
s_waitcnt lgkmcnt(10)
v_mfma_f32_32x32x16_bf16 v[64:79], v[48:51], v[216:219], v[64:79]
ds_read_b64_tr_b16 v[40:41], v2 offset:2048
ds_read_b64_tr_b16 v[42:43], v2 offset:2560
ds_read_b128 v[232:235], v18 offset:8192
ds_read_b128 v[240:243], v20 offset:8192
s_add_u32 s21, s48, 0x80
s_add_u32 m0, s49, 0x0
s_nop 0
buffer_load_dwordx4 v4, s[36:39], s21 offen lds
v_lshlrev_b32 v104, 16, v98
v_and_b32 v105, 0xffff0000, v98
v_lshlrev_b32 v106, 16, v99
v_mfma_f32_32x32x16_bf16 v[80:95], v[52:55], v[216:219], v[80:95]
ds_read_b64_tr_b16 v[44:45], v3 offset:2048
ds_read_b64_tr_b16 v[46:47], v3 offset:2560
ds_read_b128 v[236:239], v19 offset:8192
v_and_b32 v107, 0xffff0000, v99
v_mul_f32 v100, v100, v111
v_mul_f32 v101, v101, v111
s_waitcnt lgkmcnt(13)
v_mfma_f32_32x32x16_bf16 v[64:79], v[56:59], v[220:223], v[64:79]
ds_read_b64_tr_b16 v[48:49], v2 offset:4096
ds_read_b64_tr_b16 v[50:51], v2 offset:4608
ds_read_b128 v[244:247], v21 offset:8192
ds_read_b128 v[252:255], v23 offset:8192
s_add_u32 s21, s48, 0x80
s_add_u32 m0, s49, 0x0
s_nop 0
buffer_load_dwordx4 v5, s[36:39], s21 offen offset:1024 lds
v_mul_f32 v102, v102, v111
v_mul_f32 v103, v103, v111
v_mul_f32 v104, v104, v111
v_mfma_f32_32x32x16_bf16 v[80:95], v[60:63], v[220:223], v[80:95]
ds_read_b64_tr_b16 v[52:53], v3 offset:4096
ds_read_b64_tr_b16 v[54:55], v3 offset:4608
ds_read_b128 v[248:251], v22 offset:8192
v_mul_f32 v105, v105, v111
v_mul_f32 v106, v106, v111
v_mul_f32 v107, v107, v111
s_waitcnt lgkmcnt(0)
v_mfma_f32_32x32x16_bf16 v[64:79], v[32:35], v[224:227], v[64:79]
ds_read_b64_tr_b16 v[56:57], v2 offset:6144
ds_read_b64_tr_b16 v[58:59], v2 offset:6656
s_add_u32 s54, s15, 13
s_cmp_gt_u32 s54, 15
s_cbranch_scc1 L_wt_13
s_cmp_gt_u32 s12, 1
s_cbranch_scc1 L_wt_13
s_and_b32 s55, s54, 3
s_lshl_b32 s55, s55, 1
s_add_u32 s55, s55, s12
s_lshl_b32 s55, s55, 19
s_add_u32 s55, s55, s48
s_bitcmp1_b32 s54, 2
s_cselect_b32 s53, 128, 0
s_add_u32 s55, s55, s53
v_lshlrev_b32 v12, 13, v14
s_cmp_lt_u32 s54, 8
s_cbranch_scc0 L_wt_13v
buffer_load_dword v11, v12, s[36:39], s55 offen
s_branch L_wt_13
L_wt_13v:
buffer_load_dword v11, v12, s[40:43], s55 offen
L_wt_13:
v_cvt_pk_bf16_f32 v96, v100, v101
v_cvt_pk_bf16_f32 v97, v102, v103
v_cvt_pk_bf16_f32 v98, v104, v105
v_mfma_f32_32x32x16_bf16 v[80:95], v[36:39], v[224:227], v[80:95]
ds_read_b64_tr_b16 v[60:61], v3 offset:6144
ds_read_b64_tr_b16 v[62:63], v3 offset:6656
v_cvt_pk_bf16_f32 v99, v106, v107
s_waitcnt lgkmcnt(12)
v_mfma_f32_32x32x16_bf16 v[64:79], v[40:43], v[228:231], v[64:79]
ds_read_b64_tr_b16 v[32:33], v2 offset:8192
ds_read_b64_tr_b16 v[34:35], v2 offset:8704
v_mfma_f32_32x32x16_bf16 v[80:95], v[44:47], v[228:231], v[80:95]
ds_read_b64_tr_b16 v[36:37], v3 offset:8192
ds_read_b64_tr_b16 v[38:39], v3 offset:8704
s_waitcnt lgkmcnt(9)
v_mfma_f32_32x32x16_bf16 v[64:79], v[48:51], v[232:235], v[64:79]
ds_read_b64_tr_b16 v[40:41], v2 offset:10240
ds_read_b64_tr_b16 v[42:43], v2 offset:10752
v_mfma_f32_32x32x16_bf16 v[80:95], v[52:55], v[232:235], v[80:95]
ds_read_b64_tr_b16 v[44:45], v3 offset:10240
ds_read_b64_tr_b16 v[46:47], v3 offset:10752
s_waitcnt lgkmcnt(8)
v_mfma_f32_32x32x16_bf16 v[64:79], v[56:59], v[236:239], v[64:79]
ds_read_b64_tr_b16 v[48:49], v2 offset:12288
ds_read_b64_tr_b16 v[50:51], v2 offset:12800
v_mfma_f32_32x32x16_bf16 v[80:95], v[60:63], v[236:239], v[80:95]
ds_read_b64_tr_b16 v[52:53], v3 offset:12288
ds_read_b64_tr_b16 v[54:55], v3 offset:12800
s_waitcnt lgkmcnt(8)
v_mfma_f32_32x32x16_bf16 v[64:79], v[32:35], v[240:243], v[64:79]
ds_read_b64_tr_b16 v[56:57], v2 offset:14336
ds_read_b64_tr_b16 v[58:59], v2 offset:14848
v_mfma_f32_32x32x16_bf16 v[80:95], v[36:39], v[240:243], v[80:95]
ds_read_b64_tr_b16 v[60:61], v3 offset:14336
ds_read_b64_tr_b16 v[62:63], v3 offset:14848
s_waitcnt vmcnt(0)
s_barrier
v_add_u32 v2, 0xffffc000, v2
v_add_u32 v3, 0xffffc000, v3
s_waitcnt lgkmcnt(8)
v_mfma_f32_32x32x16_bf16 v[64:79], v[40:43], v[244:247], v[64:79]
ds_read_b64_tr_b16 v[32:33], v2 offset:0
ds_read_b64_tr_b16 v[34:35], v2 offset:512
s_add_u32 s21, s48, 0x100080
s_add_u32 m0, s49, 0x8000
s_nop 0
buffer_load_dwordx4 v4, s[36:39], s21 offen lds
v_mfma_f32_32x32x16_bf16 v[80:95], v[44:47], v[244:247], v[80:95]
ds_read_b64_tr_b16 v[36:37], v3 offset:0
ds_read_b64_tr_b16 v[38:39], v3 offset:512
s_waitcnt lgkmcnt(8)
v_mfma_f32_32x32x16_bf16 v[64:79], v[48:51], v[248:251], v[64:79]
ds_read_b64_tr_b16 v[40:41], v2 offset:2048
ds_read_b64_tr_b16 v[42:43], v2 offset:2560
s_add_u32 s21, s48, 0x100080
s_add_u32 m0, s49, 0x8000
s_nop 0
buffer_load_dwordx4 v5, s[36:39], s21 offen offset:1024 lds
v_mfma_f32_32x32x16_bf16 v[80:95], v[52:55], v[248:251], v[80:95]
ds_read_b64_tr_b16 v[44:45], v3 offset:2048
ds_read_b64_tr_b16 v[46:47], v3 offset:2560
s_mul_i32 s54, s12, 1040
s_add_u32 s54, s54, 147456
v_add_u32 v109, s54, v1
ds_write_b128 v109, v[96:99]
s_waitcnt lgkmcnt(9)
v_mfma_f32_32x32x16_bf16 v[64:79], v[56:59], v[252:255], v[64:79]
ds_read_b64_tr_b16 v[48:49], v2 offset:4096
ds_read_b64_tr_b16 v[50:51], v2 offset:4608
v_mfma_f32_32x32x16_bf16 v[80:95], v[60:63], v[252:255], v[80:95]
ds_read_b64_tr_b16 v[52:53], v3 offset:4096
ds_read_b64_tr_b16 v[54:55], v3 offset:4608
s_waitcnt lgkmcnt(9)
v_mfma_f32_32x32x16_bf16 v[96:111], v[32:35], v[128:131], 0
ds_read_b64_tr_b16 v[56:57], v2 offset:6144
ds_read_b64_tr_b16 v[58:59], v2 offset:6656
v_mfma_f32_32x32x16_bf16 v[112:127], v[36:39], v[128:131], 0
ds_read_b64_tr_b16 v[60:61], v3 offset:6144
ds_read_b64_tr_b16 v[62:63], v3 offset:6656
s_waitcnt lgkmcnt(9)
v_mfma_f32_32x32x16_bf16 v[96:111], v[40:43], v[132:135], v[96:111]
ds_read_b64_tr_b16 v[32:33], v2 offset:8192
ds_read_b64_tr_b16 v[34:35], v2 offset:8704
s_add_u32 s21, s48, 0x200080
s_add_u32 m0, s49, 0xc000
s_nop 0
buffer_load_dwordx4 v4, s[36:39], s21 offen lds
v_mfma_f32_32x32x16_bf16 v[112:127], v[44:47], v[132:135], v[112:127]
ds_read_b64_tr_b16 v[36:37], v3 offset:8192
ds_read_b64_tr_b16 v[38:39], v3 offset:8704
v_cvt_pk_bf16_f32 v24, v64, v65
v_cvt_pk_bf16_f32 v25, v66, v67
v_cvt_pk_bf16_f32 v26, v68, v69
v_cvt_pk_bf16_f32 v27, v70, v71
s_waitcnt lgkmcnt(8)
v_mfma_f32_32x32x16_bf16 v[96:111], v[48:51], v[136:139], v[96:111]
ds_read_b64_tr_b16 v[40:41], v2 offset:10240
ds_read_b64_tr_b16 v[42:43], v2 offset:10752
s_add_u32 s21, s48, 0x200080
s_add_u32 m0, s49, 0xc000
s_nop 0
buffer_load_dwordx4 v5, s[36:39], s21 offen offset:1024 lds
s_cmp_lg_u32 s12, 0
s_cbranch_scc1 L_st_34_1_0
buffer_store_dwordx4 v[24:27], v1, s[4:7], s52 offen sc1
L_st_34_1_0:
v_mfma_f32_32x32x16_bf16 v[112:127], v[52:55], v[136:139], v[112:127]
ds_read_b64_tr_b16 v[44:45], v3 offset:10240
ds_read_b64_tr_b16 v[46:47], v3 offset:10752
s_waitcnt lgkmcnt(8)
v_mfma_f32_32x32x16_bf16 v[96:111], v[56:59], v[140:143], v[96:111]
ds_read_b64_tr_b16 v[48:49], v2 offset:12288
ds_read_b64_tr_b16 v[50:51], v2 offset:12800
s_cmp_lg_u32 s12, 1
s_cbranch_scc1 L_st_35_1_0
buffer_store_dwordx4 v[24:27], v1, s[4:7], s52 offen sc1
L_st_35_1_0:
v_mfma_f32_32x32x16_bf16 v[112:127], v[60:63], v[140:143], v[112:127]
ds_read_b64_tr_b16 v[52:53], v3 offset:12288
ds_read_b64_tr_b16 v[54:55], v3 offset:12800
s_waitcnt lgkmcnt(8)
v_mfma_f32_32x32x16_bf16 v[96:111], v[32:35], v[144:147], v[96:111]
ds_read_b64_tr_b16 v[56:57], v2 offset:14336
ds_read_b64_tr_b16 v[58:59], v2 offset:14848
s_cmp_lg_u32 s12, 2
s_cbranch_scc1 L_st_36_1_0
buffer_store_dwordx4 v[24:27], v1, s[4:7], s52 offen sc1
L_st_36_1_0:
v_mfma_f32_32x32x16_bf16 v[112:127], v[36:39], v[144:147], v[112:127]
ds_read_b64_tr_b16 v[60:61], v3 offset:14336
ds_read_b64_tr_b16 v[62:63], v3 offset:14848
s_waitcnt lgkmcnt(15)
s_waitcnt vmcnt(2)
s_barrier
v_add_u32 v2, 0x8000, v2
v_add_u32 v3, 0x8000, v3
s_waitcnt lgkmcnt(8)
v_mfma_f32_32x32x16_bf16 v[96:111], v[40:43], v[148:151], v[96:111]
ds_read_b64_tr_b16 v[32:33], v2 offset:0
ds_read_b64_tr_b16 v[34:35], v2 offset:512
s_add_u32 s21, s48, 0x300080
s_add_u32 m0, s49, 0x10000
s_nop 0
buffer_load_dwordx4 v4, s[36:39], s21 offen lds
s_cmp_lg_u32 s12, 3
s_cbranch_scc1 L_st_37_1_0
buffer_store_dwordx4 v[24:27], v1, s[4:7], s52 offen sc1
L_st_37_1_0:
v_mfma_f32_32x32x16_bf16 v[112:127], v[44:47], v[148:151], v[112:127]
ds_read_b64_tr_b16 v[36:37], v3 offset:0
ds_read_b64_tr_b16 v[38:39], v3 offset:512
s_waitcnt lgkmcnt(8)
v_mfma_f32_32x32x16_bf16 v[96:111], v[48:51], v[152:155], v[96:111]
ds_read_b64_tr_b16 v[40:41], v2 offset:2048
ds_read_b64_tr_b16 v[42:43], v2 offset:2560
s_add_u32 s21, s48, 0x300080
s_add_u32 m0, s49, 0x10000
s_nop 0
buffer_load_dwordx4 v5, s[36:39], s21 offen offset:1024 lds
s_cmp_lg_u32 s12, 4
s_cbranch_scc1 L_st_38_1_0
buffer_store_dwordx4 v[24:27], v1, s[4:7], s52 offen sc1
L_st_38_1_0:
v_mfma_f32_32x32x16_bf16 v[112:127], v[52:55], v[152:155], v[112:127]
ds_read_b64_tr_b16 v[44:45], v3 offset:2048
ds_read_b64_tr_b16 v[46:47], v3 offset:2560
v_and_b32 v20, 7, v14
v_lshrrev_b32 v21, 3, v14
v_mul_u32_u24 v22, 1040, v20
s_lshl_b32 s54, s12, 7
s_add_u32 s54, s54, 147456
v_lshl_add_u32 v22, v21, 4, v22
v_add_u32 v22, s54, v22
ds_read_b128 v[16:19], v22
v_lshrrev_b32 v22, 1, v21
v_lshlrev_b32 v22, 10, v22
v_and_b32 v21, 1, v21
v_lshlrev_b32 v21, 5, v21
v_add_u32 v21, v21, v20
v_lshl_add_u32 v22, v21, 4, v22
s_lshr_b32 s54, s2, 2
s_lshl_b32 s54, s54, 15
s_lshl_b32 s55, s12, 12
s_add_u32 s54, s54, s55
s_and_b32 s55, s2, 3
s_lshl_b32 s55, s55, 7
s_add_u32 s54, s54, s55
s_add_u32 s54, s54, 0x0
s_waitcnt lgkmcnt(0)
buffer_store_dwordx4 v[16:19], v22, s[4:7], s54 offen sc1
s_waitcnt lgkmcnt(9)
v_mfma_f32_32x32x16_bf16 v[96:111], v[56:59], v[156:159], v[96:111]
ds_read_b64_tr_b16 v[48:49], v2 offset:4096
ds_read_b64_tr_b16 v[50:51], v2 offset:4608
s_cmp_lg_u32 s12, 5
s_cbranch_scc1 L_st_39_1_0
buffer_store_dwordx4 v[24:27], v1, s[4:7], s52 offen sc1
L_st_39_1_0:
v_mfma_f32_32x32x16_bf16 v[112:127], v[60:63], v[156:159], v[112:127]
ds_read_b64_tr_b16 v[52:53], v3 offset:4096
ds_read_b64_tr_b16 v[54:55], v3 offset:4608
s_waitcnt lgkmcnt(9)
v_mfma_f32_32x32x16_bf16 v[96:111], v[32:35], v[160:163], v[96:111]
ds_read_b64_tr_b16 v[56:57], v2 offset:6144
ds_read_b64_tr_b16 v[58:59], v2 offset:6656
v_mov_b32 v22, 0
global_load_dword v23, v22, s[62:63] sc1
s_cmp_lg_u32 s12, 6
s_cbranch_scc1 L_st_40_1_0
buffer_store_dwordx4 v[24:27], v1, s[4:7], s52 offen sc1
L_st_40_1_0:
v_mfma_f32_32x32x16_bf16 v[112:127], v[36:39], v[160:163], v[112:127]
ds_read_b64_tr_b16 v[60:61], v3 offset:6144
ds_read_b64_tr_b16 v[62:63], v3 offset:6656
s_waitcnt lgkmcnt(9)
v_mfma_f32_32x32x16_bf16 v[96:111], v[40:43], v[164:167], v[96:111]
ds_read_b64_tr_b16 v[32:33], v2 offset:8192
ds_read_b64_tr_b16 v[34:35], v2 offset:8704
s_add_u32 s21, s48, 0x0
s_add_u32 m0, s49, 0x14000
s_nop 0
buffer_load_dwordx4 v4, s[40:43], s21 offen lds
s_cmp_lg_u32 s12, 7
s_cbranch_scc1 L_st_41_1_0
buffer_store_dwordx4 v[24:27], v1, s[4:7], s52 offen sc1
L_st_41_1_0:
v_mfma_f32_32x32x16_bf16 v[112:127], v[44:47], v[164:167], v[112:127]
ds_read_b64_tr_b16 v[36:37], v3 offset:8192
ds_read_b64_tr_b16 v[38:39], v3 offset:8704
v_cvt_pk_bf16_f32 v28, v72, v73
v_cvt_pk_bf16_f32 v29, v74, v75
v_cvt_pk_bf16_f32 v30, v76, v77
v_cvt_pk_bf16_f32 v31, v78, v79
s_waitcnt lgkmcnt(8)
v_mfma_f32_32x32x16_bf16 v[96:111], v[48:51], v[168:171], v[96:111]
ds_read_b64_tr_b16 v[40:41], v2 offset:10240
ds_read_b64_tr_b16 v[42:43], v2 offset:10752
s_add_u32 s21, s48, 0x0
s_add_u32 m0, s49, 0x14000
s_nop 0
buffer_load_dwordx4 v5, s[40:43], s21 offen offset:1024 lds
s_cmp_lg_u32 s12, 0
s_cbranch_scc1 L_st_42_1_1
buffer_store_dwordx4 v[28:31], v1, s[4:7], s52 offen offset:1024 sc1
L_st_42_1_1:
v_mfma_f32_32x32x16_bf16 v[112:127], v[52:55], v[168:171], v[112:127]
ds_read_b64_tr_b16 v[44:45], v3 offset:10240
ds_read_b64_tr_b16 v[46:47], v3 offset:10752
s_waitcnt lgkmcnt(8)
v_mfma_f32_32x32x16_bf16 v[96:111], v[56:59], v[172:175], v[96:111]
ds_read_b64_tr_b16 v[48:49], v2 offset:12288
ds_read_b64_tr_b16 v[50:51], v2 offset:12800
s_cmp_lg_u32 s12, 1
s_cbranch_scc1 L_st_43_1_1
buffer_store_dwordx4 v[28:31], v1, s[4:7], s52 offen offset:1024 sc1
L_st_43_1_1:
v_mfma_f32_32x32x16_bf16 v[112:127], v[60:63], v[172:175], v[112:127]
ds_read_b64_tr_b16 v[52:53], v3 offset:12288
ds_read_b64_tr_b16 v[54:55], v3 offset:12800
s_waitcnt lgkmcnt(8)
v_mfma_f32_32x32x16_bf16 v[96:111], v[32:35], v[176:179], v[96:111]
ds_read_b64_tr_b16 v[56:57], v2 offset:14336
ds_read_b64_tr_b16 v[58:59], v2 offset:14848
s_lshl_b32 s54, s15, 3
s_add_u32 s54, s54, s12
s_lshl_b32 s54, s54, 16
s_add_u32 s54, s54, s48
v_bfe_u32 v12, v14, 1, 3
v_lshlrev_b32 v12, 13, v12
v_and_b32 v13, 1, v14
v_lshl_add_u32 v12, v13, 7, v12
buffer_load_dword v11, v12, s[8:11], s54 offen
s_cmp_lg_u32 s12, 2
s_cbranch_scc1 L_st_44_1_1
buffer_store_dwordx4 v[28:31], v1, s[4:7], s52 offen offset:1024 sc1
L_st_44_1_1:
v_mfma_f32_32x32x16_bf16 v[112:127], v[36:39], v[176:179], v[112:127]
ds_read_b64_tr_b16 v[60:61], v3 offset:14336
ds_read_b64_tr_b16 v[62:63], v3 offset:14848
s_waitcnt vmcnt(7)
s_waitcnt vmcnt(3)
v_readfirstlane_b32 s96, v23
s_nop 3
s_cmp_lg_u32 s96, 0
s_cbranch_scc1 L_f_nzok
s_mov_b32 s55, 65536
L_f_nzspin:
global_load_dword v23, v22, s[62:63] sc1
s_waitcnt vmcnt(0)
v_readfirstlane_b32 s96, v23
s_nop 3
s_cmp_lg_u32 s96, 0
s_cbranch_scc1 L_f_nzok
s_sleep 1
s_sub_u32 s55, s55, 1
s_cbranch_scc0 L_f_nzspin
L_f_nzok:
s_barrier
v_add_u32 v2, 0x4000, v2
v_add_u32 v3, 0x4000, v3
s_waitcnt lgkmcnt(8)
v_mfma_f32_32x32x16_bf16 v[96:111], v[40:43], v[180:183], v[96:111]
ds_read_b64_tr_b16 v[32:33], v2 offset:0
ds_read_b64_tr_b16 v[34:35], v2 offset:512
s_add_u32 s21, s48, 0x100000
s_add_u32 m0, s49, 0x18000
s_nop 0
buffer_load_dwordx4 v4, s[40:43], s21 offen lds
s_cmp_lg_u32 s12, 3
s_cbranch_scc1 L_st_45_1_1
buffer_store_dwordx4 v[28:31], v1, s[4:7], s52 offen offset:1024 sc1
L_st_45_1_1:
v_mfma_f32_32x32x16_bf16 v[112:127], v[44:47], v[180:183], v[112:127]
ds_read_b64_tr_b16 v[36:37], v3 offset:0
ds_read_b64_tr_b16 v[38:39], v3 offset:512
s_waitcnt lgkmcnt(8)
v_mfma_f32_32x32x16_bf16 v[96:111], v[48:51], v[184:187], v[96:111]
ds_read_b64_tr_b16 v[40:41], v2 offset:2048
ds_read_b64_tr_b16 v[42:43], v2 offset:2560
s_add_u32 s21, s48, 0x100000
s_add_u32 m0, s49, 0x18000
s_nop 0
buffer_load_dwordx4 v5, s[40:43], s21 offen offset:1024 lds
s_cmp_lg_u32 s12, 4
s_cbranch_scc1 L_st_46_1_1
buffer_store_dwordx4 v[28:31], v1, s[4:7], s52 offen offset:1024 sc1
L_st_46_1_1:
v_mfma_f32_32x32x16_bf16 v[112:127], v[52:55], v[184:187], v[112:127]
ds_read_b64_tr_b16 v[44:45], v3 offset:2048
ds_read_b64_tr_b16 v[46:47], v3 offset:2560
s_waitcnt lgkmcnt(8)
v_mfma_f32_32x32x16_bf16 v[96:111], v[56:59], v[188:191], v[96:111]
ds_read_b64_tr_b16 v[48:49], v2 offset:4096
ds_read_b64_tr_b16 v[50:51], v2 offset:4608
s_cmp_lg_u32 s12, 5
s_cbranch_scc1 L_st_47_1_1
buffer_store_dwordx4 v[28:31], v1, s[4:7], s52 offen offset:1024 sc1
L_st_47_1_1:
v_mfma_f32_32x32x16_bf16 v[112:127], v[60:63], v[188:191], v[112:127]
ds_read_b64_tr_b16 v[52:53], v3 offset:4096
ds_read_b64_tr_b16 v[54:55], v3 offset:4608
s_waitcnt lgkmcnt(8)
v_mfma_f32_32x32x16_bf16 v[96:111], v[32:35], v[192:195], v[96:111]
ds_read_b64_tr_b16 v[56:57], v2 offset:6144
ds_read_b64_tr_b16 v[58:59], v2 offset:6656
s_cmp_lg_u32 s12, 6
s_cbranch_scc1 L_st_48_1_1
buffer_store_dwordx4 v[28:31], v1, s[4:7], s52 offen offset:1024 sc1
L_st_48_1_1:
v_mfma_f32_32x32x16_bf16 v[112:127], v[36:39], v[192:195], v[112:127]
ds_read_b64_tr_b16 v[60:61], v3 offset:6144
ds_read_b64_tr_b16 v[62:63], v3 offset:6656
s_waitcnt lgkmcnt(8)
v_mfma_f32_32x32x16_bf16 v[96:111], v[40:43], v[196:199], v[96:111]
ds_read_b64_tr_b16 v[32:33], v2 offset:8192
ds_read_b64_tr_b16 v[34:35], v2 offset:8704
s_add_u32 s21, s48, 0x200000
s_add_u32 m0, s49, 0x1c000
s_nop 0
buffer_load_dwordx4 v4, s[40:43], s21 offen lds
s_cmp_lg_u32 s12, 7
s_cbranch_scc1 L_st_49_1_1
buffer_store_dwordx4 v[28:31], v1, s[4:7], s52 offen offset:1024 sc1
L_st_49_1_1:
v_mfma_f32_32x32x16_bf16 v[112:127], v[44:47], v[196:199], v[112:127]
ds_read_b64_tr_b16 v[36:37], v3 offset:8192
ds_read_b64_tr_b16 v[38:39], v3 offset:8704
v_cvt_pk_bf16_f32 v24, v80, v81
v_cvt_pk_bf16_f32 v25, v82, v83
v_cvt_pk_bf16_f32 v26, v84, v85
v_cvt_pk_bf16_f32 v27, v86, v87
s_waitcnt lgkmcnt(8)
v_mfma_f32_32x32x16_bf16 v[96:111], v[48:51], v[200:203], v[96:111]
ds_read_b64_tr_b16 v[40:41], v2 offset:10240
ds_read_b64_tr_b16 v[42:43], v2 offset:10752
s_add_u32 s21, s48, 0x200000
s_add_u32 m0, s49, 0x1c000
s_nop 0
buffer_load_dwordx4 v5, s[40:43], s21 offen offset:1024 lds
s_cmp_lg_u32 s12, 0
s_cbranch_scc1 L_st_50_1_2
buffer_store_dwordx4 v[24:27], v1, s[4:7], s52 offen offset:2048 sc1
L_st_50_1_2:
v_mfma_f32_32x32x16_bf16 v[112:127], v[52:55], v[200:203], v[112:127]
ds_read_b64_tr_b16 v[44:45], v3 offset:10240
ds_read_b64_tr_b16 v[46:47], v3 offset:10752
s_waitcnt lgkmcnt(8)
v_mfma_f32_32x32x16_bf16 v[96:111], v[56:59], v[204:207], v[96:111]
ds_read_b64_tr_b16 v[48:49], v2 offset:12288
ds_read_b64_tr_b16 v[50:51], v2 offset:12800
s_cmp_lg_u32 s12, 1
s_cbranch_scc1 L_st_51_1_2
buffer_store_dwordx4 v[24:27], v1, s[4:7], s52 offen offset:2048 sc1
L_st_51_1_2:
v_mfma_f32_32x32x16_bf16 v[112:127], v[60:63], v[204:207], v[112:127]
ds_read_b64_tr_b16 v[52:53], v3 offset:12288
ds_read_b64_tr_b16 v[54:55], v3 offset:12800
s_waitcnt lgkmcnt(8)
v_mfma_f32_32x32x16_bf16 v[96:111], v[32:35], v[208:211], v[96:111]
ds_read_b64_tr_b16 v[56:57], v2 offset:14336
ds_read_b64_tr_b16 v[58:59], v2 offset:14848
s_cmp_lg_u32 s12, 2
s_cbranch_scc1 L_st_52_1_2
buffer_store_dwordx4 v[24:27], v1, s[4:7], s52 offen offset:2048 sc1
L_st_52_1_2:
v_mfma_f32_32x32x16_bf16 v[112:127], v[36:39], v[208:211], v[112:127]
ds_read_b64_tr_b16 v[60:61], v3 offset:14336
ds_read_b64_tr_b16 v[62:63], v3 offset:14848
s_waitcnt vmcnt(8)
s_barrier
s_cmp_lg_u32 s12, 0
s_cbranch_scc1 L_fsig_0
s_lshl_b32 s53, s2, 2
s_add_u32 s53, s53, 0x3f02000
v_mov_b32 v12, 0
v_mov_b32 v13, s96
s_mov_b64 s[54:55], exec
s_mov_b64 exec, 1
buffer_store_dword v13, v12, s[4:7], s53 offen sc1
s_mov_b64 exec, s[54:55]
L_fsig_0:
v_add_u32 v2, 0x4000, v2
v_add_u32 v3, 0x4000, v3
s_waitcnt lgkmcnt(8)
v_mfma_f32_32x32x16_bf16 v[96:111], v[40:43], v[212:215], v[96:111]
ds_read_b64_tr_b16 v[32:33], v2 offset:0
ds_read_b64_tr_b16 v[34:35], v2 offset:512
s_add_u32 s21, s48, 0x300000
s_add_u32 m0, s49, 0x20000
s_nop 0
buffer_load_dwordx4 v4, s[40:43], s21 offen lds
s_cmp_lg_u32 s12, 3
s_cbranch_scc1 L_st_53_1_2
buffer_store_dwordx4 v[24:27], v1, s[4:7], s52 offen offset:2048 sc1
L_st_53_1_2:
v_mfma_f32_32x32x16_bf16 v[112:127], v[44:47], v[212:215], v[112:127]
ds_read_b64_tr_b16 v[36:37], v3 offset:0
ds_read_b64_tr_b16 v[38:39], v3 offset:512
s_waitcnt lgkmcnt(8)
v_mfma_f32_32x32x16_bf16 v[96:111], v[48:51], v[216:219], v[96:111]
ds_read_b64_tr_b16 v[40:41], v2 offset:2048
ds_read_b64_tr_b16 v[42:43], v2 offset:2560
s_add_u32 s21, s48, 0x300000
s_add_u32 m0, s49, 0x20000
s_nop 0
buffer_load_dwordx4 v5, s[40:43], s21 offen offset:1024 lds
s_cmp_lg_u32 s12, 4
s_cbranch_scc1 L_st_54_1_2
buffer_store_dwordx4 v[24:27], v1, s[4:7], s52 offen offset:2048 sc1
L_st_54_1_2:
v_mfma_f32_32x32x16_bf16 v[112:127], v[52:55], v[216:219], v[112:127]
ds_read_b64_tr_b16 v[44:45], v3 offset:2048
ds_read_b64_tr_b16 v[46:47], v3 offset:2560
s_waitcnt lgkmcnt(8)
v_mfma_f32_32x32x16_bf16 v[96:111], v[56:59], v[220:223], v[96:111]
ds_read_b64_tr_b16 v[48:49], v2 offset:4096
ds_read_b64_tr_b16 v[50:51], v2 offset:4608
s_cmp_lg_u32 s12, 5
s_cbranch_scc1 L_st_55_1_2
buffer_store_dwordx4 v[24:27], v1, s[4:7], s52 offen offset:2048 sc1
L_st_55_1_2:
v_mfma_f32_32x32x16_bf16 v[112:127], v[60:63], v[220:223], v[112:127]
ds_read_b64_tr_b16 v[52:53], v3 offset:4096
ds_read_b64_tr_b16 v[54:55], v3 offset:4608
s_waitcnt lgkmcnt(8)
v_mfma_f32_32x32x16_bf16 v[96:111], v[32:35], v[224:227], v[96:111]
ds_read_b64_tr_b16 v[56:57], v2 offset:6144
ds_read_b64_tr_b16 v[58:59], v2 offset:6656
s_cmp_lg_u32 s12, 6
s_cbranch_scc1 L_st_56_1_2
buffer_store_dwordx4 v[24:27], v1, s[4:7], s52 offen offset:2048 sc1
L_st_56_1_2:
v_mfma_f32_32x32x16_bf16 v[112:127], v[36:39], v[224:227], v[112:127]
ds_read_b64_tr_b16 v[60:61], v3 offset:6144
ds_read_b64_tr_b16 v[62:63], v3 offset:6656
s_waitcnt lgkmcnt(8)
v_mfma_f32_32x32x16_bf16 v[96:111], v[40:43], v[228:231], v[96:111]
ds_read_b64_tr_b16 v[32:33], v2 offset:8192
ds_read_b64_tr_b16 v[34:35], v2 offset:8704
s_add_u32 s21, s48, 0x80
s_add_u32 m0, s49, 0x0
s_nop 0
buffer_load_dwordx4 v4, s[40:43], s21 offen lds
s_cmp_lg_u32 s12, 7
s_cbranch_scc1 L_st_57_1_2
buffer_store_dwordx4 v[24:27], v1, s[4:7], s52 offen offset:2048 sc1
L_st_57_1_2:
v_mfma_f32_32x32x16_bf16 v[112:127], v[44:47], v[228:231], v[112:127]
ds_read_b64_tr_b16 v[36:37], v3 offset:8192
ds_read_b64_tr_b16 v[38:39], v3 offset:8704
v_cvt_pk_bf16_f32 v28, v88, v89
v_cvt_pk_bf16_f32 v29, v90, v91
v_cvt_pk_bf16_f32 v30, v92, v93
v_cvt_pk_bf16_f32 v31, v94, v95
s_waitcnt lgkmcnt(8)
v_mfma_f32_32x32x16_bf16 v[96:111], v[48:51], v[232:235], v[96:111]
ds_read_b64_tr_b16 v[40:41], v2 offset:10240
ds_read_b64_tr_b16 v[42:43], v2 offset:10752
s_add_u32 s21, s48, 0x80
s_add_u32 m0, s49, 0x0
s_nop 0
buffer_load_dwordx4 v5, s[40:43], s21 offen offset:1024 lds
s_cmp_lg_u32 s12, 0
s_cbranch_scc1 L_st_58_1_3
buffer_store_dwordx4 v[28:31], v1, s[4:7], s52 offen offset:3072 sc1
L_st_58_1_3:
v_mfma_f32_32x32x16_bf16 v[112:127], v[52:55], v[232:235], v[112:127]
ds_read_b64_tr_b16 v[44:45], v3 offset:10240
ds_read_b64_tr_b16 v[46:47], v3 offset:10752
s_waitcnt lgkmcnt(8)
v_mfma_f32_32x32x16_bf16 v[96:111], v[56:59], v[236:239], v[96:111]
ds_read_b64_tr_b16 v[48:49], v2 offset:12288
ds_read_b64_tr_b16 v[50:51], v2 offset:12800
s_cmp_lg_u32 s12, 1
s_cbranch_scc1 L_st_59_1_3
buffer_store_dwordx4 v[28:31], v1, s[4:7], s52 offen offset:3072 sc1
L_st_59_1_3:
v_mfma_f32_32x32x16_bf16 v[112:127], v[60:63], v[236:239], v[112:127]
ds_read_b64_tr_b16 v[52:53], v3 offset:12288
ds_read_b64_tr_b16 v[54:55], v3 offset:12800
s_waitcnt lgkmcnt(8)
v_mfma_f32_32x32x16_bf16 v[96:111], v[32:35], v[240:243], v[96:111]
ds_read_b64_tr_b16 v[56:57], v2 offset:14336
ds_read_b64_tr_b16 v[58:59], v2 offset:14848
v_lshrrev_b32 v12, 4, v14
v_and_b32 v13, 15, v14
v_lshlrev_b32 v15, 2, v12
v_xor_b32 v15, v15, v13
v_lshlrev_b32 v15, 4, v15
v_lshl_add_u32 v15, v12, 13, v15
s_lshl_b32 s54, s12, 17
v_add_u32 v6, s54, v15
v_add_u32 v7, 0x7c00, v6
v_add_u32 v8, 0xf800, v6
v_add_u32 v9, 0x17400, v6
s_cmp_lg_u32 s12, 2
s_cbranch_scc1 L_st_60_1_3
buffer_store_dwordx4 v[28:31], v1, s[4:7], s52 offen offset:3072 sc1
L_st_60_1_3:
v_mfma_f32_32x32x16_bf16 v[112:127], v[36:39], v[240:243], v[112:127]
ds_read_b64_tr_b16 v[60:61], v3 offset:14336
ds_read_b64_tr_b16 v[62:63], v3 offset:14848
s_waitcnt vmcnt(9)
s_barrier
v_add_u32 v2, 0x4000, v2
v_add_u32 v3, 0x4000, v3
s_waitcnt lgkmcnt(8)
v_mfma_f32_32x32x16_bf16 v[96:111], v[40:43], v[244:247], v[96:111]
ds_read_b64_tr_b16 v[32:33], v2 offset:0
ds_read_b64_tr_b16 v[34:35], v2 offset:512
s_add_u32 s21, s48, 0x100080
s_add_u32 m0, s49, 0x4000
s_nop 0
buffer_load_dwordx4 v4, s[40:43], s21 offen lds
s_cmp_lg_u32 s12, 3
s_cbranch_scc1 L_st_61_1_3
buffer_store_dwordx4 v[28:31], v1, s[4:7], s52 offen offset:3072 sc1
L_st_61_1_3:
v_mfma_f32_32x32x16_bf16 v[112:127], v[44:47], v[244:247], v[112:127]
ds_read_b64_tr_b16 v[36:37], v3 offset:0
ds_read_b64_tr_b16 v[38:39], v3 offset:512
s_waitcnt lgkmcnt(8)
v_mfma_f32_32x32x16_bf16 v[96:111], v[48:51], v[248:251], v[96:111]
ds_read_b64_tr_b16 v[40:41], v2 offset:2048
ds_read_b64_tr_b16 v[42:43], v2 offset:2560
s_add_u32 s21, s48, 0x100080
s_add_u32 m0, s49, 0x4000
s_nop 0
buffer_load_dwordx4 v5, s[40:43], s21 offen offset:1024 lds
s_cmp_lg_u32 s12, 4
s_cbranch_scc1 L_st_62_1_3
buffer_store_dwordx4 v[28:31], v1, s[4:7], s52 offen offset:3072 sc1
L_st_62_1_3:
v_mfma_f32_32x32x16_bf16 v[112:127], v[52:55], v[248:251], v[112:127]
ds_read_b64_tr_b16 v[44:45], v3 offset:2048
ds_read_b64_tr_b16 v[46:47], v3 offset:2560
s_waitcnt lgkmcnt(8)
v_mfma_f32_32x32x16_bf16 v[96:111], v[56:59], v[252:255], v[96:111]
ds_read_b64_tr_b16 v[48:49], v2 offset:4096
ds_read_b64_tr_b16 v[50:51], v2 offset:4608
s_cmp_lg_u32 s12, 5
s_cbranch_scc1 L_st_63_1_3
buffer_store_dwordx4 v[28:31], v1, s[4:7], s52 offen offset:3072 sc1
L_st_63_1_3:
v_mfma_f32_32x32x16_bf16 v[112:127], v[60:63], v[252:255], v[112:127]
ds_read_b64_tr_b16 v[52:53], v3 offset:4096
ds_read_b64_tr_b16 v[54:55], v3 offset:4608
s_waitcnt lgkmcnt(8)
v_mfma_f32_32x32x16_bf16 v[64:79], v[128:131], v[32:35], 0
ds_read_b64_tr_b16 v[56:57], v2 offset:6144
ds_read_b64_tr_b16 v[58:59], v2 offset:6656
s_cmp_lg_u32 s12, 6
s_cbranch_scc1 L_st_64_1_3
buffer_store_dwordx4 v[28:31], v1, s[4:7], s52 offen offset:3072 sc1
L_st_64_1_3:
v_mfma_f32_32x32x16_bf16 v[80:95], v[128:131], v[36:39], 0
ds_read_b64_tr_b16 v[60:61], v3 offset:6144
ds_read_b64_tr_b16 v[62:63], v3 offset:6656
s_waitcnt lgkmcnt(8)
v_mfma_f32_32x32x16_bf16 v[64:79], v[132:135], v[40:43], v[64:79]
ds_read_b64_tr_b16 v[32:33], v2 offset:8192
ds_read_b64_tr_b16 v[34:35], v2 offset:8704
s_add_u32 s21, s48, 0x200080
s_add_u32 m0, s49, 0x8000
s_nop 0
buffer_load_dwordx4 v4, s[40:43], s21 offen lds
s_cmp_lg_u32 s12, 7
s_cbranch_scc1 L_st_65_1_3
buffer_store_dwordx4 v[28:31], v1, s[4:7], s52 offen offset:3072 sc1
L_st_65_1_3:
v_mfma_f32_32x32x16_bf16 v[80:95], v[132:135], v[44:47], v[80:95]
ds_read_b64_tr_b16 v[36:37], v3 offset:8192
ds_read_b64_tr_b16 v[38:39], v3 offset:8704
v_cvt_pk_bf16_f32 v24, v96, v97
v_cvt_pk_bf16_f32 v25, v98, v99
v_cvt_pk_bf16_f32 v26, v100, v101
v_cvt_pk_bf16_f32 v27, v102, v103
s_waitcnt lgkmcnt(8)
v_mfma_f32_32x32x16_bf16 v[64:79], v[136:139], v[48:51], v[64:79]
ds_read_b64_tr_b16 v[40:41], v2 offset:10240
ds_read_b64_tr_b16 v[42:43], v2 offset:10752
s_add_u32 s21, s48, 0x200080
s_add_u32 m0, s49, 0x8000
s_nop 0
buffer_load_dwordx4 v5, s[40:43], s21 offen offset:1024 lds
s_cmp_lg_u32 s12, 0
s_cbranch_scc1 L_st_66_2_0
s_add_u32 s55, s52, 4096
buffer_store_dwordx4 v[24:27], v1, s[4:7], s55 offen sc1
L_st_66_2_0:
v_mfma_f32_32x32x16_bf16 v[80:95], v[136:139], v[52:55], v[80:95]
ds_read_b64_tr_b16 v[44:45], v3 offset:10240
ds_read_b64_tr_b16 v[46:47], v3 offset:10752
s_waitcnt lgkmcnt(8)
v_mfma_f32_32x32x16_bf16 v[64:79], v[140:143], v[56:59], v[64:79]
ds_read_b64_tr_b16 v[48:49], v2 offset:12288
ds_read_b64_tr_b16 v[50:51], v2 offset:12800
s_cmp_lg_u32 s12, 1
s_cbranch_scc1 L_st_67_2_0
s_add_u32 s55, s52, 4096
buffer_store_dwordx4 v[24:27], v1, s[4:7], s55 offen sc1
L_st_67_2_0:
v_mfma_f32_32x32x16_bf16 v[80:95], v[140:143], v[60:63], v[80:95]
ds_read_b64_tr_b16 v[52:53], v3 offset:12288
ds_read_b64_tr_b16 v[54:55], v3 offset:12800
s_waitcnt lgkmcnt(8)
v_mfma_f32_32x32x16_bf16 v[64:79], v[144:147], v[32:35], v[64:79]
ds_read_b64_tr_b16 v[56:57], v2 offset:14336
ds_read_b64_tr_b16 v[58:59], v2 offset:14848
s_cmp_lg_u32 s12, 2
s_cbranch_scc1 L_st_68_2_0
s_add_u32 s55, s52, 4096
buffer_store_dwordx4 v[24:27], v1, s[4:7], s55 offen sc1
L_st_68_2_0:
v_mfma_f32_32x32x16_bf16 v[80:95], v[144:147], v[36:39], v[80:95]
ds_read_b64_tr_b16 v[60:61], v3 offset:14336
ds_read_b64_tr_b16 v[62:63], v3 offset:14848
s_waitcnt vmcnt(10)
s_barrier
v_add_u32 v2, 0x4000, v2
v_add_u32 v3, 0x4000, v3
s_waitcnt lgkmcnt(8)
v_mfma_f32_32x32x16_bf16 v[64:79], v[148:151], v[40:43], v[64:79]
ds_read_b64_tr_b16 v[32:33], v2 offset:0
ds_read_b64_tr_b16 v[34:35], v2 offset:512
s_add_u32 s21, s48, 0x300080
s_add_u32 m0, s49, 0xc000
s_nop 0
buffer_load_dwordx4 v4, s[40:43], s21 offen lds
s_cmp_lg_u32 s12, 3
s_cbranch_scc1 L_st_69_2_0
s_add_u32 s55, s52, 4096
buffer_store_dwordx4 v[24:27], v1, s[4:7], s55 offen sc1
L_st_69_2_0:
v_mfma_f32_32x32x16_bf16 v[80:95], v[148:151], v[44:47], v[80:95]
ds_read_b64_tr_b16 v[36:37], v3 offset:0
ds_read_b64_tr_b16 v[38:39], v3 offset:512
s_waitcnt lgkmcnt(8)
v_mfma_f32_32x32x16_bf16 v[64:79], v[152:155], v[48:51], v[64:79]
ds_read_b64_tr_b16 v[40:41], v2 offset:2048
ds_read_b64_tr_b16 v[42:43], v2 offset:2560
s_add_u32 s21, s48, 0x300080
s_add_u32 m0, s49, 0xc000
s_nop 0
buffer_load_dwordx4 v5, s[40:43], s21 offen offset:1024 lds
s_cmp_lg_u32 s12, 4
s_cbranch_scc1 L_st_70_2_0
s_add_u32 s55, s52, 4096
buffer_store_dwordx4 v[24:27], v1, s[4:7], s55 offen sc1
L_st_70_2_0:
v_mfma_f32_32x32x16_bf16 v[80:95], v[152:155], v[52:55], v[80:95]
ds_read_b64_tr_b16 v[44:45], v3 offset:2048
ds_read_b64_tr_b16 v[46:47], v3 offset:2560
s_waitcnt lgkmcnt(8)
v_mfma_f32_32x32x16_bf16 v[64:79], v[156:159], v[56:59], v[64:79]
ds_read_b64_tr_b16 v[48:49], v2 offset:4096
ds_read_b64_tr_b16 v[50:51], v2 offset:4608
s_cmp_lg_u32 s12, 5
s_cbranch_scc1 L_st_71_2_0
s_add_u32 s55, s52, 4096
buffer_store_dwordx4 v[24:27], v1, s[4:7], s55 offen sc1
L_st_71_2_0:
v_mfma_f32_32x32x16_bf16 v[80:95], v[156:159], v[60:63], v[80:95]
ds_read_b64_tr_b16 v[52:53], v3 offset:4096
ds_read_b64_tr_b16 v[54:55], v3 offset:4608
s_waitcnt lgkmcnt(8)
v_mfma_f32_32x32x16_bf16 v[64:79], v[160:163], v[32:35], v[64:79]
ds_read_b64_tr_b16 v[56:57], v2 offset:6144
ds_read_b64_tr_b16 v[58:59], v2 offset:6656
s_cmp_lg_u32 s12, 6
s_cbranch_scc1 L_st_72_2_0
s_add_u32 s55, s52, 4096
buffer_store_dwordx4 v[24:27], v1, s[4:7], s55 offen sc1
L_st_72_2_0:
v_mfma_f32_32x32x16_bf16 v[80:95], v[160:163], v[36:39], v[80:95]
ds_read_b64_tr_b16 v[60:61], v3 offset:6144
ds_read_b64_tr_b16 v[62:63], v3 offset:6656
s_waitcnt lgkmcnt(8)
v_mfma_f32_32x32x16_bf16 v[64:79], v[164:167], v[40:43], v[64:79]
ds_read_b64_tr_b16 v[32:33], v2 offset:8192
ds_read_b64_tr_b16 v[34:35], v2 offset:8704
s_cmp_lg_u32 s12, 7
s_cbranch_scc1 L_st_73_2_0
s_add_u32 s55, s52, 4096
buffer_store_dwordx4 v[24:27], v1, s[4:7], s55 offen sc1
L_st_73_2_0:
v_mfma_f32_32x32x16_bf16 v[80:95], v[164:167], v[44:47], v[80:95]
ds_read_b64_tr_b16 v[36:37], v3 offset:8192
ds_read_b64_tr_b16 v[38:39], v3 offset:8704
v_cvt_pk_bf16_f32 v28, v104, v105
v_cvt_pk_bf16_f32 v29, v106, v107
v_cvt_pk_bf16_f32 v30, v108, v109
v_cvt_pk_bf16_f32 v31, v110, v111
s_waitcnt lgkmcnt(8)
v_mfma_f32_32x32x16_bf16 v[64:79], v[168:171], v[48:51], v[64:79]
ds_read_b64_tr_b16 v[40:41], v2 offset:10240
ds_read_b64_tr_b16 v[42:43], v2 offset:10752
s_cmp_lg_u32 s12, 0
s_cbranch_scc1 L_st_74_2_1
s_add_u32 s55, s52, 4096
buffer_store_dwordx4 v[28:31], v1, s[4:7], s55 offen offset:1024 sc1
L_st_74_2_1:
v_mfma_f32_32x32x16_bf16 v[80:95], v[168:171], v[52:55], v[80:95]
ds_read_b64_tr_b16 v[44:45], v3 offset:10240
ds_read_b64_tr_b16 v[46:47], v3 offset:10752
s_waitcnt lgkmcnt(8)
v_mfma_f32_32x32x16_bf16 v[64:79], v[172:175], v[56:59], v[64:79]
ds_read_b64_tr_b16 v[48:49], v2 offset:12288
ds_read_b64_tr_b16 v[50:51], v2 offset:12800
s_cmp_lg_u32 s12, 1
s_cbranch_scc1 L_st_75_2_1
s_add_u32 s55, s52, 4096
buffer_store_dwordx4 v[28:31], v1, s[4:7], s55 offen offset:1024 sc1
L_st_75_2_1:
v_mfma_f32_32x32x16_bf16 v[80:95], v[172:175], v[60:63], v[80:95]
ds_read_b64_tr_b16 v[52:53], v3 offset:12288
ds_read_b64_tr_b16 v[54:55], v3 offset:12800
s_waitcnt lgkmcnt(8)
v_mfma_f32_32x32x16_bf16 v[64:79], v[176:179], v[32:35], v[64:79]
ds_read_b64_tr_b16 v[56:57], v2 offset:14336
ds_read_b64_tr_b16 v[58:59], v2 offset:14848
s_cmp_lg_u32 s12, 2
s_cbranch_scc1 L_st_76_2_1
s_add_u32 s55, s52, 4096
buffer_store_dwordx4 v[28:31], v1, s[4:7], s55 offen offset:1024 sc1
L_st_76_2_1:
v_mfma_f32_32x32x16_bf16 v[80:95], v[176:179], v[36:39], v[80:95]
ds_read_b64_tr_b16 v[60:61], v3 offset:14336
ds_read_b64_tr_b16 v[62:63], v3 offset:14848
s_waitcnt vmcnt(10)
s_barrier
v_add_u32 v2, 0x4000, v2
v_add_u32 v3, 0x4000, v3
s_waitcnt lgkmcnt(8)
v_mfma_f32_32x32x16_bf16 v[64:79], v[180:183], v[40:43], v[64:79]
ds_read_b64_tr_b16 v[32:33], v2 offset:0
ds_read_b64_tr_b16 v[34:35], v2 offset:512
s_cmp_lg_u32 s12, 3
s_cbranch_scc1 L_st_77_2_1
s_add_u32 s55, s52, 4096
buffer_store_dwordx4 v[28:31], v1, s[4:7], s55 offen offset:1024 sc1
L_st_77_2_1:
v_mfma_f32_32x32x16_bf16 v[80:95], v[180:183], v[44:47], v[80:95]
ds_read_b64_tr_b16 v[36:37], v3 offset:0
ds_read_b64_tr_b16 v[38:39], v3 offset:512
s_waitcnt lgkmcnt(8)
v_mfma_f32_32x32x16_bf16 v[64:79], v[184:187], v[48:51], v[64:79]
ds_read_b64_tr_b16 v[40:41], v2 offset:2048
ds_read_b64_tr_b16 v[42:43], v2 offset:2560
s_add_u32 s21, s48, 0x100000
s_lshl_b32 s22, s12, 12
s_add_u32 m0, s22, 0x10000
s_nop 0
buffer_load_dwordx4 v6, s[8:11], s21 offen lds
s_cmp_lg_u32 s12, 4
s_cbranch_scc1 L_st_78_2_1
s_add_u32 s55, s52, 4096
buffer_store_dwordx4 v[28:31], v1, s[4:7], s55 offen offset:1024 sc1
L_st_78_2_1:
v_mfma_f32_32x32x16_bf16 v[80:95], v[184:187], v[52:55], v[80:95]
ds_read_b64_tr_b16 v[44:45], v3 offset:2048
ds_read_b64_tr_b16 v[46:47], v3 offset:2560
s_waitcnt lgkmcnt(8)
v_mfma_f32_32x32x16_bf16 v[64:79], v[188:191], v[56:59], v[64:79]
ds_read_b64_tr_b16 v[48:49], v2 offset:4096
ds_read_b64_tr_b16 v[50:51], v2 offset:4608
s_add_u32 s21, s48, 0x100000
s_lshl_b32 s22, s12, 12
s_add_u32 m0, s22, 0x10000
s_nop 0
buffer_load_dwordx4 v7, s[8:11], s21 offen offset:1024 lds
s_cmp_lg_u32 s12, 5
s_cbranch_scc1 L_st_79_2_1
s_add_u32 s55, s52, 4096
buffer_store_dwordx4 v[28:31], v1, s[4:7], s55 offen offset:1024 sc1
L_st_79_2_1:
v_mfma_f32_32x32x16_bf16 v[80:95], v[188:191], v[60:63], v[80:95]
ds_read_b64_tr_b16 v[52:53], v3 offset:4096
ds_read_b64_tr_b16 v[54:55], v3 offset:4608
s_waitcnt lgkmcnt(8)
v_mfma_f32_32x32x16_bf16 v[64:79], v[192:195], v[32:35], v[64:79]
ds_read_b64_tr_b16 v[56:57], v2 offset:6144
ds_read_b64_tr_b16 v[58:59], v2 offset:6656
s_add_u32 s21, s48, 0x100000
s_lshl_b32 s22, s12, 12
s_add_u32 m0, s22, 0x10000
s_nop 0
buffer_load_dwordx4 v8, s[8:11], s21 offen offset:2048 lds
s_cmp_lg_u32 s12, 6
s_cbranch_scc1 L_st_80_2_1
s_add_u32 s55, s52, 4096
buffer_store_dwordx4 v[28:31], v1, s[4:7], s55 offen offset:1024 sc1
L_st_80_2_1:
v_mfma_f32_32x32x16_bf16 v[80:95], v[192:195], v[36:39], v[80:95]
ds_read_b64_tr_b16 v[60:61], v3 offset:6144
ds_read_b64_tr_b16 v[62:63], v3 offset:6656
s_waitcnt lgkmcnt(8)
v_mfma_f32_32x32x16_bf16 v[64:79], v[196:199], v[40:43], v[64:79]
ds_read_b64_tr_b16 v[32:33], v2 offset:8192
ds_read_b64_tr_b16 v[34:35], v2 offset:8704
s_add_u32 s21, s48, 0x100000
s_lshl_b32 s22, s12, 12
s_add_u32 m0, s22, 0x10000
s_nop 0
buffer_load_dwordx4 v9, s[8:11], s21 offen offset:3072 lds
s_cmp_lg_u32 s12, 7
s_cbranch_scc1 L_st_81_2_1
s_add_u32 s55, s52, 4096
buffer_store_dwordx4 v[28:31], v1, s[4:7], s55 offen offset:1024 sc1
L_st_81_2_1:
v_mfma_f32_32x32x16_bf16 v[80:95], v[196:199], v[44:47], v[80:95]
ds_read_b64_tr_b16 v[36:37], v3 offset:8192
ds_read_b64_tr_b16 v[38:39], v3 offset:8704
v_cvt_pk_bf16_f32 v24, v112, v113
v_cvt_pk_bf16_f32 v25, v114, v115
v_cvt_pk_bf16_f32 v26, v116, v117
v_cvt_pk_bf16_f32 v27, v118, v119
s_waitcnt lgkmcnt(8)
v_mfma_f32_32x32x16_bf16 v[64:79], v[200:203], v[48:51], v[64:79]
ds_read_b64_tr_b16 v[40:41], v2 offset:10240
ds_read_b64_tr_b16 v[42:43], v2 offset:10752
s_cmp_lg_u32 s12, 0
s_cbranch_scc1 L_st_82_2_2
s_add_u32 s55, s52, 4096
buffer_store_dwordx4 v[24:27], v1, s[4:7], s55 offen offset:2048 sc1
L_st_82_2_2:
v_mfma_f32_32x32x16_bf16 v[80:95], v[200:203], v[52:55], v[80:95]
ds_read_b64_tr_b16 v[44:45], v3 offset:10240
ds_read_b64_tr_b16 v[46:47], v3 offset:10752
s_waitcnt lgkmcnt(8)
v_mfma_f32_32x32x16_bf16 v[64:79], v[204:207], v[56:59], v[64:79]
ds_read_b64_tr_b16 v[48:49], v2 offset:12288
ds_read_b64_tr_b16 v[50:51], v2 offset:12800
s_cmp_lg_u32 s12, 1
s_cbranch_scc1 L_st_83_2_2
s_add_u32 s55, s52, 4096
buffer_store_dwordx4 v[24:27], v1, s[4:7], s55 offen offset:2048 sc1
L_st_83_2_2:
v_mfma_f32_32x32x16_bf16 v[80:95], v[204:207], v[60:63], v[80:95]
ds_read_b64_tr_b16 v[52:53], v3 offset:12288
ds_read_b64_tr_b16 v[54:55], v3 offset:12800
s_waitcnt lgkmcnt(8)
v_mfma_f32_32x32x16_bf16 v[64:79], v[208:211], v[32:35], v[64:79]
ds_read_b64_tr_b16 v[56:57], v2 offset:14336
ds_read_b64_tr_b16 v[58:59], v2 offset:14848
s_cmp_lg_u32 s12, 2
s_cbranch_scc1 L_st_84_2_2
s_add_u32 s55, s52, 4096
buffer_store_dwordx4 v[24:27], v1, s[4:7], s55 offen offset:2048 sc1
L_st_84_2_2:
v_mfma_f32_32x32x16_bf16 v[80:95], v[208:211], v[36:39], v[80:95]
ds_read_b64_tr_b16 v[60:61], v3 offset:14336
ds_read_b64_tr_b16 v[62:63], v3 offset:14848
s_waitcnt vmcnt(12)
s_barrier
v_add_u32 v2, 0x4000, v2
v_add_u32 v3, 0x4000, v3
s_waitcnt lgkmcnt(8)
v_mfma_f32_32x32x16_bf16 v[64:79], v[212:215], v[40:43], v[64:79]
ds_read_b64_tr_b16 v[32:33], v2 offset:0
ds_read_b64_tr_b16 v[34:35], v2 offset:512
s_cmp_lg_u32 s12, 3
s_cbranch_scc1 L_st_85_2_2
s_add_u32 s55, s52, 4096
buffer_store_dwordx4 v[24:27], v1, s[4:7], s55 offen offset:2048 sc1
L_st_85_2_2:
v_mfma_f32_32x32x16_bf16 v[80:95], v[212:215], v[44:47], v[80:95]
ds_read_b64_tr_b16 v[36:37], v3 offset:0
ds_read_b64_tr_b16 v[38:39], v3 offset:512
s_waitcnt lgkmcnt(8)
v_mfma_f32_32x32x16_bf16 v[64:79], v[216:219], v[48:51], v[64:79]
ds_read_b64_tr_b16 v[40:41], v2 offset:2048
ds_read_b64_tr_b16 v[42:43], v2 offset:2560
s_cmp_lg_u32 s12, 4
s_cbranch_scc1 L_st_86_2_2
s_add_u32 s55, s52, 4096
buffer_store_dwordx4 v[24:27], v1, s[4:7], s55 offen offset:2048 sc1
L_st_86_2_2:
v_mfma_f32_32x32x16_bf16 v[80:95], v[216:219], v[52:55], v[80:95]
ds_read_b64_tr_b16 v[44:45], v3 offset:2048
ds_read_b64_tr_b16 v[46:47], v3 offset:2560
s_waitcnt lgkmcnt(8)
v_mfma_f32_32x32x16_bf16 v[64:79], v[220:223], v[56:59], v[64:79]
ds_read_b64_tr_b16 v[48:49], v2 offset:4096
ds_read_b64_tr_b16 v[50:51], v2 offset:4608
s_cmp_lg_u32 s12, 5
s_cbranch_scc1 L_st_87_2_2
s_add_u32 s55, s52, 4096
buffer_store_dwordx4 v[24:27], v1, s[4:7], s55 offen offset:2048 sc1
L_st_87_2_2:
v_mfma_f32_32x32x16_bf16 v[80:95], v[220:223], v[60:63], v[80:95]
ds_read_b64_tr_b16 v[52:53], v3 offset:4096
ds_read_b64_tr_b16 v[54:55], v3 offset:4608
s_waitcnt lgkmcnt(8)
v_mfma_f32_32x32x16_bf16 v[64:79], v[224:227], v[32:35], v[64:79]
ds_read_b64_tr_b16 v[56:57], v2 offset:6144
ds_read_b64_tr_b16 v[58:59], v2 offset:6656
s_cmp_lg_u32 s12, 6
s_cbranch_scc1 L_st_88_2_2
s_add_u32 s55, s52, 4096
buffer_store_dwordx4 v[24:27], v1, s[4:7], s55 offen offset:2048 sc1
L_st_88_2_2:
v_mfma_f32_32x32x16_bf16 v[80:95], v[224:227], v[36:39], v[80:95]
ds_read_b64_tr_b16 v[60:61], v3 offset:6144
ds_read_b64_tr_b16 v[62:63], v3 offset:6656
s_waitcnt lgkmcnt(8)
v_mfma_f32_32x32x16_bf16 v[64:79], v[228:231], v[40:43], v[64:79]
ds_read_b64_tr_b16 v[32:33], v2 offset:8192
ds_read_b64_tr_b16 v[34:35], v2 offset:8704
s_cmp_lg_u32 s12, 7
s_cbranch_scc1 L_st_89_2_2
s_add_u32 s55, s52, 4096
buffer_store_dwordx4 v[24:27], v1, s[4:7], s55 offen offset:2048 sc1
L_st_89_2_2:
v_mfma_f32_32x32x16_bf16 v[80:95], v[228:231], v[44:47], v[80:95]
ds_read_b64_tr_b16 v[36:37], v3 offset:8192
ds_read_b64_tr_b16 v[38:39], v3 offset:8704
v_cvt_pk_bf16_f32 v28, v120, v121
v_cvt_pk_bf16_f32 v29, v122, v123
v_cvt_pk_bf16_f32 v30, v124, v125
v_cvt_pk_bf16_f32 v31, v126, v127
s_waitcnt lgkmcnt(8)
v_mfma_f32_32x32x16_bf16 v[64:79], v[232:235], v[48:51], v[64:79]
ds_read_b64_tr_b16 v[40:41], v2 offset:10240
ds_read_b64_tr_b16 v[42:43], v2 offset:10752
s_cmp_lg_u32 s12, 0
s_cbranch_scc1 L_st_90_2_3
s_add_u32 s55, s52, 4096
buffer_store_dwordx4 v[28:31], v1, s[4:7], s55 offen offset:3072 sc1
L_st_90_2_3:
v_mfma_f32_32x32x16_bf16 v[80:95], v[232:235], v[52:55], v[80:95]
ds_read_b64_tr_b16 v[44:45], v3 offset:10240
ds_read_b64_tr_b16 v[46:47], v3 offset:10752
s_waitcnt lgkmcnt(8)
v_mfma_f32_32x32x16_bf16 v[64:79], v[236:239], v[56:59], v[64:79]
ds_read_b64_tr_b16 v[48:49], v2 offset:12288
ds_read_b64_tr_b16 v[50:51], v2 offset:12800
s_cmp_lg_u32 s12, 1
s_cbranch_scc1 L_st_91_2_3
s_add_u32 s55, s52, 4096
buffer_store_dwordx4 v[28:31], v1, s[4:7], s55 offen offset:3072 sc1
L_st_91_2_3:
v_mfma_f32_32x32x16_bf16 v[80:95], v[236:239], v[60:63], v[80:95]
ds_read_b64_tr_b16 v[52:53], v3 offset:12288
ds_read_b64_tr_b16 v[54:55], v3 offset:12800
s_waitcnt lgkmcnt(8)
v_mfma_f32_32x32x16_bf16 v[64:79], v[240:243], v[32:35], v[64:79]
ds_read_b64_tr_b16 v[56:57], v2 offset:14336
ds_read_b64_tr_b16 v[58:59], v2 offset:14848
s_cmp_lg_u32 s12, 2
s_cbranch_scc1 L_st_92_2_3
s_add_u32 s55, s52, 4096
buffer_store_dwordx4 v[28:31], v1, s[4:7], s55 offen offset:3072 sc1
L_st_92_2_3:
v_mfma_f32_32x32x16_bf16 v[80:95], v[240:243], v[36:39], v[80:95]
ds_read_b64_tr_b16 v[60:61], v3 offset:14336
ds_read_b64_tr_b16 v[62:63], v3 offset:14848
s_waitcnt vmcnt(10)
s_cmp_lg_u32 s12, 0
s_cbranch_scc1 L_fpoll_1d
v_and_b32 v12, 15, v14
v_lshlrev_b32 v12, 2, v12
s_sub_u32 s54, 15, s15
s_sub_u32 s54, s54, s15
s_lshl_b32 s54, s54, 6
v_mov_b32 v13, s54
v_bfe_u32 v15, v14, 4, 1
v_xor_b32 v15, 1, v15
v_mul_u32_u24 v13, v15, v13
v_add_u32 v12, v12, v13
s_lshl_b32 s54, s15, 6
s_add_u32 s54, s54, 0x3f02000
s_mov_b32 s55, 65536
L_fpoll_1:
buffer_load_dword v13, v12, s[4:7], s54 offen sc1
s_waitcnt vmcnt(0)
v_cmp_ne_u32 vcc, s96, v13
s_nop 3
s_cmp_eq_u64 vcc, 0
s_cbranch_scc1 L_fpoll_1d
s_sleep 1
s_sub_u32 s55, s55, 1
s_cbranch_scc0 L_fpoll_1
L_fpoll_1d:
s_barrier
v_add_u32 v2, 0xfffe0000, v2
v_add_u32 v3, 0xfffe0000, v3
s_waitcnt lgkmcnt(8)
v_mfma_f32_32x32x16_bf16 v[64:79], v[244:247], v[40:43], v[64:79]
ds_read_b64_tr_b16 v[32:33], v2 offset:0
ds_read_b64_tr_b16 v[34:35], v2 offset:512
s_cmp_lg_u32 s12, 3
s_cbranch_scc1 L_st_93_2_3
s_add_u32 s55, s52, 4096
buffer_store_dwordx4 v[28:31], v1, s[4:7], s55 offen offset:3072 sc1
L_st_93_2_3:
v_mfma_f32_32x32x16_bf16 v[80:95], v[244:247], v[44:47], v[80:95]
ds_read_b64_tr_b16 v[36:37], v3 offset:0
ds_read_b64_tr_b16 v[38:39], v3 offset:512
s_waitcnt lgkmcnt(8)
v_mfma_f32_32x32x16_bf16 v[64:79], v[248:251], v[48:51], v[64:79]
ds_read_b64_tr_b16 v[40:41], v2 offset:2048
ds_read_b64_tr_b16 v[42:43], v2 offset:2560
s_add_u32 s21, s48, 0x200000
s_lshl_b32 s22, s12, 12
s_add_u32 m0, s22, 0x18000
s_nop 0
buffer_load_dwordx4 v6, s[8:11], s21 offen lds
s_cmp_lg_u32 s12, 4
s_cbranch_scc1 L_st_94_2_3
s_add_u32 s55, s52, 4096
buffer_store_dwordx4 v[28:31], v1, s[4:7], s55 offen offset:3072 sc1
L_st_94_2_3:
v_mfma_f32_32x32x16_bf16 v[80:95], v[248:251], v[52:55], v[80:95]
ds_read_b64_tr_b16 v[44:45], v3 offset:2048
ds_read_b64_tr_b16 v[46:47], v3 offset:2560
s_waitcnt lgkmcnt(8)
v_mfma_f32_32x32x16_bf16 v[64:79], v[252:255], v[56:59], v[64:79]
ds_read_b64_tr_b16 v[48:49], v2 offset:4096
ds_read_b64_tr_b16 v[50:51], v2 offset:4608
s_add_u32 s21, s48, 0x200000
s_lshl_b32 s22, s12, 12
s_add_u32 m0, s22, 0x18000
s_nop 0
buffer_load_dwordx4 v7, s[8:11], s21 offen offset:1024 lds
s_cmp_lg_u32 s12, 5
s_cbranch_scc1 L_st_95_2_3
s_add_u32 s55, s52, 4096
buffer_store_dwordx4 v[28:31], v1, s[4:7], s55 offen offset:3072 sc1
L_st_95_2_3:
v_mfma_f32_32x32x16_bf16 v[80:95], v[252:255], v[60:63], v[80:95]
ds_read_b64_tr_b16 v[52:53], v3 offset:4096
ds_read_b64_tr_b16 v[54:55], v3 offset:4608
s_waitcnt lgkmcnt(8)
v_mfma_f32_32x32x16_bf16 v[96:111], v[128:131], v[32:35], 0
ds_read_b64_tr_b16 v[56:57], v2 offset:6144
ds_read_b64_tr_b16 v[58:59], v2 offset:6656
s_add_u32 s21, s48, 0x200000
s_lshl_b32 s22, s12, 12
s_add_u32 m0, s22, 0x18000
s_nop 0
buffer_load_dwordx4 v8, s[8:11], s21 offen offset:2048 lds
s_cmp_lg_u32 s12, 6
s_cbranch_scc1 L_st_96_2_3
s_add_u32 s55, s52, 4096
buffer_store_dwordx4 v[28:31], v1, s[4:7], s55 offen offset:3072 sc1
L_st_96_2_3:
v_mfma_f32_32x32x16_bf16 v[112:127], v[128:131], v[36:39], 0
ds_read_b64_tr_b16 v[60:61], v3 offset:6144
ds_read_b64_tr_b16 v[62:63], v3 offset:6656
buffer_load_dwordx4 v[128:131], v1, s[4:7], s29 offen sc1
s_waitcnt lgkmcnt(8)
v_mfma_f32_32x32x16_bf16 v[96:111], v[132:135], v[40:43], v[96:111]
ds_read_b64_tr_b16 v[32:33], v2 offset:8192
ds_read_b64_tr_b16 v[34:35], v2 offset:8704
s_add_u32 s21, s48, 0x200000
s_lshl_b32 s22, s12, 12
s_add_u32 m0, s22, 0x18000
s_nop 0
buffer_load_dwordx4 v9, s[8:11], s21 offen offset:3072 lds
s_cmp_lg_u32 s12, 7
s_cbranch_scc1 L_st_97_2_3
s_add_u32 s55, s52, 4096
buffer_store_dwordx4 v[28:31], v1, s[4:7], s55 offen offset:3072 sc1
L_st_97_2_3:
v_mfma_f32_32x32x16_bf16 v[112:127], v[132:135], v[44:47], v[112:127]
ds_read_b64_tr_b16 v[36:37], v3 offset:8192
ds_read_b64_tr_b16 v[38:39], v3 offset:8704
v_cvt_pk_bf16_f32 v24, v64, v65
v_cvt_pk_bf16_f32 v25, v66, v67
v_cvt_pk_bf16_f32 v26, v68, v69
v_cvt_pk_bf16_f32 v27, v70, v71
buffer_load_dwordx4 v[132:135], v1, s[4:7], s29 offen offset:1024 sc1
s_waitcnt lgkmcnt(8)
v_mfma_f32_32x32x16_bf16 v[96:111], v[136:139], v[48:51], v[96:111]
ds_read_b64_tr_b16 v[40:41], v2 offset:10240
ds_read_b64_tr_b16 v[42:43], v2 offset:10752
s_cmp_lg_u32 s12, 0
s_cbranch_scc1 L_st_98_3_0
s_add_u32 s55, s52, 8192
buffer_store_dwordx4 v[24:27], v1, s[4:7], s55 offen sc1
L_st_98_3_0:
v_mfma_f32_32x32x16_bf16 v[112:127], v[136:139], v[52:55], v[112:127]
ds_read_b64_tr_b16 v[44:45], v3 offset:10240
ds_read_b64_tr_b16 v[46:47], v3 offset:10752
buffer_load_dwordx4 v[136:139], v1, s[4:7], s29 offen offset:2048 sc1
s_waitcnt lgkmcnt(8)
v_mfma_f32_32x32x16_bf16 v[96:111], v[140:143], v[56:59], v[96:111]
ds_read_b64_tr_b16 v[48:49], v2 offset:12288
ds_read_b64_tr_b16 v[50:51], v2 offset:12800
s_cmp_lg_u32 s12, 1
s_cbranch_scc1 L_st_99_3_0
s_add_u32 s55, s52, 8192
buffer_store_dwordx4 v[24:27], v1, s[4:7], s55 offen sc1
L_st_99_3_0:
v_mfma_f32_32x32x16_bf16 v[112:127], v[140:143], v[60:63], v[112:127]
ds_read_b64_tr_b16 v[52:53], v3 offset:12288
ds_read_b64_tr_b16 v[54:55], v3 offset:12800
buffer_load_dwordx4 v[140:143], v1, s[4:7], s29 offen offset:3072 sc1
s_waitcnt lgkmcnt(8)
v_mfma_f32_32x32x16_bf16 v[96:111], v[144:147], v[32:35], v[96:111]
ds_read_b64_tr_b16 v[56:57], v2 offset:14336
ds_read_b64_tr_b16 v[58:59], v2 offset:14848
s_cmp_lg_u32 s12, 2
s_cbranch_scc1 L_st_100_3_0
s_add_u32 s55, s52, 8192
buffer_store_dwordx4 v[24:27], v1, s[4:7], s55 offen sc1
L_st_100_3_0:
v_mfma_f32_32x32x16_bf16 v[112:127], v[144:147], v[36:39], v[112:127]
ds_read_b64_tr_b16 v[60:61], v3 offset:14336
ds_read_b64_tr_b16 v[62:63], v3 offset:14848
s_add_u32 s29, s29, 4096
buffer_load_dwordx4 v[144:147], v1, s[4:7], s29 offen sc1
s_waitcnt vmcnt(17)
s_barrier
v_add_u32 v2, 0x4000, v2
v_add_u32 v3, 0x4000, v3
s_waitcnt lgkmcnt(8)
v_mfma_f32_32x32x16_bf16 v[96:111], v[148:151], v[40:43], v[96:111]
ds_read_b64_tr_b16 v[32:33], v2 offset:0
ds_read_b64_tr_b16 v[34:35], v2 offset:512
s_cmp_lg_u32 s12, 3
s_cbranch_scc1 L_st_101_3_0
s_add_u32 s55, s52, 8192
buffer_store_dwordx4 v[24:27], v1, s[4:7], s55 offen sc1
L_st_101_3_0:
v_mfma_f32_32x32x16_bf16 v[112:127], v[148:151], v[44:47], v[112:127]
ds_read_b64_tr_b16 v[36:37], v3 offset:0
ds_read_b64_tr_b16 v[38:39], v3 offset:512
buffer_load_dwordx4 v[148:151], v1, s[4:7], s29 offen offset:1024 sc1
s_waitcnt lgkmcnt(8)
v_mfma_f32_32x32x16_bf16 v[96:111], v[152:155], v[48:51], v[96:111]
ds_read_b64_tr_b16 v[40:41], v2 offset:2048
ds_read_b64_tr_b16 v[42:43], v2 offset:2560
s_add_u32 s21, s48, 0x0
s_lshl_b32 s22, s12, 12
s_add_u32 m0, s22, 0x20000
s_nop 0
buffer_load_dwordx4 v6, s[8:11], s21 offen lds
s_cmp_lg_u32 s12, 4
s_cbranch_scc1 L_st_102_3_0
s_add_u32 s55, s52, 8192
buffer_store_dwordx4 v[24:27], v1, s[4:7], s55 offen sc1
L_st_102_3_0:
v_mfma_f32_32x32x16_bf16 v[112:127], v[152:155], v[52:55], v[112:127]
ds_read_b64_tr_b16 v[44:45], v3 offset:2048
ds_read_b64_tr_b16 v[46:47], v3 offset:2560
buffer_load_dwordx4 v[152:155], v1, s[4:7], s29 offen offset:2048 sc1
s_waitcnt lgkmcnt(8)
v_mfma_f32_32x32x16_bf16 v[96:111], v[156:159], v[56:59], v[96:111]
ds_read_b64_tr_b16 v[48:49], v2 offset:4096
ds_read_b64_tr_b16 v[50:51], v2 offset:4608
s_add_u32 s21, s48, 0x0
s_lshl_b32 s22, s12, 12
s_add_u32 m0, s22, 0x20000
s_nop 0
buffer_load_dwordx4 v7, s[8:11], s21 offen offset:1024 lds
s_cmp_lg_u32 s12, 5
s_cbranch_scc1 L_st_103_3_0
s_add_u32 s55, s52, 8192
buffer_store_dwordx4 v[24:27], v1, s[4:7], s55 offen sc1
L_st_103_3_0:
v_mfma_f32_32x32x16_bf16 v[112:127], v[156:159], v[60:63], v[112:127]
ds_read_b64_tr_b16 v[52:53], v3 offset:4096
ds_read_b64_tr_b16 v[54:55], v3 offset:4608
buffer_load_dwordx4 v[156:159], v1, s[4:7], s29 offen offset:3072 sc1
s_waitcnt lgkmcnt(8)
v_mfma_f32_32x32x16_bf16 v[96:111], v[160:163], v[32:35], v[96:111]
ds_read_b64_tr_b16 v[56:57], v2 offset:6144
ds_read_b64_tr_b16 v[58:59], v2 offset:6656
s_add_u32 s21, s48, 0x0
s_lshl_b32 s22, s12, 12
s_add_u32 m0, s22, 0x20000
s_nop 0
buffer_load_dwordx4 v8, s[8:11], s21 offen offset:2048 lds
s_cmp_lg_u32 s12, 6
s_cbranch_scc1 L_st_104_3_0
s_add_u32 s55, s52, 8192
buffer_store_dwordx4 v[24:27], v1, s[4:7], s55 offen sc1
L_st_104_3_0:
v_mfma_f32_32x32x16_bf16 v[112:127], v[160:163], v[36:39], v[112:127]
ds_read_b64_tr_b16 v[60:61], v3 offset:6144
ds_read_b64_tr_b16 v[62:63], v3 offset:6656
s_add_u32 s29, s29, 4096
buffer_load_dwordx4 v[160:163], v1, s[4:7], s29 offen sc1
s_waitcnt lgkmcnt(8)
v_mfma_f32_32x32x16_bf16 v[96:111], v[164:167], v[40:43], v[96:111]
ds_read_b64_tr_b16 v[32:33], v2 offset:8192
ds_read_b64_tr_b16 v[34:35], v2 offset:8704
s_add_u32 s21, s48, 0x0
s_lshl_b32 s22, s12, 12
s_add_u32 m0, s22, 0x20000
s_nop 0
buffer_load_dwordx4 v9, s[8:11], s21 offen offset:3072 lds
s_cmp_lg_u32 s12, 7
s_cbranch_scc1 L_st_105_3_0
s_add_u32 s55, s52, 8192
buffer_store_dwordx4 v[24:27], v1, s[4:7], s55 offen sc1
L_st_105_3_0:
v_mfma_f32_32x32x16_bf16 v[112:127], v[164:167], v[44:47], v[112:127]
ds_read_b64_tr_b16 v[36:37], v3 offset:8192
ds_read_b64_tr_b16 v[38:39], v3 offset:8704
v_cvt_pk_bf16_f32 v28, v72, v73
v_cvt_pk_bf16_f32 v29, v74, v75
v_cvt_pk_bf16_f32 v30, v76, v77
v_cvt_pk_bf16_f32 v31, v78, v79
buffer_load_dwordx4 v[164:167], v1, s[4:7], s29 offen offset:1024 sc1
s_waitcnt lgkmcnt(8)
v_mfma_f32_32x32x16_bf16 v[96:111], v[168:171], v[48:51], v[96:111]
ds_read_b64_tr_b16 v[40:41], v2 offset:10240
ds_read_b64_tr_b16 v[42:43], v2 offset:10752
s_cmp_lg_u32 s12, 0
s_cbranch_scc1 L_st_106_3_1
s_add_u32 s55, s52, 12288
buffer_store_dwordx4 v[28:31], v1, s[4:7], s55 offen sc1
L_st_106_3_1:
v_mfma_f32_32x32x16_bf16 v[112:127], v[168:171], v[52:55], v[112:127]
ds_read_b64_tr_b16 v[44:45], v3 offset:10240
ds_read_b64_tr_b16 v[46:47], v3 offset:10752
buffer_load_dwordx4 v[168:171], v1, s[4:7], s29 offen offset:2048 sc1
s_waitcnt lgkmcnt(8)
v_mfma_f32_32x32x16_bf16 v[96:111], v[172:175], v[56:59], v[96:111]
ds_read_b64_tr_b16 v[48:49], v2 offset:12288
ds_read_b64_tr_b16 v[50:51], v2 offset:12800
s_cmp_lg_u32 s12, 1
s_cbranch_scc1 L_st_107_3_1
s_add_u32 s55, s52, 12288
buffer_store_dwordx4 v[28:31], v1, s[4:7], s55 offen sc1
L_st_107_3_1:
v_mfma_f32_32x32x16_bf16 v[112:127], v[172:175], v[60:63], v[112:127]
ds_read_b64_tr_b16 v[52:53], v3 offset:12288
ds_read_b64_tr_b16 v[54:55], v3 offset:12800
buffer_load_dwordx4 v[172:175], v1, s[4:7], s29 offen offset:3072 sc1
s_waitcnt lgkmcnt(8)
v_mfma_f32_32x32x16_bf16 v[96:111], v[176:179], v[32:35], v[96:111]
ds_read_b64_tr_b16 v[56:57], v2 offset:14336
ds_read_b64_tr_b16 v[58:59], v2 offset:14848
s_cmp_lg_u32 s12, 2
s_cbranch_scc1 L_st_108_3_1
s_add_u32 s55, s52, 12288
buffer_store_dwordx4 v[28:31], v1, s[4:7], s55 offen sc1
L_st_108_3_1:
v_mfma_f32_32x32x16_bf16 v[112:127], v[176:179], v[36:39], v[112:127]
ds_read_b64_tr_b16 v[60:61], v3 offset:14336
ds_read_b64_tr_b16 v[62:63], v3 offset:14848
s_add_u32 s29, s29, 4096
buffer_load_dwordx4 v[176:179], v1, s[4:7], s29 offen sc1
s_waitcnt vmcnt(27)
s_barrier
v_add_u32 v2, 0x4000, v2
v_add_u32 v3, 0x4000, v3
s_waitcnt lgkmcnt(8)
v_mfma_f32_32x32x16_bf16 v[96:111], v[180:183], v[40:43], v[96:111]
ds_read_b64_tr_b16 v[32:33], v2 offset:0
ds_read_b64_tr_b16 v[34:35], v2 offset:512
s_cmp_lg_u32 s12, 3
s_cbranch_scc1 L_st_109_3_1
s_add_u32 s55, s52, 12288
buffer_store_dwordx4 v[28:31], v1, s[4:7], s55 offen sc1
L_st_109_3_1:
v_mfma_f32_32x32x16_bf16 v[112:127], v[180:183], v[44:47], v[112:127]
ds_read_b64_tr_b16 v[36:37], v3 offset:0
ds_read_b64_tr_b16 v[38:39], v3 offset:512
buffer_load_dwordx4 v[180:183], v1, s[4:7], s29 offen offset:1024 sc1
s_waitcnt lgkmcnt(8)
v_mfma_f32_32x32x16_bf16 v[96:111], v[184:187], v[48:51], v[96:111]
ds_read_b64_tr_b16 v[40:41], v2 offset:2048
ds_read_b64_tr_b16 v[42:43], v2 offset:2560
s_cmp_lg_u32 s12, 4
s_cbranch_scc1 L_st_110_3_1
s_add_u32 s55, s52, 12288
buffer_store_dwordx4 v[28:31], v1, s[4:7], s55 offen sc1
L_st_110_3_1:
v_mfma_f32_32x32x16_bf16 v[112:127], v[184:187], v[52:55], v[112:127]
ds_read_b64_tr_b16 v[44:45], v3 offset:2048
ds_read_b64_tr_b16 v[46:47], v3 offset:2560
buffer_load_dwordx4 v[184:187], v1, s[4:7], s29 offen offset:2048 sc1
s_waitcnt lgkmcnt(8)
v_mfma_f32_32x32x16_bf16 v[96:111], v[188:191], v[56:59], v[96:111]
ds_read_b64_tr_b16 v[48:49], v2 offset:4096
ds_read_b64_tr_b16 v[50:51], v2 offset:4608
s_cmp_lg_u32 s12, 5
s_cbranch_scc1 L_st_111_3_1
s_add_u32 s55, s52, 12288
buffer_store_dwordx4 v[28:31], v1, s[4:7], s55 offen sc1
L_st_111_3_1:
v_mfma_f32_32x32x16_bf16 v[112:127], v[188:191], v[60:63], v[112:127]
ds_read_b64_tr_b16 v[52:53], v3 offset:4096
ds_read_b64_tr_b16 v[54:55], v3 offset:4608
buffer_load_dwordx4 v[188:191], v1, s[4:7], s29 offen offset:3072 sc1
s_waitcnt lgkmcnt(8)
v_mfma_f32_32x32x16_bf16 v[96:111], v[192:195], v[32:35], v[96:111]
ds_read_b64_tr_b16 v[56:57], v2 offset:6144
ds_read_b64_tr_b16 v[58:59], v2 offset:6656
s_cmp_lg_u32 s12, 6
s_cbranch_scc1 L_st_112_3_1
s_add_u32 s55, s52, 12288
buffer_store_dwordx4 v[28:31], v1, s[4:7], s55 offen sc1
L_st_112_3_1:
v_mfma_f32_32x32x16_bf16 v[112:127], v[192:195], v[36:39], v[112:127]
ds_read_b64_tr_b16 v[60:61], v3 offset:6144
ds_read_b64_tr_b16 v[62:63], v3 offset:6656
s_waitcnt lgkmcnt(8)
v_mfma_f32_32x32x16_bf16 v[96:111], v[196:199], v[40:43], v[96:111]
ds_read_b64_tr_b16 v[32:33], v2 offset:8192
ds_read_b64_tr_b16 v[34:35], v2 offset:8704
s_cmp_lg_u32 s12, 7
s_cbranch_scc1 L_st_113_3_1
s_add_u32 s55, s52, 12288
buffer_store_dwordx4 v[28:31], v1, s[4:7], s55 offen sc1
L_st_113_3_1:
v_mfma_f32_32x32x16_bf16 v[112:127], v[196:199], v[44:47], v[112:127]
ds_read_b64_tr_b16 v[36:37], v3 offset:8192
ds_read_b64_tr_b16 v[38:39], v3 offset:8704
v_cvt_pk_bf16_f32 v24, v80, v81
v_cvt_pk_bf16_f32 v25, v82, v83
v_cvt_pk_bf16_f32 v26, v84, v85
v_cvt_pk_bf16_f32 v27, v86, v87
s_waitcnt lgkmcnt(8)
v_mfma_f32_32x32x16_bf16 v[96:111], v[200:203], v[48:51], v[96:111]
ds_read_b64_tr_b16 v[40:41], v2 offset:10240
ds_read_b64_tr_b16 v[42:43], v2 offset:10752
s_cmp_lg_u32 s12, 0
s_cbranch_scc1 L_st_114_3_2
s_add_u32 s55, s52, 8192
buffer_store_dwordx4 v[24:27], v1, s[4:7], s55 offen offset:1024 sc1
L_st_114_3_2:
v_mfma_f32_32x32x16_bf16 v[112:127], v[200:203], v[52:55], v[112:127]
ds_read_b64_tr_b16 v[44:45], v3 offset:10240
ds_read_b64_tr_b16 v[46:47], v3 offset:10752
s_waitcnt lgkmcnt(8)
v_mfma_f32_32x32x16_bf16 v[96:111], v[204:207], v[56:59], v[96:111]
ds_read_b64_tr_b16 v[48:49], v2 offset:12288
ds_read_b64_tr_b16 v[50:51], v2 offset:12800
s_cmp_lg_u32 s12, 1
s_cbranch_scc1 L_st_115_3_2
s_add_u32 s55, s52, 8192
buffer_store_dwordx4 v[24:27], v1, s[4:7], s55 offen offset:1024 sc1
L_st_115_3_2:
v_mfma_f32_32x32x16_bf16 v[112:127], v[204:207], v[60:63], v[112:127]
ds_read_b64_tr_b16 v[52:53], v3 offset:12288
ds_read_b64_tr_b16 v[54:55], v3 offset:12800
s_waitcnt lgkmcnt(8)
v_mfma_f32_32x32x16_bf16 v[96:111], v[208:211], v[32:35], v[96:111]
ds_read_b64_tr_b16 v[56:57], v2 offset:14336
ds_read_b64_tr_b16 v[58:59], v2 offset:14848
s_cmp_lg_u32 s12, 2
s_cbranch_scc1 L_st_116_3_2
s_add_u32 s55, s52, 8192
buffer_store_dwordx4 v[24:27], v1, s[4:7], s55 offen offset:1024 sc1
L_st_116_3_2:
v_mfma_f32_32x32x16_bf16 v[112:127], v[208:211], v[36:39], v[112:127]
ds_read_b64_tr_b16 v[60:61], v3 offset:14336
ds_read_b64_tr_b16 v[62:63], v3 offset:14848
s_waitcnt vmcnt(28)
s_barrier
v_add_u32 v2, 0x4000, v2
v_add_u32 v3, 0x4000, v3
s_waitcnt lgkmcnt(8)
v_mfma_f32_32x32x16_bf16 v[96:111], v[212:215], v[40:43], v[96:111]
ds_read_b64_tr_b16 v[32:33], v2 offset:0
ds_read_b64_tr_b16 v[34:35], v2 offset:512
s_cmp_lg_u32 s12, 3
s_cbranch_scc1 L_st_117_3_2
s_add_u32 s55, s52, 8192
buffer_store_dwordx4 v[24:27], v1, s[4:7], s55 offen offset:1024 sc1
L_st_117_3_2:
v_mfma_f32_32x32x16_bf16 v[112:127], v[212:215], v[44:47], v[112:127]
ds_read_b64_tr_b16 v[36:37], v3 offset:0
ds_read_b64_tr_b16 v[38:39], v3 offset:512
s_waitcnt lgkmcnt(8)
v_mfma_f32_32x32x16_bf16 v[96:111], v[216:219], v[48:51], v[96:111]
ds_read_b64_tr_b16 v[40:41], v2 offset:2048
ds_read_b64_tr_b16 v[42:43], v2 offset:2560
s_cmp_lg_u32 s12, 4
s_cbranch_scc1 L_st_118_3_2
s_add_u32 s55, s52, 8192
buffer_store_dwordx4 v[24:27], v1, s[4:7], s55 offen offset:1024 sc1
L_st_118_3_2:
v_mfma_f32_32x32x16_bf16 v[112:127], v[216:219], v[52:55], v[112:127]
ds_read_b64_tr_b16 v[44:45], v3 offset:2048
ds_read_b64_tr_b16 v[46:47], v3 offset:2560
s_waitcnt lgkmcnt(8)
v_mfma_f32_32x32x16_bf16 v[96:111], v[220:223], v[56:59], v[96:111]
ds_read_b64_tr_b16 v[48:49], v2 offset:4096
ds_read_b64_tr_b16 v[50:51], v2 offset:4608
s_cmp_lg_u32 s12, 5
s_cbranch_scc1 L_st_119_3_2
s_add_u32 s55, s52, 8192
buffer_store_dwordx4 v[24:27], v1, s[4:7], s55 offen offset:1024 sc1
L_st_119_3_2:
v_mfma_f32_32x32x16_bf16 v[112:127], v[220:223], v[60:63], v[112:127]
ds_read_b64_tr_b16 v[52:53], v3 offset:4096
ds_read_b64_tr_b16 v[54:55], v3 offset:4608
s_waitcnt lgkmcnt(8)
v_mfma_f32_32x32x16_bf16 v[96:111], v[224:227], v[32:35], v[96:111]
ds_read_b64_tr_b16 v[56:57], v2 offset:6144
ds_read_b64_tr_b16 v[58:59], v2 offset:6656
s_cmp_lg_u32 s12, 6
s_cbranch_scc1 L_st_120_3_2
s_add_u32 s55, s52, 8192
buffer_store_dwordx4 v[24:27], v1, s[4:7], s55 offen offset:1024 sc1
L_st_120_3_2:
v_mfma_f32_32x32x16_bf16 v[112:127], v[224:227], v[36:39], v[112:127]
ds_read_b64_tr_b16 v[60:61], v3 offset:6144
ds_read_b64_tr_b16 v[62:63], v3 offset:6656
s_waitcnt lgkmcnt(8)
v_mfma_f32_32x32x16_bf16 v[96:111], v[228:231], v[40:43], v[96:111]
ds_read_b64_tr_b16 v[32:33], v2 offset:8192
ds_read_b64_tr_b16 v[34:35], v2 offset:8704
s_cmp_lg_u32 s12, 7
s_cbranch_scc1 L_st_121_3_2
s_add_u32 s55, s52, 8192
buffer_store_dwordx4 v[24:27], v1, s[4:7], s55 offen offset:1024 sc1
L_st_121_3_2:
v_mfma_f32_32x32x16_bf16 v[112:127], v[228:231], v[44:47], v[112:127]
ds_read_b64_tr_b16 v[36:37], v3 offset:8192
ds_read_b64_tr_b16 v[38:39], v3 offset:8704
v_cvt_pk_bf16_f32 v28, v88, v89
v_cvt_pk_bf16_f32 v29, v90, v91
v_cvt_pk_bf16_f32 v30, v92, v93
v_cvt_pk_bf16_f32 v31, v94, v95
s_waitcnt lgkmcnt(8)
v_mfma_f32_32x32x16_bf16 v[96:111], v[232:235], v[48:51], v[96:111]
ds_read_b64_tr_b16 v[40:41], v2 offset:10240
ds_read_b64_tr_b16 v[42:43], v2 offset:10752
s_cmp_lg_u32 s12, 0
s_cbranch_scc1 L_st_122_3_3
s_add_u32 s55, s52, 12288
buffer_store_dwordx4 v[28:31], v1, s[4:7], s55 offen offset:1024 sc1
L_st_122_3_3:
v_mfma_f32_32x32x16_bf16 v[112:127], v[232:235], v[52:55], v[112:127]
ds_read_b64_tr_b16 v[44:45], v3 offset:10240
ds_read_b64_tr_b16 v[46:47], v3 offset:10752
s_waitcnt lgkmcnt(8)
v_mfma_f32_32x32x16_bf16 v[96:111], v[236:239], v[56:59], v[96:111]
ds_read_b64_tr_b16 v[48:49], v2 offset:12288
ds_read_b64_tr_b16 v[50:51], v2 offset:12800
s_cmp_lg_u32 s12, 1
s_cbranch_scc1 L_st_123_3_3
s_add_u32 s55, s52, 12288
buffer_store_dwordx4 v[28:31], v1, s[4:7], s55 offen offset:1024 sc1
L_st_123_3_3:
v_mfma_f32_32x32x16_bf16 v[112:127], v[236:239], v[60:63], v[112:127]
ds_read_b64_tr_b16 v[52:53], v3 offset:12288
ds_read_b64_tr_b16 v[54:55], v3 offset:12800
s_waitcnt lgkmcnt(8)
v_mfma_f32_32x32x16_bf16 v[96:111], v[240:243], v[32:35], v[96:111]
ds_read_b64_tr_b16 v[56:57], v2 offset:14336
ds_read_b64_tr_b16 v[58:59], v2 offset:14848
s_cmp_lg_u32 s12, 2
s_cbranch_scc1 L_st_124_3_3
s_add_u32 s55, s52, 12288
buffer_store_dwordx4 v[28:31], v1, s[4:7], s55 offen offset:1024 sc1
L_st_124_3_3:
v_mfma_f32_32x32x16_bf16 v[112:127], v[240:243], v[36:39], v[112:127]
ds_read_b64_tr_b16 v[60:61], v3 offset:14336
ds_read_b64_tr_b16 v[62:63], v3 offset:14848
s_waitcnt lgkmcnt(8)
v_mfma_f32_32x32x16_bf16 v[96:111], v[244:247], v[40:43], v[96:111]
s_cmp_lg_u32 s12, 3
s_cbranch_scc1 L_st_125_3_3
s_add_u32 s55, s52, 12288
buffer_store_dwordx4 v[28:31], v1, s[4:7], s55 offen offset:1024 sc1
L_st_125_3_3:
v_mfma_f32_32x32x16_bf16 v[112:127], v[244:247], v[44:47], v[112:127]
s_waitcnt lgkmcnt(4)
v_mfma_f32_32x32x16_bf16 v[96:111], v[248:251], v[48:51], v[96:111]
s_cmp_lg_u32 s12, 4
s_cbranch_scc1 L_st_126_3_3
s_add_u32 s55, s52, 12288
buffer_store_dwordx4 v[28:31], v1, s[4:7], s55 offen offset:1024 sc1
L_st_126_3_3:
v_mfma_f32_32x32x16_bf16 v[112:127], v[248:251], v[52:55], v[112:127]
s_waitcnt lgkmcnt(0)
v_mfma_f32_32x32x16_bf16 v[96:111], v[252:255], v[56:59], v[96:111]
s_cmp_lg_u32 s12, 5
s_cbranch_scc1 L_st_127_3_3
s_add_u32 s55, s52, 12288
buffer_store_dwordx4 v[28:31], v1, s[4:7], s55 offen offset:1024 sc1
L_st_127_3_3:
v_mfma_f32_32x32x16_bf16 v[112:127], v[252:255], v[60:63], v[112:127]
s_cmp_lg_u32 s12, 6
s_cbranch_scc1 L_st_fin_6
s_add_u32 s55, s52, 12288
buffer_store_dwordx4 v[28:31], v1, s[4:7], s55 offen offset:1024 sc1
L_st_fin_6:
s_cmp_lg_u32 s12, 7
s_cbranch_scc1 L_st_fin_7
s_add_u32 s55, s52, 12288
buffer_store_dwordx4 v[28:31], v1, s[4:7], s55 offen offset:1024 sc1
L_st_fin_7:
v_xor_b32 v15, 0, v10
v_add_u32 v2, 0x20000, v15
v_xor_b32 v15, 64, v10
v_add_u32 v3, 0x20000, v15
v_xor_b32 v15, 128, v10
v_add_u32 v4, 0x20000, v15
v_xor_b32 v15, 192, v10
v_add_u32 v5, 0x20000, v15
s_nop 3
v_cvt_pk_bf16_f32 v24, v96, v97
v_cvt_pk_bf16_f32 v25, v98, v99
v_cvt_pk_bf16_f32 v26, v100, v101
v_cvt_pk_bf16_f32 v27, v102, v103
s_add_u32 s55, s52, 8192
buffer_store_dwordx4 v[24:27], v1, s[4:7], s55 offen offset:2048 sc1
s_nop 1
v_cvt_pk_bf16_f32 v28, v104, v105
v_cvt_pk_bf16_f32 v29, v106, v107
v_cvt_pk_bf16_f32 v30, v108, v109
v_cvt_pk_bf16_f32 v31, v110, v111
s_add_u32 s55, s52, 12288
buffer_store_dwordx4 v[28:31], v1, s[4:7], s55 offen offset:2048 sc1
s_nop 1
v_cvt_pk_bf16_f32 v24, v112, v113
v_cvt_pk_bf16_f32 v25, v114, v115
v_cvt_pk_bf16_f32 v26, v116, v117
v_cvt_pk_bf16_f32 v27, v118, v119
s_add_u32 s55, s52, 8192
buffer_store_dwordx4 v[24:27], v1, s[4:7], s55 offen offset:3072 sc1
s_nop 1
v_cvt_pk_bf16_f32 v28, v120, v121
v_cvt_pk_bf16_f32 v29, v122, v123
v_cvt_pk_bf16_f32 v30, v124, v125
v_cvt_pk_bf16_f32 v31, v126, v127
s_add_u32 s55, s52, 12288
buffer_store_dwordx4 v[28:31], v1, s[4:7], s55 offen offset:3072 sc1
s_nop 1
s_waitcnt vmcnt(11)
s_barrier
ds_read_b64_tr_b16 v[16:17], v2 offset:0
ds_read_b64_tr_b16 v[18:19], v2 offset:1024
ds_read_b64_tr_b16 v[20:21], v3 offset:0
ds_read_b64_tr_b16 v[22:23], v3 offset:1024
ds_read_b64_tr_b16 v[24:25], v4 offset:0
ds_read_b64_tr_b16 v[26:27], v4 offset:1024
ds_read_b64_tr_b16 v[28:29], v5 offset:0
ds_read_b64_tr_b16 v[30:31], v5 offset:1024
ds_read_b64_tr_b16 v[32:33], v2 offset:4096
ds_read_b64_tr_b16 v[34:35], v2 offset:5120
ds_read_b64_tr_b16 v[36:37], v3 offset:4096
ds_read_b64_tr_b16 v[38:39], v3 offset:5120
ds_read_b64_tr_b16 v[40:41], v4 offset:4096
ds_read_b64_tr_b16 v[42:43], v4 offset:5120
ds_read_b64_tr_b16 v[44:45], v5 offset:4096
ds_read_b64_tr_b16 v[46:47], v5 offset:5120
s_waitcnt lgkmcnt(8)
v_mfma_f32_32x32x16_bf16 v[64:79], v[16:19], v[128:131], 0
ds_read_b64_tr_b16 v[48:49], v2 offset:8192
ds_read_b64_tr_b16 v[50:51], v2 offset:9216
s_add_u32 s29, s29, 4096
buffer_load_dwordx4 v[192:195], v1, s[4:7], s29 offen sc1
v_mfma_f32_32x32x16_bf16 v[80:95], v[20:23], v[128:131], 0
ds_read_b64_tr_b16 v[52:53], v3 offset:8192
ds_read_b64_tr_b16 v[54:55], v3 offset:9216
v_mfma_f32_32x32x16_bf16 v[96:111], v[24:27], v[128:131], 0
ds_read_b64_tr_b16 v[56:57], v4 offset:8192
ds_read_b64_tr_b16 v[58:59], v4 offset:9216
v_mfma_f32_32x32x16_bf16 v[112:127], v[28:31], v[128:131], 0
ds_read_b64_tr_b16 v[60:61], v5 offset:8192
ds_read_b64_tr_b16 v[62:63], v5 offset:9216
s_waitcnt lgkmcnt(8)
v_mfma_f32_32x32x16_bf16 v[64:79], v[32:35], v[132:135], v[64:79]
ds_read_b64_tr_b16 v[16:17], v2 offset:12288
ds_read_b64_tr_b16 v[18:19], v2 offset:13312
buffer_load_dwordx4 v[196:199], v1, s[4:7], s29 offen offset:1024 sc1
v_mfma_f32_32x32x16_bf16 v[80:95], v[36:39], v[132:135], v[80:95]
ds_read_b64_tr_b16 v[20:21], v3 offset:12288
ds_read_b64_tr_b16 v[22:23], v3 offset:13312
v_mfma_f32_32x32x16_bf16 v[96:111], v[40:43], v[132:135], v[96:111]
ds_read_b64_tr_b16 v[24:25], v4 offset:12288
ds_read_b64_tr_b16 v[26:27], v4 offset:13312
v_mfma_f32_32x32x16_bf16 v[112:127], v[44:47], v[132:135], v[112:127]
ds_read_b64_tr_b16 v[28:29], v5 offset:12288
ds_read_b64_tr_b16 v[30:31], v5 offset:13312
s_waitcnt lgkmcnt(8)
v_mfma_f32_32x32x16_bf16 v[64:79], v[48:51], v[136:139], v[64:79]
ds_read_b64_tr_b16 v[32:33], v2 offset:16384
ds_read_b64_tr_b16 v[34:35], v2 offset:17408
buffer_load_dwordx4 v[200:203], v1, s[4:7], s29 offen offset:2048 sc1
v_mfma_f32_32x32x16_bf16 v[80:95], v[52:55], v[136:139], v[80:95]
ds_read_b64_tr_b16 v[36:37], v3 offset:16384
ds_read_b64_tr_b16 v[38:39], v3 offset:17408
v_mfma_f32_32x32x16_bf16 v[96:111], v[56:59], v[136:139], v[96:111]
ds_read_b64_tr_b16 v[40:41], v4 offset:16384
ds_read_b64_tr_b16 v[42:43], v4 offset:17408
v_mfma_f32_32x32x16_bf16 v[112:127], v[60:63], v[136:139], v[112:127]
ds_read_b64_tr_b16 v[44:45], v5 offset:16384
ds_read_b64_tr_b16 v[46:47], v5 offset:17408
s_waitcnt lgkmcnt(8)
v_mfma_f32_32x32x16_bf16 v[64:79], v[16:19], v[140:143], v[64:79]
ds_read_b64_tr_b16 v[48:49], v2 offset:20480
ds_read_b64_tr_b16 v[50:51], v2 offset:21504
buffer_load_dwordx4 v[204:207], v1, s[4:7], s29 offen offset:3072 sc1
v_mfma_f32_32x32x16_bf16 v[80:95], v[20:23], v[140:143], v[80:95]
ds_read_b64_tr_b16 v[52:53], v3 offset:20480
ds_read_b64_tr_b16 v[54:55], v3 offset:21504
v_mfma_f32_32x32x16_bf16 v[96:111], v[24:27], v[140:143], v[96:111]
ds_read_b64_tr_b16 v[56:57], v4 offset:20480
ds_read_b64_tr_b16 v[58:59], v4 offset:21504
v_mfma_f32_32x32x16_bf16 v[112:127], v[28:31], v[140:143], v[112:127]
ds_read_b64_tr_b16 v[60:61], v5 offset:20480
ds_read_b64_tr_b16 v[62:63], v5 offset:21504
s_waitcnt vmcnt(18)
s_waitcnt lgkmcnt(8)
v_mfma_f32_32x32x16_bf16 v[64:79], v[32:35], v[144:147], v[64:79]
ds_read_b64_tr_b16 v[16:17], v2 offset:24576
ds_read_b64_tr_b16 v[18:19], v2 offset:25600
s_add_u32 s29, s29, 4096
buffer_load_dwordx4 v[208:211], v1, s[4:7], s29 offen sc1
v_mfma_f32_32x32x16_bf16 v[80:95], v[36:39], v[144:147], v[80:95]
ds_read_b64_tr_b16 v[20:21], v3 offset:24576
ds_read_b64_tr_b16 v[22:23], v3 offset:25600
v_mfma_f32_32x32x16_bf16 v[96:111], v[40:43], v[144:147], v[96:111]
ds_read_b64_tr_b16 v[24:25], v4 offset:24576
ds_read_b64_tr_b16 v[26:27], v4 offset:25600
v_mfma_f32_32x32x16_bf16 v[112:127], v[44:47], v[144:147], v[112:127]
ds_read_b64_tr_b16 v[28:29], v5 offset:24576
ds_read_b64_tr_b16 v[30:31], v5 offset:25600
s_waitcnt lgkmcnt(8)
v_mfma_f32_32x32x16_bf16 v[64:79], v[48:51], v[148:151], v[64:79]
ds_read_b64_tr_b16 v[32:33], v2 offset:28672
ds_read_b64_tr_b16 v[34:35], v2 offset:29696
buffer_load_dwordx4 v[212:215], v1, s[4:7], s29 offen offset:1024 sc1
v_mfma_f32_32x32x16_bf16 v[80:95], v[52:55], v[148:151], v[80:95]
ds_read_b64_tr_b16 v[36:37], v3 offset:28672
ds_read_b64_tr_b16 v[38:39], v3 offset:29696
v_mfma_f32_32x32x16_bf16 v[96:111], v[56:59], v[148:151], v[96:111]
ds_read_b64_tr_b16 v[40:41], v4 offset:28672
ds_read_b64_tr_b16 v[42:43], v4 offset:29696
v_mfma_f32_32x32x16_bf16 v[112:127], v[60:63], v[148:151], v[112:127]
ds_read_b64_tr_b16 v[44:45], v5 offset:28672
ds_read_b64_tr_b16 v[46:47], v5 offset:29696
s_waitcnt vmcnt(6)
s_barrier
s_cmp_lg_u32 s12, 0
s_cbranch_scc1 L_fsig_2
s_lshl_b32 s53, s14, 7
s_lshl_b32 s54, s15, 2
s_add_u32 s53, s53, s54
s_add_u32 s53, s53, 0x3f03000
v_mov_b32 v12, 0
v_mov_b32 v13, s96
s_mov_b64 s[54:55], exec
s_mov_b64 exec, 1
buffer_store_dword v13, v12, s[4:7], s53 offen sc1
s_mov_b64 exec, s[54:55]
L_fsig_2:
v_xor_b32 v15, 0, v10
v_add_u32 v2, 0x10000, v15
v_xor_b32 v15, 64, v10
v_add_u32 v3, 0x10000, v15
v_xor_b32 v15, 128, v10
v_add_u32 v4, 0x10000, v15
v_xor_b32 v15, 192, v10
v_add_u32 v5, 0x10000, v15
s_waitcnt lgkmcnt(8)
v_mfma_f32_32x32x16_bf16 v[64:79], v[16:19], v[152:155], v[64:79]
ds_read_b64_tr_b16 v[48:49], v2 offset:0
ds_read_b64_tr_b16 v[50:51], v2 offset:1024
buffer_load_dwordx4 v[216:219], v1, s[4:7], s29 offen offset:2048 sc1
v_mfma_f32_32x32x16_bf16 v[80:95], v[20:23], v[152:155], v[80:95]
ds_read_b64_tr_b16 v[52:53], v3 offset:0
ds_read_b64_tr_b16 v[54:55], v3 offset:1024
v_mfma_f32_32x32x16_bf16 v[96:111], v[24:27], v[152:155], v[96:111]
ds_read_b64_tr_b16 v[56:57], v4 offset:0
ds_read_b64_tr_b16 v[58:59], v4 offset:1024
v_mfma_f32_32x32x16_bf16 v[112:127], v[28:31], v[152:155], v[112:127]
ds_read_b64_tr_b16 v[60:61], v5 offset:0
ds_read_b64_tr_b16 v[62:63], v5 offset:1024
s_waitcnt lgkmcnt(8)
v_mfma_f32_32x32x16_bf16 v[64:79], v[32:35], v[156:159], v[64:79]
ds_read_b64_tr_b16 v[16:17], v2 offset:4096
ds_read_b64_tr_b16 v[18:19], v2 offset:5120
buffer_load_dwordx4 v[220:223], v1, s[4:7], s29 offen offset:3072 sc1
v_mfma_f32_32x32x16_bf16 v[80:95], v[36:39], v[156:159], v[80:95]
ds_read_b64_tr_b16 v[20:21], v3 offset:4096
ds_read_b64_tr_b16 v[22:23], v3 offset:5120
v_mfma_f32_32x32x16_bf16 v[96:111], v[40:43], v[156:159], v[96:111]
ds_read_b64_tr_b16 v[24:25], v4 offset:4096
ds_read_b64_tr_b16 v[26:27], v4 offset:5120
v_mfma_f32_32x32x16_bf16 v[112:127], v[44:47], v[156:159], v[112:127]
ds_read_b64_tr_b16 v[28:29], v5 offset:4096
ds_read_b64_tr_b16 v[30:31], v5 offset:5120
s_waitcnt vmcnt(16)
s_waitcnt lgkmcnt(8)
v_mfma_f32_32x32x16_bf16 v[64:79], v[48:51], v[160:163], v[64:79]
ds_read_b64_tr_b16 v[32:33], v2 offset:8192
ds_read_b64_tr_b16 v[34:35], v2 offset:9216
s_add_u32 s29, s29, 4096
buffer_load_dwordx4 v[224:227], v1, s[4:7], s29 offen sc1
v_mfma_f32_32x32x16_bf16 v[80:95], v[52:55], v[160:163], v[80:95]
ds_read_b64_tr_b16 v[36:37], v3 offset:8192
ds_read_b64_tr_b16 v[38:39], v3 offset:9216
v_mfma_f32_32x32x16_bf16 v[96:111], v[56:59], v[160:163], v[96:111]
ds_read_b64_tr_b16 v[40:41], v4 offset:8192
ds_read_b64_tr_b16 v[42:43], v4 offset:9216
v_mfma_f32_32x32x16_bf16 v[112:127], v[60:63], v[160:163], v[112:127]
ds_read_b64_tr_b16 v[44:45], v5 offset:8192
ds_read_b64_tr_b16 v[46:47], v5 offset:9216
s_waitcnt lgkmcnt(8)
v_mfma_f32_32x32x16_bf16 v[64:79], v[16:19], v[164:167], v[64:79]
ds_read_b64_tr_b16 v[48:49], v2 offset:12288
ds_read_b64_tr_b16 v[50:51], v2 offset:13312
buffer_load_dwordx4 v[228:231], v1, s[4:7], s29 offen offset:1024 sc1
v_mfma_f32_32x32x16_bf16 v[80:95], v[20:23], v[164:167], v[80:95]
ds_read_b64_tr_b16 v[52:53], v3 offset:12288
ds_read_b64_tr_b16 v[54:55], v3 offset:13312
v_mfma_f32_32x32x16_bf16 v[96:111], v[24:27], v[164:167], v[96:111]
ds_read_b64_tr_b16 v[56:57], v4 offset:12288
ds_read_b64_tr_b16 v[58:59], v4 offset:13312
v_mfma_f32_32x32x16_bf16 v[112:127], v[28:31], v[164:167], v[112:127]
ds_read_b64_tr_b16 v[60:61], v5 offset:12288
ds_read_b64_tr_b16 v[62:63], v5 offset:13312
s_waitcnt lgkmcnt(8)
v_mfma_f32_32x32x16_bf16 v[64:79], v[32:35], v[168:171], v[64:79]
ds_read_b64_tr_b16 v[16:17], v2 offset:16384
ds_read_b64_tr_b16 v[18:19], v2 offset:17408
buffer_load_dwordx4 v[232:235], v1, s[4:7], s29 offen offset:2048 sc1
v_mfma_f32_32x32x16_bf16 v[80:95], v[36:39], v[168:171], v[80:95]
ds_read_b64_tr_b16 v[20:21], v3 offset:16384
ds_read_b64_tr_b16 v[22:23], v3 offset:17408
v_mfma_f32_32x32x16_bf16 v[96:111], v[40:43], v[168:171], v[96:111]
ds_read_b64_tr_b16 v[24:25], v4 offset:16384
ds_read_b64_tr_b16 v[26:27], v4 offset:17408
v_mfma_f32_32x32x16_bf16 v[112:127], v[44:47], v[168:171], v[112:127]
ds_read_b64_tr_b16 v[28:29], v5 offset:16384
ds_read_b64_tr_b16 v[30:31], v5 offset:17408
s_waitcnt lgkmcnt(8)
v_mfma_f32_32x32x16_bf16 v[64:79], v[48:51], v[172:175], v[64:79]
ds_read_b64_tr_b16 v[32:33], v2 offset:20480
ds_read_b64_tr_b16 v[34:35], v2 offset:21504
buffer_load_dwordx4 v[236:239], v1, s[4:7], s29 offen offset:3072 sc1
v_mfma_f32_32x32x16_bf16 v[80:95], v[52:55], v[172:175], v[80:95]
ds_read_b64_tr_b16 v[36:37], v3 offset:20480
ds_read_b64_tr_b16 v[38:39], v3 offset:21504
v_mfma_f32_32x32x16_bf16 v[96:111], v[56:59], v[172:175], v[96:111]
ds_read_b64_tr_b16 v[40:41], v4 offset:20480
ds_read_b64_tr_b16 v[42:43], v4 offset:21504
v_mfma_f32_32x32x16_bf16 v[112:127], v[60:63], v[172:175], v[112:127]
ds_read_b64_tr_b16 v[44:45], v5 offset:20480
ds_read_b64_tr_b16 v[46:47], v5 offset:21504
s_waitcnt vmcnt(16)
s_waitcnt lgkmcnt(8)
v_mfma_f32_32x32x16_bf16 v[64:79], v[16:19], v[176:179], v[64:79]
ds_read_b64_tr_b16 v[48:49], v2 offset:24576
ds_read_b64_tr_b16 v[50:51], v2 offset:25600
s_add_u32 s29, s29, 4096
buffer_load_dwordx4 v[240:243], v1, s[4:7], s29 offen sc1
v_mfma_f32_32x32x16_bf16 v[80:95], v[20:23], v[176:179], v[80:95]
ds_read_b64_tr_b16 v[52:53], v3 offset:24576
ds_read_b64_tr_b16 v[54:55], v3 offset:25600
v_mfma_f32_32x32x16_bf16 v[96:111], v[24:27], v[176:179], v[96:111]
ds_read_b64_tr_b16 v[56:57], v4 offset:24576
ds_read_b64_tr_b16 v[58:59], v4 offset:25600
v_mfma_f32_32x32x16_bf16 v[112:127], v[28:31], v[176:179], v[112:127]
ds_read_b64_tr_b16 v[60:61], v5 offset:24576
ds_read_b64_tr_b16 v[62:63], v5 offset:25600
s_waitcnt lgkmcnt(8)
v_mfma_f32_32x32x16_bf16 v[64:79], v[32:35], v[180:183], v[64:79]
ds_read_b64_tr_b16 v[16:17], v2 offset:28672
ds_read_b64_tr_b16 v[18:19], v2 offset:29696
buffer_load_dwordx4 v[244:247], v1, s[4:7], s29 offen offset:1024 sc1
v_mfma_f32_32x32x16_bf16 v[80:95], v[36:39], v[180:183], v[80:95]
ds_read_b64_tr_b16 v[20:21], v3 offset:28672
ds_read_b64_tr_b16 v[22:23], v3 offset:29696
v_mfma_f32_32x32x16_bf16 v[96:111], v[40:43], v[180:183], v[96:111]
ds_read_b64_tr_b16 v[24:25], v4 offset:28672
ds_read_b64_tr_b16 v[26:27], v4 offset:29696
v_mfma_f32_32x32x16_bf16 v[112:127], v[44:47], v[180:183], v[112:127]
ds_read_b64_tr_b16 v[28:29], v5 offset:28672
ds_read_b64_tr_b16 v[30:31], v5 offset:29696
s_waitcnt vmcnt(37)
s_barrier
v_xor_b32 v15, 0, v10
v_add_u32 v2, 0x18000, v15
v_xor_b32 v15, 64, v10
v_add_u32 v3, 0x18000, v15
v_xor_b32 v15, 128, v10
v_add_u32 v4, 0x18000, v15
v_xor_b32 v15, 192, v10
v_add_u32 v5, 0x18000, v15
s_waitcnt lgkmcnt(8)
v_mfma_f32_32x32x16_bf16 v[64:79], v[48:51], v[184:187], v[64:79]
ds_read_b64_tr_b16 v[32:33], v2 offset:0
ds_read_b64_tr_b16 v[34:35], v2 offset:1024
buffer_load_dwordx4 v[248:251], v1, s[4:7], s29 offen offset:2048 sc1
v_mfma_f32_32x32x16_bf16 v[80:95], v[52:55], v[184:187], v[80:95]
ds_read_b64_tr_b16 v[36:37], v3 offset:0
ds_read_b64_tr_b16 v[38:39], v3 offset:1024
s_add_u32 s21, s48, 0x300000
s_lshl_b32 s22, s12, 12
s_add_u32 m0, s22, 0x20000
s_nop 0
buffer_load_dwordx4 v6, s[8:11], s21 offen lds
v_mfma_f32_32x32x16_bf16 v[96:111], v[56:59], v[184:187], v[96:111]
ds_read_b64_tr_b16 v[40:41], v4 offset:0
ds_read_b64_tr_b16 v[42:43], v4 offset:1024
v_mfma_f32_32x32x16_bf16 v[112:127], v[60:63], v[184:187], v[112:127]
ds_read_b64_tr_b16 v[44:45], v5 offset:0
ds_read_b64_tr_b16 v[46:47], v5 offset:1024
buffer_load_dwordx4 v7, s[8:11], s21 offen offset:1024 lds
s_waitcnt lgkmcnt(8)
v_mfma_f32_32x32x16_bf16 v[64:79], v[16:19], v[188:191], v[64:79]
ds_read_b64_tr_b16 v[48:49], v2 offset:4096
ds_read_b64_tr_b16 v[50:51], v2 offset:5120
buffer_load_dwordx4 v[252:255], v1, s[4:7], s29 offen offset:3072 sc1
v_mfma_f32_32x32x16_bf16 v[80:95], v[20:23], v[188:191], v[80:95]
ds_read_b64_tr_b16 v[52:53], v3 offset:4096
ds_read_b64_tr_b16 v[54:55], v3 offset:5120
buffer_load_dwordx4 v8, s[8:11], s21 offen offset:2048 lds
v_mfma_f32_32x32x16_bf16 v[96:111], v[24:27], v[188:191], v[96:111]
ds_read_b64_tr_b16 v[56:57], v4 offset:4096
ds_read_b64_tr_b16 v[58:59], v4 offset:5120
v_mfma_f32_32x32x16_bf16 v[112:127], v[28:31], v[188:191], v[112:127]
ds_read_b64_tr_b16 v[60:61], v5 offset:4096
ds_read_b64_tr_b16 v[62:63], v5 offset:5120
buffer_load_dwordx4 v9, s[8:11], s21 offen offset:3072 lds
s_waitcnt vmcnt(16)
s_waitcnt lgkmcnt(8)
v_mfma_f32_32x32x16_bf16 v[64:79], v[32:35], v[192:195], v[64:79]
ds_read_b64_tr_b16 v[16:17], v2 offset:8192
ds_read_b64_tr_b16 v[18:19], v2 offset:9216
v_mfma_f32_32x32x16_bf16 v[80:95], v[36:39], v[192:195], v[80:95]
ds_read_b64_tr_b16 v[20:21], v3 offset:8192
ds_read_b64_tr_b16 v[22:23], v3 offset:9216
v_mfma_f32_32x32x16_bf16 v[96:111], v[40:43], v[192:195], v[96:111]
ds_read_b64_tr_b16 v[24:25], v4 offset:8192
ds_read_b64_tr_b16 v[26:27], v4 offset:9216
v_mfma_f32_32x32x16_bf16 v[112:127], v[44:47], v[192:195], v[112:127]
ds_read_b64_tr_b16 v[28:29], v5 offset:8192
ds_read_b64_tr_b16 v[30:31], v5 offset:9216
s_waitcnt lgkmcnt(8)
v_mfma_f32_32x32x16_bf16 v[64:79], v[48:51], v[196:199], v[64:79]
ds_read_b64_tr_b16 v[32:33], v2 offset:12288
ds_read_b64_tr_b16 v[34:35], v2 offset:13312
v_mfma_f32_32x32x16_bf16 v[80:95], v[52:55], v[196:199], v[80:95]
ds_read_b64_tr_b16 v[36:37], v3 offset:12288
ds_read_b64_tr_b16 v[38:39], v3 offset:13312
v_mfma_f32_32x32x16_bf16 v[96:111], v[56:59], v[196:199], v[96:111]
ds_read_b64_tr_b16 v[40:41], v4 offset:12288
ds_read_b64_tr_b16 v[42:43], v4 offset:13312
v_mfma_f32_32x32x16_bf16 v[112:127], v[60:63], v[196:199], v[112:127]
ds_read_b64_tr_b16 v[44:45], v5 offset:12288
ds_read_b64_tr_b16 v[46:47], v5 offset:13312
s_waitcnt lgkmcnt(8)
v_mfma_f32_32x32x16_bf16 v[64:79], v[16:19], v[200:203], v[64:79]
ds_read_b64_tr_b16 v[48:49], v2 offset:16384
ds_read_b64_tr_b16 v[50:51], v2 offset:17408
v_mfma_f32_32x32x16_bf16 v[80:95], v[20:23], v[200:203], v[80:95]
ds_read_b64_tr_b16 v[52:53], v3 offset:16384
ds_read_b64_tr_b16 v[54:55], v3 offset:17408
v_mfma_f32_32x32x16_bf16 v[96:111], v[24:27], v[200:203], v[96:111]
ds_read_b64_tr_b16 v[56:57], v4 offset:16384
ds_read_b64_tr_b16 v[58:59], v4 offset:17408
v_mfma_f32_32x32x16_bf16 v[112:127], v[28:31], v[200:203], v[112:127]
ds_read_b64_tr_b16 v[60:61], v5 offset:16384
ds_read_b64_tr_b16 v[62:63], v5 offset:17408
s_waitcnt lgkmcnt(8)
v_mfma_f32_32x32x16_bf16 v[64:79], v[32:35], v[204:207], v[64:79]
ds_read_b64_tr_b16 v[16:17], v2 offset:20480
ds_read_b64_tr_b16 v[18:19], v2 offset:21504
v_mfma_f32_32x32x16_bf16 v[80:95], v[36:39], v[204:207], v[80:95]
ds_read_b64_tr_b16 v[20:21], v3 offset:20480
ds_read_b64_tr_b16 v[22:23], v3 offset:21504
v_mfma_f32_32x32x16_bf16 v[96:111], v[40:43], v[204:207], v[96:111]
ds_read_b64_tr_b16 v[24:25], v4 offset:20480
ds_read_b64_tr_b16 v[26:27], v4 offset:21504
v_mfma_f32_32x32x16_bf16 v[112:127], v[44:47], v[204:207], v[112:127]
ds_read_b64_tr_b16 v[28:29], v5 offset:20480
ds_read_b64_tr_b16 v[30:31], v5 offset:21504
s_waitcnt vmcnt(12)
s_waitcnt lgkmcnt(8)
v_mfma_f32_32x32x16_bf16 v[64:79], v[48:51], v[208:211], v[64:79]
ds_read_b64_tr_b16 v[32:33], v2 offset:24576
ds_read_b64_tr_b16 v[34:35], v2 offset:25600
v_mfma_f32_32x32x16_bf16 v[80:95], v[52:55], v[208:211], v[80:95]
ds_read_b64_tr_b16 v[36:37], v3 offset:24576
ds_read_b64_tr_b16 v[38:39], v3 offset:25600
v_mfma_f32_32x32x16_bf16 v[96:111], v[56:59], v[208:211], v[96:111]
ds_read_b64_tr_b16 v[40:41], v4 offset:24576
ds_read_b64_tr_b16 v[42:43], v4 offset:25600
v_mfma_f32_32x32x16_bf16 v[112:127], v[60:63], v[208:211], v[112:127]
ds_read_b64_tr_b16 v[44:45], v5 offset:24576
ds_read_b64_tr_b16 v[46:47], v5 offset:25600
s_waitcnt lgkmcnt(8)
v_mfma_f32_32x32x16_bf16 v[64:79], v[16:19], v[212:215], v[64:79]
ds_read_b64_tr_b16 v[48:49], v2 offset:28672
ds_read_b64_tr_b16 v[50:51], v2 offset:29696
v_mfma_f32_32x32x16_bf16 v[80:95], v[20:23], v[212:215], v[80:95]
ds_read_b64_tr_b16 v[52:53], v3 offset:28672
ds_read_b64_tr_b16 v[54:55], v3 offset:29696
v_mfma_f32_32x32x16_bf16 v[96:111], v[24:27], v[212:215], v[96:111]
ds_read_b64_tr_b16 v[56:57], v4 offset:28672
ds_read_b64_tr_b16 v[58:59], v4 offset:29696
v_mfma_f32_32x32x16_bf16 v[112:127], v[28:31], v[212:215], v[112:127]
ds_read_b64_tr_b16 v[60:61], v5 offset:28672
ds_read_b64_tr_b16 v[62:63], v5 offset:29696
s_waitcnt vmcnt(0)
s_cmp_lg_u32 s12, 0
s_cbranch_scc1 L_fpoll_3d
v_and_b32 v12, 7, v14
v_lshlrev_b32 v12, 2, v12
s_lshl_b32 s54, s14, 7
s_add_u32 s54, s54, 0x3f03000
s_mov_b32 s55, 65536
L_fpoll_3:
buffer_load_dword v13, v12, s[4:7], s54 offen sc1
s_waitcnt vmcnt(0)
v_cmp_ne_u32 vcc, s96, v13
s_nop 3
s_cmp_eq_u64 vcc, 0
s_cbranch_scc1 L_fpoll_3d
s_sleep 1
s_sub_u32 s55, s55, 1
s_cbranch_scc0 L_fpoll_3
L_fpoll_3d:
s_barrier
v_xor_b32 v15, 0, v10
v_add_u32 v2, 0x20000, v15
v_xor_b32 v15, 64, v10
v_add_u32 v3, 0x20000, v15
v_xor_b32 v15, 128, v10
v_add_u32 v4, 0x20000, v15
v_xor_b32 v15, 192, v10
v_add_u32 v5, 0x20000, v15
s_waitcnt lgkmcnt(8)
v_mfma_f32_32x32x16_bf16 v[64:79], v[32:35], v[216:219], v[64:79]
ds_read_b64_tr_b16 v[16:17], v2 offset:0
ds_read_b64_tr_b16 v[18:19], v2 offset:1024
v_mfma_f32_32x32x16_bf16 v[80:95], v[36:39], v[216:219], v[80:95]
ds_read_b64_tr_b16 v[20:21], v3 offset:0
ds_read_b64_tr_b16 v[22:23], v3 offset:1024
s_lshl_b32 s22, s12, 11
s_add_u32 m0, s22, 0
s_add_u32 s21, s27, 0
buffer_load_dwordx4 v1, s[4:7], s21 offen sc1 lds
v_mfma_f32_32x32x16_bf16 v[96:111], v[40:43], v[216:219], v[96:111]
ds_read_b64_tr_b16 v[24:25], v4 offset:0
ds_read_b64_tr_b16 v[26:27], v4 offset:1024
v_mfma_f32_32x32x16_bf16 v[112:127], v[44:47], v[216:219], v[112:127]
ds_read_b64_tr_b16 v[28:29], v5 offset:0
ds_read_b64_tr_b16 v[30:31], v5 offset:1024
buffer_load_dwordx4 v1, s[4:7], s21 offen offset:1024 sc1 lds
s_waitcnt lgkmcnt(8)
v_mfma_f32_32x32x16_bf16 v[64:79], v[48:51], v[220:223], v[64:79]
ds_read_b64_tr_b16 v[32:33], v2 offset:4096
ds_read_b64_tr_b16 v[34:35], v2 offset:5120
v_mfma_f32_32x32x16_bf16 v[80:95], v[52:55], v[220:223], v[80:95]
ds_read_b64_tr_b16 v[36:37], v3 offset:4096
ds_read_b64_tr_b16 v[38:39], v3 offset:5120
s_lshl_b32 s22, s12, 11
s_add_u32 m0, s22, 16384
s_add_u32 s21, s27, 8192
buffer_load_dwordx4 v1, s[4:7], s21 offen sc1 lds
v_mfma_f32_32x32x16_bf16 v[96:111], v[56:59], v[220:223], v[96:111]
ds_read_b64_tr_b16 v[40:41], v4 offset:4096
ds_read_b64_tr_b16 v[42:43], v4 offset:5120
v_mfma_f32_32x32x16_bf16 v[112:127], v[60:63], v[220:223], v[112:127]
ds_read_b64_tr_b16 v[44:45], v5 offset:4096
ds_read_b64_tr_b16 v[46:47], v5 offset:5120
buffer_load_dwordx4 v1, s[4:7], s21 offen offset:1024 sc1 lds
s_waitcnt vmcnt(12)
s_waitcnt lgkmcnt(8)
v_mfma_f32_32x32x16_bf16 v[64:79], v[16:19], v[224:227], v[64:79]
ds_read_b64_tr_b16 v[48:49], v2 offset:8192
ds_read_b64_tr_b16 v[50:51], v2 offset:9216
v_and_b32 v13, 31, v14
v_lshrrev_b32 v12, 5, v14
v_lshlrev_b32 v12, 2, v12
v_sub_u32 v13, v13, v12
v_mfma_f32_32x32x16_bf16 v[80:95], v[20:23], v[224:227], v[80:95]
ds_read_b64_tr_b16 v[52:53], v3 offset:8192
ds_read_b64_tr_b16 v[54:55], v3 offset:9216
s_lshl_b32 s22, s12, 11
s_add_u32 m0, s22, 32768
s_add_u32 s21, s27, 32768
buffer_load_dwordx4 v1, s[4:7], s21 offen sc1 lds
v_mfma_f32_32x32x16_bf16 v[96:111], v[24:27], v[224:227], v[96:111]
ds_read_b64_tr_b16 v[56:57], v4 offset:8192
ds_read_b64_tr_b16 v[58:59], v4 offset:9216
v_mfma_f32_32x32x16_bf16 v[112:127], v[28:31], v[224:227], v[112:127]
ds_read_b64_tr_b16 v[60:61], v5 offset:8192
ds_read_b64_tr_b16 v[62:63], v5 offset:9216
buffer_load_dwordx4 v1, s[4:7], s21 offen offset:1024 sc1 lds
s_waitcnt lgkmcnt(8)
v_mfma_f32_32x32x16_bf16 v[64:79], v[32:35], v[228:231], v[64:79]
ds_read_b64_tr_b16 v[16:17], v2 offset:12288
ds_read_b64_tr_b16 v[18:19], v2 offset:13312
v_cmp_lt_i32 s[32:33], v13, 0
v_mfma_f32_32x32x16_bf16 v[80:95], v[36:39], v[228:231], v[80:95]
ds_read_b64_tr_b16 v[20:21], v3 offset:12288
ds_read_b64_tr_b16 v[22:23], v3 offset:13312
v_cmp_lt_i32 s[34:35], v13, 1
v_mfma_f32_32x32x16_bf16 v[96:111], v[40:43], v[228:231], v[96:111]
ds_read_b64_tr_b16 v[24:25], v4 offset:12288
ds_read_b64_tr_b16 v[26:27], v4 offset:13312
v_cmp_lt_i32 s[36:37], v13, 2
v_mfma_f32_32x32x16_bf16 v[112:127], v[44:47], v[228:231], v[112:127]
ds_read_b64_tr_b16 v[28:29], v5 offset:12288
ds_read_b64_tr_b16 v[30:31], v5 offset:13312
v_cmp_lt_i32 s[38:39], v13, 3
s_waitcnt lgkmcnt(8)
v_mfma_f32_32x32x16_bf16 v[64:79], v[48:51], v[232:235], v[64:79]
ds_read_b64_tr_b16 v[32:33], v2 offset:16384
ds_read_b64_tr_b16 v[34:35], v2 offset:17408
v_cmp_lt_i32 s[40:41], v13, 8
v_mfma_f32_32x32x16_bf16 v[80:95], v[52:55], v[232:235], v[80:95]
ds_read_b64_tr_b16 v[36:37], v3 offset:16384
ds_read_b64_tr_b16 v[38:39], v3 offset:17408
v_cmp_lt_i32 s[42:43], v13, 9
v_mfma_f32_32x32x16_bf16 v[96:111], v[56:59], v[232:235], v[96:111]
ds_read_b64_tr_b16 v[40:41], v4 offset:16384
ds_read_b64_tr_b16 v[42:43], v4 offset:17408
v_cmp_lt_i32 s[44:45], v13, 10
v_mfma_f32_32x32x16_bf16 v[112:127], v[60:63], v[232:235], v[112:127]
ds_read_b64_tr_b16 v[44:45], v5 offset:16384
ds_read_b64_tr_b16 v[46:47], v5 offset:17408
v_cmp_lt_i32 s[46:47], v13, 11
s_waitcnt lgkmcnt(8)
v_mfma_f32_32x32x16_bf16 v[64:79], v[16:19], v[236:239], v[64:79]
ds_read_b64_tr_b16 v[48:49], v2 offset:20480
ds_read_b64_tr_b16 v[50:51], v2 offset:21504
v_cmp_lt_i32 s[48:49], v13, 16
v_mfma_f32_32x32x16_bf16 v[80:95], v[20:23], v[236:239], v[80:95]
ds_read_b64_tr_b16 v[52:53], v3 offset:20480
ds_read_b64_tr_b16 v[54:55], v3 offset:21504
v_cmp_lt_i32 s[50:51], v13, 17
v_mfma_f32_32x32x16_bf16 v[96:111], v[24:27], v[236:239], v[96:111]
ds_read_b64_tr_b16 v[56:57], v4 offset:20480
ds_read_b64_tr_b16 v[58:59], v4 offset:21504
v_cmp_lt_i32 s[52:53], v13, 18
v_mfma_f32_32x32x16_bf16 v[112:127], v[28:31], v[236:239], v[112:127]
ds_read_b64_tr_b16 v[60:61], v5 offset:20480
ds_read_b64_tr_b16 v[62:63], v5 offset:21504
v_cmp_lt_i32 s[54:55], v13, 19
s_waitcnt vmcnt(8)
s_waitcnt lgkmcnt(8)
v_mfma_f32_32x32x16_bf16 v[64:79], v[32:35], v[240:243], v[64:79]
ds_read_b64_tr_b16 v[16:17], v2 offset:24576
ds_read_b64_tr_b16 v[18:19], v2 offset:25600
v_cmp_lt_i32 s[56:57], v13, 24
v_mfma_f32_32x32x16_bf16 v[80:95], v[36:39], v[240:243], v[80:95]
ds_read_b64_tr_b16 v[20:21], v3 offset:24576
ds_read_b64_tr_b16 v[22:23], v3 offset:25600
v_cmp_lt_i32 s[58:59], v13, 25
v_mfma_f32_32x32x16_bf16 v[96:111], v[40:43], v[240:243], v[96:111]
ds_read_b64_tr_b16 v[24:25], v4 offset:24576
ds_read_b64_tr_b16 v[26:27], v4 offset:25600
v_cmp_lt_i32 s[60:61], v13, 26
v_mfma_f32_32x32x16_bf16 v[112:127], v[44:47], v[240:243], v[112:127]
ds_read_b64_tr_b16 v[28:29], v5 offset:24576
ds_read_b64_tr_b16 v[30:31], v5 offset:25600
v_cmp_lt_i32 s[62:63], v13, 27
s_waitcnt lgkmcnt(8)
v_mfma_f32_32x32x16_bf16 v[64:79], v[48:51], v[244:247], v[64:79]
ds_read_b64_tr_b16 v[32:33], v2 offset:28672
ds_read_b64_tr_b16 v[34:35], v2 offset:29696
v_mfma_f32_32x32x16_bf16 v[80:95], v[52:55], v[244:247], v[80:95]
ds_read_b64_tr_b16 v[36:37], v3 offset:28672
ds_read_b64_tr_b16 v[38:39], v3 offset:29696
v_mfma_f32_32x32x16_bf16 v[96:111], v[56:59], v[244:247], v[96:111]
ds_read_b64_tr_b16 v[40:41], v4 offset:28672
ds_read_b64_tr_b16 v[42:43], v4 offset:29696
v_mfma_f32_32x32x16_bf16 v[112:127], v[60:63], v[244:247], v[112:127]
ds_read_b64_tr_b16 v[44:45], v5 offset:28672
ds_read_b64_tr_b16 v[46:47], v5 offset:29696
s_waitcnt lgkmcnt(8)
v_mfma_f32_32x32x16_bf16 v[64:79], v[16:19], v[248:251], v[64:79]
s_mov_b32 s26, 0x47800000
v_mfma_f32_32x32x16_bf16 v[80:95], v[20:23], v[248:251], v[80:95]
v_mfma_f32_32x32x16_bf16 v[96:111], v[24:27], v[248:251], v[96:111]
v_mfma_f32_32x32x16_bf16 v[112:127], v[28:31], v[248:251], v[112:127]
s_waitcnt lgkmcnt(0)
v_mfma_f32_32x32x16_bf16 v[64:79], v[32:35], v[252:255], v[64:79]
v_mfma_f32_32x32x16_bf16 v[80:95], v[36:39], v[252:255], v[80:95]
v_mfma_f32_32x32x16_bf16 v[96:111], v[40:43], v[252:255], v[96:111]
v_mfma_f32_32x32x16_bf16 v[112:127], v[44:47], v[252:255], v[112:127]
s_waitcnt vmcnt(0)
s_barrier
v_mov_b32 v2, v1
v_mov_b32 v3, v1
ds_read_b128 v[160:163], v2 offset:0
ds_read_b128 v[164:167], v2 offset:1024
ds_read_b128 v[168:171], v2 offset:2048
ds_read_b128 v[172:175], v2 offset:3072
ds_read_b128 v[176:179], v2 offset:4096
ds_read_b128 v[180:183], v2 offset:5120
ds_read_b128 v[184:187], v2 offset:6144
ds_read_b128 v[188:191], v2 offset:7168
s_mov_b32 s19, 0
s_cmp_eq_u32 s25, 0
s_cbranch_scc1 L_k2_nol0
s_mov_b32 m0, s24
s_min_u32 s22, s20, s30
buffer_load_dwordx4 v1, s[4:7], s22 offen sc1 lds
buffer_load_dwordx4 v1, s[4:7], s22 offen offset:1024 sc1 lds
buffer_load_dwordx4 v1, s[4:7], s22 offen offset:2048 sc1 lds
buffer_load_dwordx4 v1, s[4:7], s22 offen offset:3072 sc1 lds
s_add_u32 s21, s24, 114688
s_and_b32 m0, s21, 0x1ffff
s_add_u32 s24, s24, 32768
s_min_u32 s21, s23, s31
buffer_load_dwordx4 v1, s[4:7], s21 offen sc1 lds
buffer_load_dwordx4 v1, s[4:7], s21 offen offset:1024 sc1 lds
buffer_load_dwordx4 v1, s[4:7], s21 offen offset:2048 sc1 lds
buffer_load_dwordx4 v1, s[4:7], s21 offen offset:3072 sc1 lds
s_and_b32 s24, s24, 0x1ffff
s_add_u32 s20, s20, 32768
s_add_u32 s23, s23, 32768
s_add_u32 s19, s19, 1
s_lshl_b32 s21, s2, 2
s_add_u32 s21, s21, s13
s_mov_b32 s92, s84
s_mov_b32 s93, s85
s_mov_b32 s94, 0x400000
s_mov_b32 s22, 0
s_cmp_ge_u32 s21, 512
s_cselect_b32 s92, s88, s92
s_cselect_b32 s93, s89, s93
s_cselect_b32 s94, 0x158000, s94
s_cselect_b32 s22, 512, s22
s_cmp_ge_u32 s21, 684
s_cselect_b32 s92, s90, s92
s_cselect_b32 s93, s91, s93
s_cselect_b32 s94, 0x158000, s94
s_cselect_b32 s22, 684, s22
s_cmp_ge_u32 s21, 856
s_cselect_b32 s92, s86, s92
s_cselect_b32 s93, s87, s93
s_cselect_b32 s94, 0x158000, s94
s_cselect_b32 s22, 856, s22
s_mov_b32 s95, 0x00020000
s_sub_u32 s21, s21, s22
s_lshl_b32 s21, s21, 13
v_lshlrev_b32 v5, 3, v1
buffer_load_dword v5, v5, s[92:95], s21 offen
L_k2_nol0:
v_cvt_pk_bf16_f32 v128, v64, v65
v_cvt_pk_bf16_f32 v129, v66, v67
v_cvt_pk_bf16_f32 v130, v68, v69
v_cvt_pk_bf16_f32 v131, v70, v71
v_cvt_pk_bf16_f32 v132, v72, v73
v_cvt_pk_bf16_f32 v133, v74, v75
v_cvt_pk_bf16_f32 v134, v76, v77
v_cvt_pk_bf16_f32 v135, v78, v79
v_cvt_pk_bf16_f32 v136, v80, v81
v_cvt_pk_bf16_f32 v137, v82, v83
v_cvt_pk_bf16_f32 v138, v84, v85
v_cvt_pk_bf16_f32 v139, v86, v87
v_cvt_pk_bf16_f32 v140, v88, v89
v_cvt_pk_bf16_f32 v141, v90, v91
v_cvt_pk_bf16_f32 v142, v92, v93
v_cvt_pk_bf16_f32 v143, v94, v95
v_cvt_pk_bf16_f32 v144, v96, v97
v_cvt_pk_bf16_f32 v145, v98, v99
v_cvt_pk_bf16_f32 v146, v100, v101
v_cvt_pk_bf16_f32 v147, v102, v103
v_cvt_pk_bf16_f32 v148, v104, v105
v_cvt_pk_bf16_f32 v149, v106, v107
v_cvt_pk_bf16_f32 v150, v108, v109
v_cvt_pk_bf16_f32 v151, v110, v111
v_cvt_pk_bf16_f32 v152, v112, v113
v_cvt_pk_bf16_f32 v153, v114, v115
v_cvt_pk_bf16_f32 v154, v116, v117
v_cvt_pk_bf16_f32 v155, v118, v119
v_cvt_pk_bf16_f32 v156, v120, v121
v_cvt_pk_bf16_f32 v157, v122, v123
v_cvt_pk_bf16_f32 v158, v124, v125
v_cvt_pk_bf16_f32 v159, v126, v127
v_mov_b32 v4, 0
v_mov_b32 v8, 0xff800000
v_mov_b32 v13, 0
s_waitcnt lgkmcnt(0)
v_mfma_f32_32x32x16_bf16 v[16:31], v[160:163], v[128:131], 0
ds_read_b128 v[160:163], v2 offset:8192
v_mov_b32 v64, 0
v_mov_b32 v65, 0
v_mov_b32 v66, 0
v_mov_b32 v67, 0
v_mov_b32 v68, 0
v_mov_b32 v69, 0
v_mov_b32 v70, 0
v_mov_b32 v71, 0
v_mfma_f32_32x32x16_bf16 v[16:31], v[164:167], v[132:135], v[16:31]
ds_read_b128 v[164:167], v2 offset:9216
v_mov_b32 v72, 0
v_mov_b32 v73, 0
v_mov_b32 v74, 0
v_mov_b32 v75, 0
v_mov_b32 v76, 0
v_mov_b32 v77, 0
v_mov_b32 v78, 0
v_mov_b32 v79, 0
v_mfma_f32_32x32x16_bf16 v[16:31], v[168:171], v[136:139], v[16:31]
ds_read_b128 v[168:171], v2 offset:10240
v_mov_b32 v80, 0
v_mov_b32 v81, 0
v_mov_b32 v82, 0
v_mov_b32 v83, 0
v_mov_b32 v84, 0
v_mov_b32 v85, 0
v_mov_b32 v86, 0
v_mov_b32 v87, 0
v_mfma_f32_32x32x16_bf16 v[16:31], v[172:175], v[140:143], v[16:31]
ds_read_b128 v[172:175], v2 offset:11264
v_mov_b32 v88, 0
v_mov_b32 v89, 0
v_mov_b32 v90, 0
v_mov_b32 v91, 0
v_mov_b32 v92, 0
v_mov_b32 v93, 0
v_mov_b32 v94, 0
v_mov_b32 v95, 0
v_mfma_f32_32x32x16_bf16 v[16:31], v[176:179], v[144:147], v[16:31]
ds_read_b128 v[176:179], v2 offset:12288
v_mov_b32 v96, 0
v_mov_b32 v97, 0
v_mov_b32 v98, 0
v_mov_b32 v99, 0
v_mov_b32 v100, 0
v_mov_b32 v101, 0
v_mov_b32 v102, 0
v_mov_b32 v103, 0
v_mfma_f32_32x32x16_bf16 v[16:31], v[180:183], v[148:151], v[16:31]
ds_read_b128 v[180:183], v2 offset:13312
v_mov_b32 v104, 0
v_mov_b32 v105, 0
v_mov_b32 v106, 0
v_mov_b32 v107, 0
v_mov_b32 v108, 0
v_mov_b32 v109, 0
v_mov_b32 v110, 0
v_mov_b32 v111, 0
v_mfma_f32_32x32x16_bf16 v[16:31], v[184:187], v[152:155], v[16:31]
ds_read_b128 v[184:187], v2 offset:14336
v_mov_b32 v112, 0
v_mov_b32 v113, 0
v_mov_b32 v114, 0
v_mov_b32 v115, 0
v_mov_b32 v116, 0
v_mov_b32 v117, 0
v_mov_b32 v118, 0
v_mov_b32 v119, 0
v_mfma_f32_32x32x16_bf16 v[16:31], v[188:191], v[156:159], v[16:31]
ds_read_b128 v[188:191], v2 offset:15360
v_mov_b32 v120, 0
v_mov_b32 v121, 0
v_mov_b32 v122, 0
v_mov_b32 v123, 0
v_mov_b32 v124, 0
v_mov_b32 v125, 0
v_mov_b32 v126, 0
v_mov_b32 v127, 0
s_nop 3
s_cmp_lg_u32 s16, 0
s_cbranch_scc1 L_k2_nomask0
v_cndmask_b32 v16, v16, v8, s[32:33]
v_cndmask_b32 v17, v17, v8, s[34:35]
v_cndmask_b32 v18, v18, v8, s[36:37]
v_cndmask_b32 v19, v19, v8, s[38:39]
v_cndmask_b32 v20, v20, v8, s[40:41]
v_cndmask_b32 v21, v21, v8, s[42:43]
v_cndmask_b32 v22, v22, v8, s[44:45]
v_cndmask_b32 v23, v23, v8, s[46:47]
v_cndmask_b32 v24, v24, v8, s[48:49]
v_cndmask_b32 v25, v25, v8, s[50:51]
v_cndmask_b32 v26, v26, v8, s[52:53]
v_cndmask_b32 v27, v27, v8, s[54:55]
v_cndmask_b32 v28, v28, v8, s[56:57]
v_cndmask_b32 v29, v29, v8, s[58:59]
v_cndmask_b32 v30, v30, v8, s[60:61]
v_cndmask_b32 v31, v31, v8, s[62:63]
L_k2_nomask0:
v_max3_f32 v6, v16, v17, v18
v_max3_f32 v6, v6, v19, v20
v_max3_f32 v6, v6, v21, v22
v_max3_f32 v6, v6, v23, v24
v_max3_f32 v6, v6, v25, v26
v_max3_f32 v6, v6, v27, v28
v_max3_f32 v6, v6, v29, v30
v_max_f32 v6, v6, v31
v_mov_b32 v7, v6
s_nop 1
v_permlane32_swap_b32 v6, v7
s_nop 1
v_max_f32 v6, v6, v7
v_sub_f32 v16, v16, v6
v_sub_f32 v17, v17, v6
v_sub_f32 v18, v18, v6
v_sub_f32 v19, v19, v6
v_sub_f32 v20, v20, v6
v_sub_f32 v21, v21, v6
v_sub_f32 v22, v22, v6
v_sub_f32 v23, v23, v6
v_sub_f32 v24, v24, v6
v_sub_f32 v25, v25, v6
v_sub_f32 v26, v26, v6
v_sub_f32 v27, v27, v6
v_sub_f32 v28, v28, v6
v_sub_f32 v29, v29, v6
v_sub_f32 v30, v30, v6
v_sub_f32 v31, v31, v6
v_sub_f32 v48, 0, v6
v_sub_f32 v49, 0, v6
v_sub_f32 v50, 0, v6
v_sub_f32 v51, 0, v6
v_sub_f32 v52, 0, v6
v_sub_f32 v53, 0, v6
v_sub_f32 v54, 0, v6
v_sub_f32 v55, 0, v6
v_sub_f32 v56, 0, v6
v_sub_f32 v57, 0, v6
v_sub_f32 v58, 0, v6
v_sub_f32 v59, 0, v6
v_sub_f32 v60, 0, v6
v_sub_f32 v61, 0, v6
v_sub_f32 v62, 0, v6
v_sub_f32 v63, 0, v6
s_sub_u32 s17, s16, 1
s_cmp_eq_u32 s25, 0
s_cbranch_scc0 L_grp_short
s_cmp_eq_u32 s16, 0
s_cbranch_scc1 L_last0_L
s_waitcnt lgkmcnt(4)
v_mfma_f32_32x32x16_bf16 v[32:47], v[160:163], v[128:131], v[48:63]
v_exp_f32 v208, v16
v_exp_f32 v209, v17
v_exp_f32 v210, v18
v_mfma_f32_32x32x16_bf16 v[32:47], v[164:167], v[132:135], v[32:47]
v_add_f32 v9, v208, v210
v_exp_f32 v211, v19
v_exp_f32 v212, v20
v_add_f32 v11, v209, v211
v_mfma_f32_32x32x16_bf16 v[32:47], v[168:171], v[136:139], v[32:47]
v_add_f32 v9, v9, v212
v_exp_f32 v213, v21
v_exp_f32 v214, v22
v_add_f32 v11, v11, v213
v_mfma_f32_32x32x16_bf16 v[32:47], v[172:175], v[140:143], v[32:47]
v_add_f32 v9, v9, v214
v_exp_f32 v215, v23
v_cvt_pk_bf16_f32 v192, v208, v209
v_add_f32 v11, v11, v215
s_waitcnt lgkmcnt(0)
v_mfma_f32_32x32x16_bf16 v[32:47], v[176:179], v[144:147], v[32:47]
v_exp_f32 v208, v24
v_exp_f32 v209, v25
v_add_f32 v9, v9, v208
v_add_f32 v11, v11, v209
v_mfma_f32_32x32x16_bf16 v[32:47], v[180:183], v[148:151], v[32:47]
v_cvt_pk_bf16_f32 v193, v210, v211
v_exp_f32 v210, v26
v_exp_f32 v211, v27
v_add_f32 v9, v9, v210
v_mfma_f32_32x32x16_bf16 v[32:47], v[184:187], v[152:155], v[32:47]
v_add_f32 v11, v11, v211
v_cvt_pk_bf16_f32 v194, v212, v213
v_exp_f32 v212, v28
v_exp_f32 v213, v29
v_add_f32 v4, v4, v13
v_mfma_f32_32x32x16_bf16 v[32:47], v[188:191], v[156:159], v[32:47]
v_mov_b32 v3, v2
v_add_u32 v2, 32768, v2
v_and_b32 v2, 0x1ffff, v2
s_barrier
ds_read_b128 v[160:163], v2 offset:0
v_add_f32 v9, v9, v212
v_add_f32 v11, v11, v213
v_cvt_pk_bf16_f32 v195, v214, v215
v_exp_f32 v214, v30
v_exp_f32 v215, v31
v_add_f32 v9, v9, v214
v_add_f32 v11, v11, v215
v_add_f32 v13, v9, v11
ds_read_b128 v[164:167], v2 offset:1024
v_cmp_nge_f32 vcc, s26, v13
v_cvt_pk_bf16_f32 v196, v208, v209
v_cvt_pk_bf16_f32 v197, v210, v211
v_cvt_pk_bf16_f32 v198, v212, v213
v_cvt_pk_bf16_f32 v199, v214, v215
ds_read_b128 v[168:171], v2 offset:2048
ds_read_b128 v[172:175], v2 offset:3072
ds_read_b128 v[176:179], v2 offset:4096
ds_read_b128 v[180:183], v2 offset:5120
ds_read_b128 v[184:187], v2 offset:6144
ds_read_b128 v[188:191], v2 offset:7168
s_cbranch_vccnz L_slow_fL
L_back_fL:
s_sub_u32 s17, s17, 1
s_cbranch_scc1 L_last1_L
.p2align 6
L_loop_L:
s_waitcnt lgkmcnt(4)
v_mfma_f32_32x32x16_bf16 v[16:31], v[160:163], v[128:131], v[48:63]
ds_read_b128 v[160:163], v3 offset:16384
v_exp_f32 v208, v32
v_exp_f32 v209, v33
v_mfma_f32_32x32x16_bf16 v[16:31], v[164:167], v[132:135], v[16:31]
ds_read_b128 v[164:167], v3 offset:17408
v_exp_f32 v210, v34
v_exp_f32 v211, v35
v_add_f32 v10, v208, v210
v_mfma_f32_32x32x16_bf16 v[16:31], v[168:171], v[136:139], v[16:31]
ds_read_b128 v[168:171], v3 offset:18432
v_add_f32 v12, v209, v211
v_exp_f32 v212, v36
v_cvt_pk_bf16_f32 v200, v208, v209
v_mfma_f32_32x32x16_bf16 v[16:31], v[172:175], v[140:143], v[16:31]
ds_read_b128 v[172:175], v3 offset:19456
v_add_f32 v10, v10, v212
v_exp_f32 v213, v37
s_waitcnt lgkmcnt(4)
v_mfma_f32_32x32x16_bf16 v[16:31], v[176:179], v[144:147], v[16:31]
ds_read_b128 v[176:179], v3 offset:20480
v_add_f32 v12, v12, v213
v_exp_f32 v214, v38
v_cvt_pk_bf16_f32 v201, v210, v211
v_mfma_f32_32x32x16_bf16 v[16:31], v[180:183], v[148:151], v[16:31]
ds_read_b128 v[180:183], v3 offset:21504
v_add_f32 v10, v10, v214
v_exp_f32 v215, v39
v_exp_f32 v208, v40
v_mfma_f32_32x32x16_bf16 v[16:31], v[184:187], v[152:155], v[16:31]
ds_read_b128 v[184:187], v3 offset:22528
v_add_f32 v12, v12, v215
v_add_f32 v10, v10, v208
v_exp_f32 v209, v41
v_add_f32 v4, v4, v13
v_mfma_f32_32x32x16_bf16 v[16:31], v[188:191], v[156:159], v[16:31]
ds_read_b128 v[188:191], v3 offset:23552
v_add_f32 v12, v12, v209
v_exp_f32 v210, v42
s_waitcnt lgkmcnt(4)
v_mfma_f32_32x32x16_bf16 v[64:79], v[160:163], v[192:195], v[64:79]
ds_read_b128 v[160:163], v2 offset:8192
v_add_f32 v10, v10, v210
v_exp_f32 v211, v43
v_cvt_pk_bf16_f32 v202, v212, v213
v_mfma_f32_32x32x16_bf16 v[80:95], v[164:167], v[192:195], v[80:95]
ds_read_b128 v[164:167], v2 offset:9216
v_add_f32 v12, v12, v211
v_exp_f32 v212, v44
v_exp_f32 v213, v45
v_mfma_f32_32x32x16_bf16 v[96:111], v[168:171], v[192:195], v[96:111]
ds_read_b128 v[168:171], v2 offset:10240
v_add_f32 v10, v10, v212
v_add_f32 v12, v12, v213
v_cvt_pk_bf16_f32 v203, v214, v215
v_cvt_pk_bf16_f32 v204, v208, v209
v_mfma_f32_32x32x16_bf16 v[112:127], v[172:175], v[192:195], v[112:127]
ds_read_b128 v[172:175], v2 offset:11264
v_exp_f32 v214, v46
v_cvt_pk_bf16_f32 v205, v210, v211
s_waitcnt lgkmcnt(4)
v_mfma_f32_32x32x16_bf16 v[64:79], v[176:179], v[196:199], v[64:79]
ds_read_b128 v[176:179], v2 offset:12288
v_add_f32 v10, v10, v214
v_exp_f32 v215, v47
v_cvt_pk_bf16_f32 v206, v212, v213
v_mfma_f32_32x32x16_bf16 v[80:95], v[180:183], v[196:199], v[80:95]
ds_read_b128 v[180:183], v2 offset:13312
v_add_f32 v12, v12, v215
v_add_f32 v13, v10, v12
v_cmp_nge_f32 vcc, s26, v13
v_cvt_pk_bf16_f32 v207, v214, v215
v_mfma_f32_32x32x16_bf16 v[96:111], v[184:187], v[196:199], v[96:111]
ds_read_b128 v[184:187], v2 offset:14336
v_mfma_f32_32x32x16_bf16 v[112:127], v[188:191], v[196:199], v[112:127]
ds_read_b128 v[188:191], v2 offset:15360
s_cbranch_vccnz L_slow_oL
L_back_oL:
s_sub_u32 s17, s17, 1
s_cbranch_scc1 L_last0_L
s_waitcnt lgkmcnt(4)
v_mfma_f32_32x32x16_bf16 v[32:47], v[160:163], v[128:131], v[48:63]
ds_read_b128 v[160:163], v3 offset:24576
v_exp_f32 v208, v16
v_exp_f32 v209, v17
v_mfma_f32_32x32x16_bf16 v[32:47], v[164:167], v[132:135], v[32:47]
ds_read_b128 v[164:167], v3 offset:25600
v_exp_f32 v210, v18
v_exp_f32 v211, v19
v_add_f32 v9, v208, v210
v_mfma_f32_32x32x16_bf16 v[32:47], v[168:171], v[136:139], v[32:47]
ds_read_b128 v[168:171], v3 offset:26624
v_add_f32 v11, v209, v211
v_exp_f32 v212, v20
v_cvt_pk_bf16_f32 v192, v208, v209
v_mfma_f32_32x32x16_bf16 v[32:47], v[172:175], v[140:143], v[32:47]
ds_read_b128 v[172:175], v3 offset:27648
v_add_f32 v9, v9, v212
v_exp_f32 v213, v21
s_waitcnt lgkmcnt(4)
v_mfma_f32_32x32x16_bf16 v[32:47], v[176:179], v[144:147], v[32:47]
ds_read_b128 v[176:179], v3 offset:28672
v_add_f32 v11, v11, v213
v_exp_f32 v214, v22
v_cvt_pk_bf16_f32 v193, v210, v211
v_mfma_f32_32x32x16_bf16 v[32:47], v[180:183], v[148:151], v[32:47]
ds_read_b128 v[180:183], v3 offset:29696
v_add_f32 v9, v9, v214
v_exp_f32 v215, v23
v_exp_f32 v208, v24
v_mfma_f32_32x32x16_bf16 v[32:47], v[184:187], v[152:155], v[32:47]
ds_read_b128 v[184:187], v3 offset:30720
v_add_f32 v11, v11, v215
v_add_f32 v9, v9, v208
v_exp_f32 v209, v25
v_add_f32 v4, v4, v13
v_mfma_f32_32x32x16_bf16 v[32:47], v[188:191], v[156:159], v[32:47]
ds_read_b128 v[188:191], v3 offset:31744
v_mov_b32 v3, v2
v_add_u32 v2, 32768, v2
v_and_b32 v2, 0x1ffff, v2
s_waitcnt lgkmcnt(4)
s_barrier
v_mfma_f32_32x32x16_bf16 v[64:79], v[160:163], v[200:203], v[64:79]
ds_read_b128 v[160:163], v2 offset:0
v_add_f32 v11, v11, v209
v_exp_f32 v210, v26
v_cvt_pk_bf16_f32 v194, v212, v213
v_mfma_f32_32x32x16_bf16 v[80:95], v[164:167], v[200:203], v[80:95]
ds_read_b128 v[164:167], v2 offset:1024
v_add_f32 v9, v9, v210
v_exp_f32 v211, v27
v_exp_f32 v212, v28
v_mfma_f32_32x32x16_bf16 v[96:111], v[168:171], v[200:203], v[96:111]
ds_read_b128 v[168:171], v2 offset:2048
v_add_f32 v11, v11, v211
v_add_f32 v9, v9, v212
v_exp_f32 v213, v29
v_mfma_f32_32x32x16_bf16 v[112:127], v[172:175], v[200:203], v[112:127]
ds_read_b128 v[172:175], v2 offset:3072
v_add_f32 v11, v11, v213
v_cvt_pk_bf16_f32 v195, v214, v215
v_cvt_pk_bf16_f32 v196, v208, v209
s_waitcnt lgkmcnt(4)
v_mfma_f32_32x32x16_bf16 v[64:79], v[176:179], v[204:207], v[64:79]
ds_read_b128 v[176:179], v2 offset:4096
v_exp_f32 v214, v30
v_exp_f32 v215, v31
v_mfma_f32_32x32x16_bf16 v[80:95], v[180:183], v[204:207], v[80:95]
ds_read_b128 v[180:183], v2 offset:5120
v_add_f32 v9, v9, v214
v_add_f32 v11, v11, v215
v_add_f32 v13, v9, v11
v_cmp_nge_f32 vcc, s26, v13
v_cvt_pk_bf16_f32 v197, v210, v211
v_mfma_f32_32x32x16_bf16 v[96:111], v[184:187], v[204:207], v[96:111]
ds_read_b128 v[184:187], v2 offset:6144
v_cvt_pk_bf16_f32 v198, v212, v213
v_cvt_pk_bf16_f32 v199, v214, v215
v_mfma_f32_32x32x16_bf16 v[112:127], v[188:191], v[204:207], v[112:127]
ds_read_b128 v[188:191], v2 offset:7168
s_cbranch_vccnz L_slow_eL
L_back_eL:
s_sub_u32 s17, s17, 1
s_cbranch_scc0 L_loop_L
L_last1_L:
v_cndmask_b32 v32, v32, v8, s[32:33]
v_cndmask_b32 v33, v33, v8, s[34:35]
v_cndmask_b32 v34, v34, v8, s[36:37]
v_cndmask_b32 v35, v35, v8, s[38:39]
v_cndmask_b32 v36, v36, v8, s[40:41]
v_cndmask_b32 v37, v37, v8, s[42:43]
v_cndmask_b32 v38, v38, v8, s[44:45]
v_cndmask_b32 v39, v39, v8, s[46:47]
v_cndmask_b32 v40, v40, v8, s[48:49]
v_cndmask_b32 v41, v41, v8, s[50:51]
v_cndmask_b32 v42, v42, v8, s[52:53]
v_cndmask_b32 v43, v43, v8, s[54:55]
v_cndmask_b32 v44, v44, v8, s[56:57]
v_cndmask_b32 v45, v45, v8, s[58:59]
v_cndmask_b32 v46, v46, v8, s[60:61]
v_cndmask_b32 v47, v47, v8, s[62:63]
ds_read_b128 v[160:163], v3 offset:16384
ds_read_b128 v[164:167], v3 offset:17408
ds_read_b128 v[168:171], v3 offset:18432
ds_read_b128 v[172:175], v3 offset:19456
ds_read_b128 v[176:179], v3 offset:20480
ds_read_b128 v[180:183], v3 offset:21504
ds_read_b128 v[184:187], v3 offset:22528
ds_read_b128 v[188:191], v3 offset:23552
s_waitcnt lgkmcnt(4)
v_mfma_f32_32x32x16_bf16 v[64:79], v[160:163], v[192:195], v[64:79]
ds_read_b128 v[160:163], v3 offset:24576
v_exp_f32 v208, v32
v_exp_f32 v209, v33
v_exp_f32 v210, v34
v_cvt_pk_bf16_f32 v200, v208, v209
v_mfma_f32_32x32x16_bf16 v[80:95], v[164:167], v[192:195], v[80:95]
ds_read_b128 v[164:167], v3 offset:25600
v_add_f32 v10, v208, v210
v_exp_f32 v211, v35
v_exp_f32 v212, v36
v_add_f32 v12, v209, v211
v_add_f32 v10, v10, v212
v_mfma_f32_32x32x16_bf16 v[96:111], v[168:171], v[192:195], v[96:111]
ds_read_b128 v[168:171], v3 offset:26624
v_exp_f32 v213, v37
v_exp_f32 v214, v38
v_add_f32 v12, v12, v213
v_add_f32 v10, v10, v214
v_cvt_pk_bf16_f32 v201, v210, v211
v_mfma_f32_32x32x16_bf16 v[112:127], v[172:175], v[192:195], v[112:127]
ds_read_b128 v[172:175], v3 offset:27648
v_exp_f32 v215, v39
v_exp_f32 v208, v40
v_add_f32 v12, v12, v215
v_add_f32 v10, v10, v208
v_cvt_pk_bf16_f32 v202, v212, v213
s_waitcnt lgkmcnt(4)
v_mfma_f32_32x32x16_bf16 v[64:79], v[176:179], v[196:199], v[64:79]
ds_read_b128 v[176:179], v3 offset:28672
v_exp_f32 v209, v41
v_exp_f32 v210, v42
v_add_f32 v12, v12, v209
v_add_f32 v10, v10, v210
v_cvt_pk_bf16_f32 v203, v214, v215
v_mfma_f32_32x32x16_bf16 v[80:95], v[180:183], v[196:199], v[80:95]
ds_read_b128 v[180:183], v3 offset:29696
v_exp_f32 v211, v43
v_exp_f32 v212, v44
v_add_f32 v12, v12, v211
v_add_f32 v10, v10, v212
v_cvt_pk_bf16_f32 v204, v208, v209
v_mfma_f32_32x32x16_bf16 v[96:111], v[184:187], v[196:199], v[96:111]
ds_read_b128 v[184:187], v3 offset:30720
v_exp_f32 v213, v45
v_exp_f32 v214, v46
v_add_f32 v12, v12, v213
v_add_f32 v10, v10, v214
v_cvt_pk_bf16_f32 v205, v210, v211
v_add_f32 v4, v4, v13
v_mfma_f32_32x32x16_bf16 v[112:127], v[188:191], v[196:199], v[112:127]
ds_read_b128 v[188:191], v3 offset:31744
v_exp_f32 v215, v47
v_cvt_pk_bf16_f32 v206, v212, v213
v_add_f32 v12, v12, v215
v_add_f32 v13, v10, v12
v_cmp_nge_f32 vcc, s26, v13
v_cvt_pk_bf16_f32 v207, v214, v215
s_cbranch_vccnz L_slow_l1L
L_back_l1L:
v_add_f32 v4, v4, v13
s_waitcnt lgkmcnt(4)
v_mfma_f32_32x32x16_bf16 v[64:79], v[160:163], v[200:203], v[64:79]
v_mfma_f32_32x32x16_bf16 v[80:95], v[164:167], v[200:203], v[80:95]
v_mfma_f32_32x32x16_bf16 v[96:111], v[168:171], v[200:203], v[96:111]
v_mfma_f32_32x32x16_bf16 v[112:127], v[172:175], v[200:203], v[112:127]
s_waitcnt lgkmcnt(0)
v_mfma_f32_32x32x16_bf16 v[64:79], v[176:179], v[204:207], v[64:79]
v_mfma_f32_32x32x16_bf16 v[80:95], v[180:183], v[204:207], v[80:95]
v_mfma_f32_32x32x16_bf16 v[96:111], v[184:187], v[204:207], v[96:111]
v_mfma_f32_32x32x16_bf16 v[112:127], v[188:191], v[204:207], v[112:127]
s_branch L_epi_L
L_last0_L:
s_cmp_eq_u32 s16, 0
s_cbranch_scc1 L_only_l0L
v_cndmask_b32 v16, v16, v8, s[32:33]
v_cndmask_b32 v17, v17, v8, s[34:35]
v_cndmask_b32 v18, v18, v8, s[36:37]
v_cndmask_b32 v19, v19, v8, s[38:39]
v_cndmask_b32 v20, v20, v8, s[40:41]
v_cndmask_b32 v21, v21, v8, s[42:43]
v_cndmask_b32 v22, v22, v8, s[44:45]
v_cndmask_b32 v23, v23, v8, s[46:47]
v_cndmask_b32 v24, v24, v8, s[48:49]
v_cndmask_b32 v25, v25, v8, s[50:51]
v_cndmask_b32 v26, v26, v8, s[52:53]
v_cndmask_b32 v27, v27, v8, s[54:55]
v_cndmask_b32 v28, v28, v8, s[56:57]
v_cndmask_b32 v29, v29, v8, s[58:59]
v_cndmask_b32 v30, v30, v8, s[60:61]
v_cndmask_b32 v31, v31, v8, s[62:63]
ds_read_b128 v[160:163], v3 offset:24576
ds_read_b128 v[164:167], v3 offset:25600
ds_read_b128 v[168:171], v3 offset:26624
ds_read_b128 v[172:175], v3 offset:27648
ds_read_b128 v[176:179], v3 offset:28672
ds_read_b128 v[180:183], v3 offset:29696
ds_read_b128 v[184:187], v3 offset:30720
ds_read_b128 v[188:191], v3 offset:31744
s_barrier
s_waitcnt lgkmcnt(4)
v_mfma_f32_32x32x16_bf16 v[64:79], v[160:163], v[200:203], v[64:79]
ds_read_b128 v[160:163], v2 offset:16384
v_exp_f32 v208, v16
v_exp_f32 v209, v17
v_exp_f32 v210, v18
v_cvt_pk_bf16_f32 v192, v208, v209
v_mfma_f32_32x32x16_bf16 v[80:95], v[164:167], v[200:203], v[80:95]
ds_read_b128 v[164:167], v2 offset:17408
v_add_f32 v9, v208, v210
v_exp_f32 v211, v19
v_exp_f32 v212, v20
v_add_f32 v11, v209, v211
v_add_f32 v9, v9, v212
v_mfma_f32_32x32x16_bf16 v[96:111], v[168:171], v[200:203], v[96:111]
ds_read_b128 v[168:171], v2 offset:18432
v_exp_f32 v213, v21
v_exp_f32 v214, v22
v_add_f32 v11, v11, v213
v_add_f32 v9, v9, v214
v_cvt_pk_bf16_f32 v193, v210, v211
v_mfma_f32_32x32x16_bf16 v[112:127], v[172:175], v[200:203], v[112:127]
ds_read_b128 v[172:175], v2 offset:19456
v_exp_f32 v215, v23
v_exp_f32 v208, v24
v_add_f32 v11, v11, v215
v_add_f32 v9, v9, v208
v_cvt_pk_bf16_f32 v194, v212, v213
s_waitcnt lgkmcnt(4)
v_mfma_f32_32x32x16_bf16 v[64:79], v[176:179], v[204:207], v[64:79]
ds_read_b128 v[176:179], v2 offset:20480
v_exp_f32 v209, v25
v_exp_f32 v210, v26
v_add_f32 v11, v11, v209
v_add_f32 v9, v9, v210
v_cvt_pk_bf16_f32 v195, v214, v215
v_mfma_f32_32x32x16_bf16 v[80:95], v[180:183], v[204:207], v[80:95]
ds_read_b128 v[180:183], v2 offset:21504
v_exp_f32 v211, v27
v_exp_f32 v212, v28
v_add_f32 v11, v11, v211
v_add_f32 v9, v9, v212
v_cvt_pk_bf16_f32 v196, v208, v209
v_mfma_f32_32x32x16_bf16 v[96:111], v[184:187], v[204:207], v[96:111]
ds_read_b128 v[184:187], v2 offset:22528
v_exp_f32 v213, v29
v_exp_f32 v214, v30
v_add_f32 v11, v11, v213
v_add_f32 v9, v9, v214
v_cvt_pk_bf16_f32 v197, v210, v211
v_add_f32 v4, v4, v13
v_mfma_f32_32x32x16_bf16 v[112:127], v[188:191], v[204:207], v[112:127]
ds_read_b128 v[188:191], v2 offset:23552
v_exp_f32 v215, v31
v_cvt_pk_bf16_f32 v198, v212, v213
v_add_f32 v11, v11, v215
v_add_f32 v13, v9, v11
v_cmp_nge_f32 vcc, s26, v13
v_cvt_pk_bf16_f32 v199, v214, v215
s_branch L_fin_l0L
L_only_l0L:
s_barrier
ds_read_b128 v[160:163], v2 offset:16384
ds_read_b128 v[164:167], v2 offset:17408
ds_read_b128 v[168:171], v2 offset:18432
ds_read_b128 v[172:175], v2 offset:19456
ds_read_b128 v[176:179], v2 offset:20480
ds_read_b128 v[180:183], v2 offset:21504
ds_read_b128 v[184:187], v2 offset:22528
ds_read_b128 v[188:191], v2 offset:23552
v_exp_f32 v208, v16
v_exp_f32 v209, v17
v_exp_f32 v210, v18
v_exp_f32 v211, v19
v_add_f32 v9, v208, v210
v_add_f32 v11, v209, v211
v_exp_f32 v212, v20
v_exp_f32 v213, v21
v_add_f32 v9, v9, v212
v_add_f32 v11, v11, v213
v_exp_f32 v214, v22
v_exp_f32 v215, v23
v_add_f32 v9, v9, v214
v_add_f32 v11, v11, v215
v_cvt_pk_bf16_f32 v192, v208, v209
v_exp_f32 v208, v24
v_exp_f32 v209, v25
v_add_f32 v9, v9, v208
v_add_f32 v11, v11, v209
v_cvt_pk_bf16_f32 v193, v210, v211
v_exp_f32 v210, v26
v_exp_f32 v211, v27
v_add_f32 v9, v9, v210
v_add_f32 v11, v11, v211
v_cvt_pk_bf16_f32 v194, v212, v213
v_exp_f32 v212, v28
v_exp_f32 v213, v29
v_add_f32 v9, v9, v212
v_add_f32 v11, v11, v213
v_cvt_pk_bf16_f32 v195, v214, v215
v_exp_f32 v214, v30
v_exp_f32 v215, v31
v_add_f32 v9, v9, v214
v_add_f32 v11, v11, v215
v_cvt_pk_bf16_f32 v196, v208, v209
v_cvt_pk_bf16_f32 v197, v210, v211
v_cvt_pk_bf16_f32 v198, v212, v213
v_cvt_pk_bf16_f32 v199, v214, v215
v_add_f32 v4, v4, v13
v_add_f32 v13, v9, v11
v_cmp_nge_f32 vcc, s26, v13
L_fin_l0L:
s_cbranch_vccnz L_slow_l0L
L_back_l0L:
v_add_f32 v4, v4, v13
s_waitcnt lgkmcnt(4)
v_mfma_f32_32x32x16_bf16 v[64:79], v[160:163], v[192:195], v[64:79]
v_mfma_f32_32x32x16_bf16 v[80:95], v[164:167], v[192:195], v[80:95]
v_mfma_f32_32x32x16_bf16 v[96:111], v[168:171], v[192:195], v[96:111]
v_mfma_f32_32x32x16_bf16 v[112:127], v[172:175], v[192:195], v[112:127]
s_waitcnt lgkmcnt(0)
v_mfma_f32_32x32x16_bf16 v[64:79], v[176:179], v[196:199], v[64:79]
v_mfma_f32_32x32x16_bf16 v[80:95], v[180:183], v[196:199], v[80:95]
v_mfma_f32_32x32x16_bf16 v[96:111], v[184:187], v[196:199], v[96:111]
v_mfma_f32_32x32x16_bf16 v[112:127], v[188:191], v[196:199], v[112:127]
L_epi_L:
s_cmp_ge_u32 s13, 2
s_cbranch_scc1 L_epi_nb
s_barrier
L_epi_nb:
v_mov_b32 v7, v4
s_nop 1
v_permlane32_swap_b32 v4, v7
s_nop 1
v_add_f32 v4, v4, v7
v_rcp_f32 v4, v4
s_nop 7
s_nop 3
v_mul_f32 v64, v64, v4
v_mul_f32 v65, v65, v4
v_mul_f32 v66, v66, v4
v_mul_f32 v67, v67, v4
v_mul_f32 v68, v68, v4
v_mul_f32 v69, v69, v4
v_mul_f32 v70, v70, v4
v_mul_f32 v71, v71, v4
v_mul_f32 v72, v72, v4
v_mul_f32 v73, v73, v4
v_mul_f32 v74, v74, v4
v_mul_f32 v75, v75, v4
v_mul_f32 v76, v76, v4
v_mul_f32 v77, v77, v4
v_mul_f32 v78, v78, v4
v_mul_f32 v79, v79, v4
v_cvt_pk_bf16_f32 v208, v64, v65
v_cvt_pk_bf16_f32 v209, v66, v67
v_cvt_pk_bf16_f32 v210, v68, v69
v_cvt_pk_bf16_f32 v211, v70, v71
buffer_store_dwordx4 v[208:211], v1, s[4:7], s28 offen sc1
v_cvt_pk_bf16_f32 v212, v72, v73
v_cvt_pk_bf16_f32 v213, v74, v75
v_cvt_pk_bf16_f32 v214, v76, v77
v_cvt_pk_bf16_f32 v215, v78, v79
buffer_store_dwordx4 v[212:215], v1, s[4:7], s28 offen offset:1024 sc1
v_mul_f32 v80, v80, v4
v_mul_f32 v81, v81, v4
v_mul_f32 v82, v82, v4
v_mul_f32 v83, v83, v4
v_mul_f32 v84, v84, v4
v_mul_f32 v85, v85, v4
v_mul_f32 v86, v86, v4
v_mul_f32 v87, v87, v4
v_mul_f32 v88, v88, v4
v_mul_f32 v89, v89, v4
v_mul_f32 v90, v90, v4
v_mul_f32 v91, v91, v4
v_mul_f32 v92, v92, v4
v_mul_f32 v93, v93, v4
v_mul_f32 v94, v94, v4
v_mul_f32 v95, v95, v4
v_cvt_pk_bf16_f32 v216, v80, v81
v_cvt_pk_bf16_f32 v217, v82, v83
v_cvt_pk_bf16_f32 v218, v84, v85
v_cvt_pk_bf16_f32 v219, v86, v87
buffer_store_dwordx4 v[216:219], v1, s[4:7], s28 offen offset:2048 sc1
v_cvt_pk_bf16_f32 v220, v88, v89
v_cvt_pk_bf16_f32 v221, v90, v91
v_cvt_pk_bf16_f32 v222, v92, v93
v_cvt_pk_bf16_f32 v223, v94, v95
buffer_store_dwordx4 v[220:223], v1, s[4:7], s28 offen offset:3072 sc1
v_mul_f32 v96, v96, v4
v_mul_f32 v97, v97, v4
v_mul_f32 v98, v98, v4
v_mul_f32 v99, v99, v4
v_mul_f32 v100, v100, v4
v_mul_f32 v101, v101, v4
v_mul_f32 v102, v102, v4
v_mul_f32 v103, v103, v4
v_mul_f32 v104, v104, v4
v_mul_f32 v105, v105, v4
v_mul_f32 v106, v106, v4
v_mul_f32 v107, v107, v4
v_mul_f32 v108, v108, v4
v_mul_f32 v109, v109, v4
v_mul_f32 v110, v110, v4
v_mul_f32 v111, v111, v4
v_cvt_pk_bf16_f32 v16, v96, v97
v_cvt_pk_bf16_f32 v17, v98, v99
v_cvt_pk_bf16_f32 v18, v100, v101
v_cvt_pk_bf16_f32 v19, v102, v103
s_add_u32 s28, s28, 4096
buffer_store_dwordx4 v[16:19], v1, s[4:7], s28 offen sc1
v_cvt_pk_bf16_f32 v20, v104, v105
v_cvt_pk_bf16_f32 v21, v106, v107
v_cvt_pk_bf16_f32 v22, v108, v109
v_cvt_pk_bf16_f32 v23, v110, v111
buffer_store_dwordx4 v[20:23], v1, s[4:7], s28 offen offset:1024 sc1
v_mul_f32 v112, v112, v4
v_mul_f32 v113, v113, v4
v_mul_f32 v114, v114, v4
v_mul_f32 v115, v115, v4
v_mul_f32 v116, v116, v4
v_mul_f32 v117, v117, v4
v_mul_f32 v118, v118, v4
v_mul_f32 v119, v119, v4
v_mul_f32 v120, v120, v4
v_mul_f32 v121, v121, v4
v_mul_f32 v122, v122, v4
v_mul_f32 v123, v123, v4
v_mul_f32 v124, v124, v4
v_mul_f32 v125, v125, v4
v_mul_f32 v126, v126, v4
v_mul_f32 v127, v127, v4
v_cvt_pk_bf16_f32 v24, v112, v113
v_cvt_pk_bf16_f32 v25, v114, v115
v_cvt_pk_bf16_f32 v26, v116, v117
v_cvt_pk_bf16_f32 v27, v118, v119
buffer_store_dwordx4 v[24:27], v1, s[4:7], s28 offen offset:2048 sc1
v_cvt_pk_bf16_f32 v28, v120, v121
v_cvt_pk_bf16_f32 v29, v122, v123
v_cvt_pk_bf16_f32 v30, v124, v125
v_cvt_pk_bf16_f32 v31, v126, v127
buffer_store_dwordx4 v[28:31], v1, s[4:7], s28 offen offset:3072 sc1
s_branch L_k2_fin
L_grp_short:
s_cmp_eq_u32 s16, 0
s_cbranch_scc1 L_last0_S
s_waitcnt lgkmcnt(4)
v_mfma_f32_32x32x16_bf16 v[32:47], v[160:163], v[128:131], v[48:63]
v_exp_f32 v208, v16
v_exp_f32 v209, v17
v_exp_f32 v210, v18
v_mfma_f32_32x32x16_bf16 v[32:47], v[164:167], v[132:135], v[32:47]
v_add_f32 v9, v208, v210
v_exp_f32 v211, v19
v_exp_f32 v212, v20
v_add_f32 v11, v209, v211
v_mfma_f32_32x32x16_bf16 v[32:47], v[168:171], v[136:139], v[32:47]
v_add_f32 v9, v9, v212
v_exp_f32 v213, v21
v_exp_f32 v214, v22
v_add_f32 v11, v11, v213
v_mfma_f32_32x32x16_bf16 v[32:47], v[172:175], v[140:143], v[32:47]
v_add_f32 v9, v9, v214
v_exp_f32 v215, v23
v_cvt_pk_bf16_f32 v192, v208, v209
v_add_f32 v11, v11, v215
s_waitcnt lgkmcnt(0)
v_mfma_f32_32x32x16_bf16 v[32:47], v[176:179], v[144:147], v[32:47]
v_exp_f32 v208, v24
v_exp_f32 v209, v25
v_add_f32 v9, v9, v208
v_add_f32 v11, v11, v209
v_mfma_f32_32x32x16_bf16 v[32:47], v[180:183], v[148:151], v[32:47]
v_cvt_pk_bf16_f32 v193, v210, v211
v_exp_f32 v210, v26
v_exp_f32 v211, v27
v_add_f32 v9, v9, v210
v_mfma_f32_32x32x16_bf16 v[32:47], v[184:187], v[152:155], v[32:47]
v_add_f32 v11, v11, v211
v_cvt_pk_bf16_f32 v194, v212, v213
v_exp_f32 v212, v28
v_exp_f32 v213, v29
v_add_f32 v4, v4, v13
v_mfma_f32_32x32x16_bf16 v[32:47], v[188:191], v[156:159], v[32:47]
v_mov_b32 v3, v2
v_add_u32 v2, 32768, v2
v_and_b32 v2, 0x1ffff, v2
s_waitcnt vmcnt(8)
s_barrier
ds_read_b128 v[160:163], v2 offset:0
v_add_f32 v9, v9, v212
v_add_f32 v11, v11, v213
v_cvt_pk_bf16_f32 v195, v214, v215
v_exp_f32 v214, v30
v_exp_f32 v215, v31
v_add_f32 v9, v9, v214
v_add_f32 v11, v11, v215
v_add_f32 v13, v9, v11
s_mov_b32 m0, s24
s_min_u32 s22, s20, s30
buffer_load_dwordx4 v1, s[4:7], s22 offen sc1 lds
buffer_load_dwordx4 v1, s[4:7], s22 offen offset:1024 sc1 lds
ds_read_b128 v[164:167], v2 offset:1024
v_cmp_nge_f32 vcc, s26, v13
v_cvt_pk_bf16_f32 v196, v208, v209
v_cvt_pk_bf16_f32 v197, v210, v211
v_cvt_pk_bf16_f32 v198, v212, v213
v_cvt_pk_bf16_f32 v199, v214, v215
buffer_load_dwordx4 v1, s[4:7], s22 offen offset:2048 sc1 lds
ds_read_b128 v[168:171], v2 offset:2048
buffer_load_dwordx4 v1, s[4:7], s22 offen offset:3072 sc1 lds
ds_read_b128 v[172:175], v2 offset:3072
s_add_u32 s21, s24, 114688
s_and_b32 m0, s21, 0x1ffff
s_add_u32 s24, s24, 32768
s_min_u32 s21, s23, s31
buffer_load_dwordx4 v1, s[4:7], s21 offen sc1 lds
ds_read_b128 v[176:179], v2 offset:4096
buffer_load_dwordx4 v1, s[4:7], s21 offen offset:1024 sc1 lds
ds_read_b128 v[180:183], v2 offset:5120
buffer_load_dwordx4 v1, s[4:7], s21 offen offset:2048 sc1 lds
ds_read_b128 v[184:187], v2 offset:6144
buffer_load_dwordx4 v1, s[4:7], s21 offen offset:3072 sc1 lds
ds_read_b128 v[188:191], v2 offset:7168
s_and_b32 s24, s24, 0x1ffff
s_add_u32 s20, s20, 32768
s_add_u32 s23, s23, 32768
s_add_u32 s19, s19, 1
s_cbranch_vccnz L_slow_fS
L_back_fS:
s_sub_u32 s17, s17, 1
s_cbranch_scc1 L_last1_S
.p2align 6
L_loop_S:
s_waitcnt lgkmcnt(4)
v_mfma_f32_32x32x16_bf16 v[16:31], v[160:163], v[128:131], v[48:63]
ds_read_b128 v[160:163], v3 offset:16384
v_exp_f32 v208, v32
v_exp_f32 v209, v33
v_mfma_f32_32x32x16_bf16 v[16:31], v[164:167], v[132:135], v[16:31]
ds_read_b128 v[164:167], v3 offset:17408
v_exp_f32 v210, v34
v_exp_f32 v211, v35
v_add_f32 v10, v208, v210
v_mfma_f32_32x32x16_bf16 v[16:31], v[168:171], v[136:139], v[16:31]
ds_read_b128 v[168:171], v3 offset:18432
v_add_f32 v12, v209, v211
v_exp_f32 v212, v36
v_cvt_pk_bf16_f32 v200, v208, v209
v_mfma_f32_32x32x16_bf16 v[16:31], v[172:175], v[140:143], v[16:31]
ds_read_b128 v[172:175], v3 offset:19456
v_add_f32 v10, v10, v212
v_exp_f32 v213, v37
s_waitcnt lgkmcnt(4)
v_mfma_f32_32x32x16_bf16 v[16:31], v[176:179], v[144:147], v[16:31]
ds_read_b128 v[176:179], v3 offset:20480
v_add_f32 v12, v12, v213
v_exp_f32 v214, v38
v_cvt_pk_bf16_f32 v201, v210, v211
v_mfma_f32_32x32x16_bf16 v[16:31], v[180:183], v[148:151], v[16:31]
ds_read_b128 v[180:183], v3 offset:21504
v_add_f32 v10, v10, v214
v_exp_f32 v215, v39
v_exp_f32 v208, v40
v_mfma_f32_32x32x16_bf16 v[16:31], v[184:187], v[152:155], v[16:31]
ds_read_b128 v[184:187], v3 offset:22528
v_add_f32 v12, v12, v215
v_add_f32 v10, v10, v208
v_exp_f32 v209, v41
v_add_f32 v4, v4, v13
v_mfma_f32_32x32x16_bf16 v[16:31], v[188:191], v[156:159], v[16:31]
ds_read_b128 v[188:191], v3 offset:23552
v_add_f32 v12, v12, v209
v_exp_f32 v210, v42
s_waitcnt lgkmcnt(4)
v_mfma_f32_32x32x16_bf16 v[64:79], v[160:163], v[192:195], v[64:79]
ds_read_b128 v[160:163], v2 offset:8192
v_add_f32 v10, v10, v210
v_exp_f32 v211, v43
v_cvt_pk_bf16_f32 v202, v212, v213
v_mfma_f32_32x32x16_bf16 v[80:95], v[164:167], v[192:195], v[80:95]
ds_read_b128 v[164:167], v2 offset:9216
v_add_f32 v12, v12, v211
v_exp_f32 v212, v44
v_exp_f32 v213, v45
v_mfma_f32_32x32x16_bf16 v[96:111], v[168:171], v[192:195], v[96:111]
ds_read_b128 v[168:171], v2 offset:10240
v_add_f32 v10, v10, v212
v_add_f32 v12, v12, v213
v_cvt_pk_bf16_f32 v203, v214, v215
v_cvt_pk_bf16_f32 v204, v208, v209
v_mfma_f32_32x32x16_bf16 v[112:127], v[172:175], v[192:195], v[112:127]
ds_read_b128 v[172:175], v2 offset:11264
v_exp_f32 v214, v46
v_cvt_pk_bf16_f32 v205, v210, v211
s_waitcnt lgkmcnt(4)
v_mfma_f32_32x32x16_bf16 v[64:79], v[176:179], v[196:199], v[64:79]
ds_read_b128 v[176:179], v2 offset:12288
v_add_f32 v10, v10, v214
v_exp_f32 v215, v47
v_cvt_pk_bf16_f32 v206, v212, v213
v_mfma_f32_32x32x16_bf16 v[80:95], v[180:183], v[196:199], v[80:95]
ds_read_b128 v[180:183], v2 offset:13312
v_add_f32 v12, v12, v215
v_add_f32 v13, v10, v12
v_cmp_nge_f32 vcc, s26, v13
v_cvt_pk_bf16_f32 v207, v214, v215
v_mfma_f32_32x32x16_bf16 v[96:111], v[184:187], v[196:199], v[96:111]
ds_read_b128 v[184:187], v2 offset:14336
v_mfma_f32_32x32x16_bf16 v[112:127], v[188:191], v[196:199], v[112:127]
ds_read_b128 v[188:191], v2 offset:15360
s_cbranch_vccnz L_slow_oS
L_back_oS:
s_sub_u32 s17, s17, 1
s_cbranch_scc1 L_last0_S
s_waitcnt lgkmcnt(4)
v_mfma_f32_32x32x16_bf16 v[32:47], v[160:163], v[128:131], v[48:63]
ds_read_b128 v[160:163], v3 offset:24576
v_exp_f32 v208, v16
v_exp_f32 v209, v17
v_mfma_f32_32x32x16_bf16 v[32:47], v[164:167], v[132:135], v[32:47]
ds_read_b128 v[164:167], v3 offset:25600
v_exp_f32 v210, v18
v_exp_f32 v211, v19
v_add_f32 v9, v208, v210
v_mfma_f32_32x32x16_bf16 v[32:47], v[168:171], v[136:139], v[32:47]
ds_read_b128 v[168:171], v3 offset:26624
v_add_f32 v11, v209, v211
v_exp_f32 v212, v20
v_cvt_pk_bf16_f32 v192, v208, v209
v_mfma_f32_32x32x16_bf16 v[32:47], v[172:175], v[140:143], v[32:47]
ds_read_b128 v[172:175], v3 offset:27648
v_add_f32 v9, v9, v212
v_exp_f32 v213, v21
s_waitcnt lgkmcnt(4)
v_mfma_f32_32x32x16_bf16 v[32:47], v[176:179], v[144:147], v[32:47]
ds_read_b128 v[176:179], v3 offset:28672
v_add_f32 v11, v11, v213
v_exp_f32 v214, v22
v_cvt_pk_bf16_f32 v193, v210, v211
v_mfma_f32_32x32x16_bf16 v[32:47], v[180:183], v[148:151], v[32:47]
ds_read_b128 v[180:183], v3 offset:29696
v_add_f32 v9, v9, v214
v_exp_f32 v215, v23
v_exp_f32 v208, v24
v_mfma_f32_32x32x16_bf16 v[32:47], v[184:187], v[152:155], v[32:47]
ds_read_b128 v[184:187], v3 offset:30720
v_add_f32 v11, v11, v215
v_add_f32 v9, v9, v208
v_exp_f32 v209, v25
v_add_f32 v4, v4, v13
v_mfma_f32_32x32x16_bf16 v[32:47], v[188:191], v[156:159], v[32:47]
ds_read_b128 v[188:191], v3 offset:31744
v_mov_b32 v3, v2
v_add_u32 v2, 32768, v2
v_and_b32 v2, 0x1ffff, v2
s_waitcnt lgkmcnt(4)
s_waitcnt vmcnt(8)
s_barrier
v_mfma_f32_32x32x16_bf16 v[64:79], v[160:163], v[200:203], v[64:79]
ds_read_b128 v[160:163], v2 offset:0
v_add_f32 v11, v11, v209
v_exp_f32 v210, v26
v_cvt_pk_bf16_f32 v194, v212, v213
s_mov_b32 m0, s24
s_min_u32 s22, s20, s30
buffer_load_dwordx4 v1, s[4:7], s22 offen sc1 lds
buffer_load_dwordx4 v1, s[4:7], s22 offen offset:1024 sc1 lds
v_mfma_f32_32x32x16_bf16 v[80:95], v[164:167], v[200:203], v[80:95]
ds_read_b128 v[164:167], v2 offset:1024
v_add_f32 v9, v9, v210
v_exp_f32 v211, v27
v_exp_f32 v212, v28
buffer_load_dwordx4 v1, s[4:7], s22 offen offset:2048 sc1 lds
v_mfma_f32_32x32x16_bf16 v[96:111], v[168:171], v[200:203], v[96:111]
ds_read_b128 v[168:171], v2 offset:2048
v_add_f32 v11, v11, v211
v_add_f32 v9, v9, v212
v_exp_f32 v213, v29
buffer_load_dwordx4 v1, s[4:7], s22 offen offset:3072 sc1 lds
v_mfma_f32_32x32x16_bf16 v[112:127], v[172:175], v[200:203], v[112:127]
ds_read_b128 v[172:175], v2 offset:3072
v_add_f32 v11, v11, v213
v_cvt_pk_bf16_f32 v195, v214, v215
v_cvt_pk_bf16_f32 v196, v208, v209
s_add_u32 s21, s24, 114688
s_and_b32 m0, s21, 0x1ffff
s_add_u32 s24, s24, 32768
s_min_u32 s21, s23, s31
buffer_load_dwordx4 v1, s[4:7], s21 offen sc1 lds
s_waitcnt lgkmcnt(4)
v_mfma_f32_32x32x16_bf16 v[64:79], v[176:179], v[204:207], v[64:79]
ds_read_b128 v[176:179], v2 offset:4096
v_exp_f32 v214, v30
v_exp_f32 v215, v31
buffer_load_dwordx4 v1, s[4:7], s21 offen offset:1024 sc1 lds
v_mfma_f32_32x32x16_bf16 v[80:95], v[180:183], v[204:207], v[80:95]
ds_read_b128 v[180:183], v2 offset:5120
v_add_f32 v9, v9, v214
v_add_f32 v11, v11, v215
v_add_f32 v13, v9, v11
v_cmp_nge_f32 vcc, s26, v13
v_cvt_pk_bf16_f32 v197, v210, v211
buffer_load_dwordx4 v1, s[4:7], s21 offen offset:2048 sc1 lds
v_mfma_f32_32x32x16_bf16 v[96:111], v[184:187], v[204:207], v[96:111]
ds_read_b128 v[184:187], v2 offset:6144
v_cvt_pk_bf16_f32 v198, v212, v213
v_cvt_pk_bf16_f32 v199, v214, v215
buffer_load_dwordx4 v1, s[4:7], s21 offen offset:3072 sc1 lds
v_mfma_f32_32x32x16_bf16 v[112:127], v[188:191], v[204:207], v[112:127]
ds_read_b128 v[188:191], v2 offset:7168
s_and_b32 s24, s24, 0x1ffff
s_add_u32 s20, s20, 32768
s_add_u32 s23, s23, 32768
s_add_u32 s19, s19, 1
s_cbranch_vccnz L_slow_eS
L_back_eS:
s_sub_u32 s17, s17, 1
s_cbranch_scc0 L_loop_S
L_last1_S:
v_cndmask_b32 v32, v32, v8, s[32:33]
v_cndmask_b32 v33, v33, v8, s[34:35]
v_cndmask_b32 v34, v34, v8, s[36:37]
v_cndmask_b32 v35, v35, v8, s[38:39]
v_cndmask_b32 v36, v36, v8, s[40:41]
v_cndmask_b32 v37, v37, v8, s[42:43]
v_cndmask_b32 v38, v38, v8, s[44:45]
v_cndmask_b32 v39, v39, v8, s[46:47]
v_cndmask_b32 v40, v40, v8, s[48:49]
v_cndmask_b32 v41, v41, v8, s[50:51]
v_cndmask_b32 v42, v42, v8, s[52:53]
v_cndmask_b32 v43, v43, v8, s[54:55]
v_cndmask_b32 v44, v44, v8, s[56:57]
v_cndmask_b32 v45, v45, v8, s[58:59]
v_cndmask_b32 v46, v46, v8, s[60:61]
v_cndmask_b32 v47, v47, v8, s[62:63]
ds_read_b128 v[160:163], v3 offset:16384
ds_read_b128 v[164:167], v3 offset:17408
ds_read_b128 v[168:171], v3 offset:18432
ds_read_b128 v[172:175], v3 offset:19456
ds_read_b128 v[176:179], v3 offset:20480
ds_read_b128 v[180:183], v3 offset:21504
ds_read_b128 v[184:187], v3 offset:22528
ds_read_b128 v[188:191], v3 offset:23552
s_waitcnt lgkmcnt(4)
v_mfma_f32_32x32x16_bf16 v[64:79], v[160:163], v[192:195], v[64:79]
ds_read_b128 v[160:163], v3 offset:24576
v_exp_f32 v208, v32
v_exp_f32 v209, v33
v_exp_f32 v210, v34
v_cvt_pk_bf16_f32 v200, v208, v209
v_mfma_f32_32x32x16_bf16 v[80:95], v[164:167], v[192:195], v[80:95]
ds_read_b128 v[164:167], v3 offset:25600
v_add_f32 v10, v208, v210
v_exp_f32 v211, v35
v_exp_f32 v212, v36
v_add_f32 v12, v209, v211
v_add_f32 v10, v10, v212
v_mfma_f32_32x32x16_bf16 v[96:111], v[168:171], v[192:195], v[96:111]
ds_read_b128 v[168:171], v3 offset:26624
v_exp_f32 v213, v37
v_exp_f32 v214, v38
v_add_f32 v12, v12, v213
v_add_f32 v10, v10, v214
v_cvt_pk_bf16_f32 v201, v210, v211
v_mfma_f32_32x32x16_bf16 v[112:127], v[172:175], v[192:195], v[112:127]
ds_read_b128 v[172:175], v3 offset:27648
v_exp_f32 v215, v39
v_exp_f32 v208, v40
v_add_f32 v12, v12, v215
v_add_f32 v10, v10, v208
v_cvt_pk_bf16_f32 v202, v212, v213
s_waitcnt lgkmcnt(4)
v_mfma_f32_32x32x16_bf16 v[64:79], v[176:179], v[196:199], v[64:79]
ds_read_b128 v[176:179], v3 offset:28672
v_exp_f32 v209, v41
v_exp_f32 v210, v42
v_add_f32 v12, v12, v209
v_add_f32 v10, v10, v210
v_cvt_pk_bf16_f32 v203, v214, v215
v_mfma_f32_32x32x16_bf16 v[80:95], v[180:183], v[196:199], v[80:95]
ds_read_b128 v[180:183], v3 offset:29696
v_exp_f32 v211, v43
v_exp_f32 v212, v44
v_add_f32 v12, v12, v211
v_add_f32 v10, v10, v212
v_cvt_pk_bf16_f32 v204, v208, v209
v_mfma_f32_32x32x16_bf16 v[96:111], v[184:187], v[196:199], v[96:111]
ds_read_b128 v[184:187], v3 offset:30720
v_exp_f32 v213, v45
v_exp_f32 v214, v46
v_add_f32 v12, v12, v213
v_add_f32 v10, v10, v214
v_cvt_pk_bf16_f32 v205, v210, v211
v_add_f32 v4, v4, v13
v_mfma_f32_32x32x16_bf16 v[112:127], v[188:191], v[196:199], v[112:127]
ds_read_b128 v[188:191], v3 offset:31744
v_exp_f32 v215, v47
v_cvt_pk_bf16_f32 v206, v212, v213
v_add_f32 v12, v12, v215
v_add_f32 v13, v10, v12
v_cmp_nge_f32 vcc, s26, v13
v_cvt_pk_bf16_f32 v207, v214, v215
s_cbranch_vccnz L_slow_l1S
L_back_l1S:
v_add_f32 v4, v4, v13
s_waitcnt lgkmcnt(4)
v_mfma_f32_32x32x16_bf16 v[64:79], v[160:163], v[200:203], v[64:79]
v_mfma_f32_32x32x16_bf16 v[80:95], v[164:167], v[200:203], v[80:95]
v_mfma_f32_32x32x16_bf16 v[96:111], v[168:171], v[200:203], v[96:111]
v_mfma_f32_32x32x16_bf16 v[112:127], v[172:175], v[200:203], v[112:127]
s_waitcnt lgkmcnt(0)
v_mfma_f32_32x32x16_bf16 v[64:79], v[176:179], v[204:207], v[64:79]
v_mfma_f32_32x32x16_bf16 v[80:95], v[180:183], v[204:207], v[80:95]
v_mfma_f32_32x32x16_bf16 v[96:111], v[184:187], v[204:207], v[96:111]
v_mfma_f32_32x32x16_bf16 v[112:127], v[188:191], v[204:207], v[112:127]
s_branch L_epi_S
L_last0_S:
s_cmp_eq_u32 s16, 0
s_cbranch_scc1 L_only_l0S
v_cndmask_b32 v16, v16, v8, s[32:33]
v_cndmask_b32 v17, v17, v8, s[34:35]
v_cndmask_b32 v18, v18, v8, s[36:37]
v_cndmask_b32 v19, v19, v8, s[38:39]
v_cndmask_b32 v20, v20, v8, s[40:41]
v_cndmask_b32 v21, v21, v8, s[42:43]
v_cndmask_b32 v22, v22, v8, s[44:45]
v_cndmask_b32 v23, v23, v8, s[46:47]
v_cndmask_b32 v24, v24, v8, s[48:49]
v_cndmask_b32 v25, v25, v8, s[50:51]
v_cndmask_b32 v26, v26, v8, s[52:53]
v_cndmask_b32 v27, v27, v8, s[54:55]
v_cndmask_b32 v28, v28, v8, s[56:57]
v_cndmask_b32 v29, v29, v8, s[58:59]
v_cndmask_b32 v30, v30, v8, s[60:61]
v_cndmask_b32 v31, v31, v8, s[62:63]
ds_read_b128 v[160:163], v3 offset:24576
ds_read_b128 v[164:167], v3 offset:25600
ds_read_b128 v[168:171], v3 offset:26624
ds_read_b128 v[172:175], v3 offset:27648
ds_read_b128 v[176:179], v3 offset:28672
ds_read_b128 v[180:183], v3 offset:29696
ds_read_b128 v[184:187], v3 offset:30720
ds_read_b128 v[188:191], v3 offset:31744
s_waitcnt vmcnt(8)
s_barrier
s_mov_b32 m0, s24
s_min_u32 s22, s20, s30
buffer_load_dwordx4 v1, s[4:7], s22 offen sc1 lds
buffer_load_dwordx4 v1, s[4:7], s22 offen offset:1024 sc1 lds
buffer_load_dwordx4 v1, s[4:7], s22 offen offset:2048 sc1 lds
buffer_load_dwordx4 v1, s[4:7], s22 offen offset:3072 sc1 lds
s_add_u32 s21, s24, 114688
s_and_b32 m0, s21, 0x1ffff
s_add_u32 s24, s24, 32768
s_min_u32 s21, s23, s31
buffer_load_dwordx4 v1, s[4:7], s21 offen sc1 lds
buffer_load_dwordx4 v1, s[4:7], s21 offen offset:1024 sc1 lds
buffer_load_dwordx4 v1, s[4:7], s21 offen offset:2048 sc1 lds
buffer_load_dwordx4 v1, s[4:7], s21 offen offset:3072 sc1 lds
s_and_b32 s24, s24, 0x1ffff
s_add_u32 s20, s20, 32768
s_add_u32 s23, s23, 32768
s_add_u32 s19, s19, 1
s_waitcnt lgkmcnt(4)
v_mfma_f32_32x32x16_bf16 v[64:79], v[160:163], v[200:203], v[64:79]
ds_read_b128 v[160:163], v2 offset:16384
v_exp_f32 v208, v16
v_exp_f32 v209, v17
v_exp_f32 v210, v18
v_cvt_pk_bf16_f32 v192, v208, v209
v_mfma_f32_32x32x16_bf16 v[80:95], v[164:167], v[200:203], v[80:95]
ds_read_b128 v[164:167], v2 offset:17408
v_add_f32 v9, v208, v210
v_exp_f32 v211, v19
v_exp_f32 v212, v20
v_add_f32 v11, v209, v211
v_add_f32 v9, v9, v212
v_mfma_f32_32x32x16_bf16 v[96:111], v[168:171], v[200:203], v[96:111]
ds_read_b128 v[168:171], v2 offset:18432
v_exp_f32 v213, v21
v_exp_f32 v214, v22
v_add_f32 v11, v11, v213
v_add_f32 v9, v9, v214
v_cvt_pk_bf16_f32 v193, v210, v211
v_mfma_f32_32x32x16_bf16 v[112:127], v[172:175], v[200:203], v[112:127]
ds_read_b128 v[172:175], v2 offset:19456
v_exp_f32 v215, v23
v_exp_f32 v208, v24
v_add_f32 v11, v11, v215
v_add_f32 v9, v9, v208
v_cvt_pk_bf16_f32 v194, v212, v213
s_waitcnt lgkmcnt(4)
v_mfma_f32_32x32x16_bf16 v[64:79], v[176:179], v[204:207], v[64:79]
ds_read_b128 v[176:179], v2 offset:20480
v_exp_f32 v209, v25
v_exp_f32 v210, v26
v_add_f32 v11, v11, v209
v_add_f32 v9, v9, v210
v_cvt_pk_bf16_f32 v195, v214, v215
v_mfma_f32_32x32x16_bf16 v[80:95], v[180:183], v[204:207], v[80:95]
ds_read_b128 v[180:183], v2 offset:21504
v_exp_f32 v211, v27
v_exp_f32 v212, v28
v_add_f32 v11, v11, v211
v_add_f32 v9, v9, v212
v_cvt_pk_bf16_f32 v196, v208, v209
v_mfma_f32_32x32x16_bf16 v[96:111], v[184:187], v[204:207], v[96:111]
ds_read_b128 v[184:187], v2 offset:22528
v_exp_f32 v213, v29
v_exp_f32 v214, v30
v_add_f32 v11, v11, v213
v_add_f32 v9, v9, v214
v_cvt_pk_bf16_f32 v197, v210, v211
v_add_f32 v4, v4, v13
v_mfma_f32_32x32x16_bf16 v[112:127], v[188:191], v[204:207], v[112:127]
ds_read_b128 v[188:191], v2 offset:23552
v_exp_f32 v215, v31
v_cvt_pk_bf16_f32 v198, v212, v213
v_add_f32 v11, v11, v215
v_add_f32 v13, v9, v11
v_cmp_nge_f32 vcc, s26, v13
v_cvt_pk_bf16_f32 v199, v214, v215
s_branch L_fin_l0S
L_only_l0S:
s_waitcnt vmcnt(8)
s_barrier
s_mov_b32 m0, s24
s_min_u32 s22, s20, s30
buffer_load_dwordx4 v1, s[4:7], s22 offen sc1 lds
buffer_load_dwordx4 v1, s[4:7], s22 offen offset:1024 sc1 lds
buffer_load_dwordx4 v1, s[4:7], s22 offen offset:2048 sc1 lds
buffer_load_dwordx4 v1, s[4:7], s22 offen offset:3072 sc1 lds
s_add_u32 s21, s24, 114688
s_and_b32 m0, s21, 0x1ffff
s_add_u32 s24, s24, 32768
s_min_u32 s21, s23, s31
buffer_load_dwordx4 v1, s[4:7], s21 offen sc1 lds
buffer_load_dwordx4 v1, s[4:7], s21 offen offset:1024 sc1 lds
buffer_load_dwordx4 v1, s[4:7], s21 offen offset:2048 sc1 lds
buffer_load_dwordx4 v1, s[4:7], s21 offen offset:3072 sc1 lds
s_and_b32 s24, s24, 0x1ffff
s_add_u32 s20, s20, 32768
s_add_u32 s23, s23, 32768
s_add_u32 s19, s19, 1
ds_read_b128 v[160:163], v2 offset:16384
ds_read_b128 v[164:167], v2 offset:17408
ds_read_b128 v[168:171], v2 offset:18432
ds_read_b128 v[172:175], v2 offset:19456
ds_read_b128 v[176:179], v2 offset:20480
ds_read_b128 v[180:183], v2 offset:21504
ds_read_b128 v[184:187], v2 offset:22528
ds_read_b128 v[188:191], v2 offset:23552
v_exp_f32 v208, v16
v_exp_f32 v209, v17
v_exp_f32 v210, v18
v_exp_f32 v211, v19
v_add_f32 v9, v208, v210
v_add_f32 v11, v209, v211
v_exp_f32 v212, v20
v_exp_f32 v213, v21
v_add_f32 v9, v9, v212
v_add_f32 v11, v11, v213
v_exp_f32 v214, v22
v_exp_f32 v215, v23
v_add_f32 v9, v9, v214
v_add_f32 v11, v11, v215
v_cvt_pk_bf16_f32 v192, v208, v209
v_exp_f32 v208, v24
v_exp_f32 v209, v25
v_add_f32 v9, v9, v208
v_add_f32 v11, v11, v209
v_cvt_pk_bf16_f32 v193, v210, v211
v_exp_f32 v210, v26
v_exp_f32 v211, v27
v_add_f32 v9, v9, v210
v_add_f32 v11, v11, v211
v_cvt_pk_bf16_f32 v194, v212, v213
v_exp_f32 v212, v28
v_exp_f32 v213, v29
v_add_f32 v9, v9, v212
v_add_f32 v11, v11, v213
v_cvt_pk_bf16_f32 v195, v214, v215
v_exp_f32 v214, v30
v_exp_f32 v215, v31
v_add_f32 v9, v9, v214
v_add_f32 v11, v11, v215
v_cvt_pk_bf16_f32 v196, v208, v209
v_cvt_pk_bf16_f32 v197, v210, v211
v_cvt_pk_bf16_f32 v198, v212, v213
v_cvt_pk_bf16_f32 v199, v214, v215
v_add_f32 v4, v4, v13
v_add_f32 v13, v9, v11
v_cmp_nge_f32 vcc, s26, v13
L_fin_l0S:
s_cbranch_vccnz L_slow_l0S
L_back_l0S:
v_add_f32 v4, v4, v13
s_waitcnt lgkmcnt(4)
v_mfma_f32_32x32x16_bf16 v[64:79], v[160:163], v[192:195], v[64:79]
v_mfma_f32_32x32x16_bf16 v[80:95], v[164:167], v[192:195], v[80:95]
v_mfma_f32_32x32x16_bf16 v[96:111], v[168:171], v[192:195], v[96:111]
v_mfma_f32_32x32x16_bf16 v[112:127], v[172:175], v[192:195], v[112:127]
s_waitcnt lgkmcnt(0)
v_mfma_f32_32x32x16_bf16 v[64:79], v[176:179], v[196:199], v[64:79]
v_mfma_f32_32x32x16_bf16 v[80:95], v[180:183], v[196:199], v[80:95]
v_mfma_f32_32x32x16_bf16 v[96:111], v[184:187], v[196:199], v[96:111]
v_mfma_f32_32x32x16_bf16 v[112:127], v[188:191], v[196:199], v[112:127]
L_epi_S:
s_cmp_ge_u32 s19, s18
s_cbranch_scc1 L_ldr_epi
s_waitcnt vmcnt(8)
s_barrier
s_mov_b32 m0, s24
s_min_u32 s22, s20, s30
buffer_load_dwordx4 v1, s[4:7], s22 offen sc1 lds
buffer_load_dwordx4 v1, s[4:7], s22 offen offset:1024 sc1 lds
buffer_load_dwordx4 v1, s[4:7], s22 offen offset:2048 sc1 lds
buffer_load_dwordx4 v1, s[4:7], s22 offen offset:3072 sc1 lds
s_add_u32 s21, s24, 114688
s_and_b32 m0, s21, 0x1ffff
s_add_u32 s24, s24, 32768
s_min_u32 s21, s23, s31
buffer_load_dwordx4 v1, s[4:7], s21 offen sc1 lds
buffer_load_dwordx4 v1, s[4:7], s21 offen offset:1024 sc1 lds
buffer_load_dwordx4 v1, s[4:7], s21 offen offset:2048 sc1 lds
buffer_load_dwordx4 v1, s[4:7], s21 offen offset:3072 sc1 lds
s_and_b32 s24, s24, 0x1ffff
s_add_u32 s20, s20, 32768
s_add_u32 s23, s23, 32768
s_add_u32 s19, s19, 1
L_ldr_epi:
v_mov_b32 v7, v4
s_nop 1
v_permlane32_swap_b32 v4, v7
s_nop 1
v_add_f32 v4, v4, v7
v_rcp_f32 v4, v4
s_nop 7
s_nop 3
v_mul_f32 v64, v64, v4
v_mul_f32 v65, v65, v4
v_mul_f32 v66, v66, v4
v_mul_f32 v67, v67, v4
v_mul_f32 v68, v68, v4
v_mul_f32 v69, v69, v4
v_mul_f32 v70, v70, v4
v_mul_f32 v71, v71, v4
v_mul_f32 v72, v72, v4
v_mul_f32 v73, v73, v4
v_mul_f32 v74, v74, v4
v_mul_f32 v75, v75, v4
v_mul_f32 v76, v76, v4
v_mul_f32 v77, v77, v4
v_mul_f32 v78, v78, v4
v_mul_f32 v79, v79, v4
v_cvt_pk_bf16_f32 v208, v64, v65
v_cvt_pk_bf16_f32 v209, v66, v67
v_cvt_pk_bf16_f32 v210, v68, v69
v_cvt_pk_bf16_f32 v211, v70, v71
buffer_store_dwordx4 v[208:211], v1, s[4:7], s28 offen sc1
v_cvt_pk_bf16_f32 v212, v72, v73
v_cvt_pk_bf16_f32 v213, v74, v75
v_cvt_pk_bf16_f32 v214, v76, v77
v_cvt_pk_bf16_f32 v215, v78, v79
buffer_store_dwordx4 v[212:215], v1, s[4:7], s28 offen offset:1024 sc1
v_mul_f32 v80, v80, v4
v_mul_f32 v81, v81, v4
v_mul_f32 v82, v82, v4
v_mul_f32 v83, v83, v4
v_mul_f32 v84, v84, v4
v_mul_f32 v85, v85, v4
v_mul_f32 v86, v86, v4
v_mul_f32 v87, v87, v4
v_mul_f32 v88, v88, v4
v_mul_f32 v89, v89, v4
v_mul_f32 v90, v90, v4
v_mul_f32 v91, v91, v4
v_mul_f32 v92, v92, v4
v_mul_f32 v93, v93, v4
v_mul_f32 v94, v94, v4
v_mul_f32 v95, v95, v4
v_cvt_pk_bf16_f32 v216, v80, v81
v_cvt_pk_bf16_f32 v217, v82, v83
v_cvt_pk_bf16_f32 v218, v84, v85
v_cvt_pk_bf16_f32 v219, v86, v87
buffer_store_dwordx4 v[216:219], v1, s[4:7], s28 offen offset:2048 sc1
v_cvt_pk_bf16_f32 v220, v88, v89
v_cvt_pk_bf16_f32 v221, v90, v91
v_cvt_pk_bf16_f32 v222, v92, v93
v_cvt_pk_bf16_f32 v223, v94, v95
buffer_store_dwordx4 v[220:223], v1, s[4:7], s28 offen offset:3072 sc1
v_mul_f32 v96, v96, v4
v_mul_f32 v97, v97, v4
v_mul_f32 v98, v98, v4
v_mul_f32 v99, v99, v4
v_mul_f32 v100, v100, v4
v_mul_f32 v101, v101, v4
v_mul_f32 v102, v102, v4
v_mul_f32 v103, v103, v4
v_mul_f32 v104, v104, v4
v_mul_f32 v105, v105, v4
v_mul_f32 v106, v106, v4
v_mul_f32 v107, v107, v4
v_mul_f32 v108, v108, v4
v_mul_f32 v109, v109, v4
v_mul_f32 v110, v110, v4
v_mul_f32 v111, v111, v4
v_cvt_pk_bf16_f32 v16, v96, v97
v_cvt_pk_bf16_f32 v17, v98, v99
v_cvt_pk_bf16_f32 v18, v100, v101
v_cvt_pk_bf16_f32 v19, v102, v103
s_add_u32 s28, s28, 4096
buffer_store_dwordx4 v[16:19], v1, s[4:7], s28 offen sc1
v_cvt_pk_bf16_f32 v20, v104, v105
v_cvt_pk_bf16_f32 v21, v106, v107
v_cvt_pk_bf16_f32 v22, v108, v109
v_cvt_pk_bf16_f32 v23, v110, v111
buffer_store_dwordx4 v[20:23], v1, s[4:7], s28 offen offset:1024 sc1
v_mul_f32 v112, v112, v4
v_mul_f32 v113, v113, v4
v_mul_f32 v114, v114, v4
v_mul_f32 v115, v115, v4
v_mul_f32 v116, v116, v4
v_mul_f32 v117, v117, v4
v_mul_f32 v118, v118, v4
v_mul_f32 v119, v119, v4
v_mul_f32 v120, v120, v4
v_mul_f32 v121, v121, v4
v_mul_f32 v122, v122, v4
v_mul_f32 v123, v123, v4
v_mul_f32 v124, v124, v4
v_mul_f32 v125, v125, v4
v_mul_f32 v126, v126, v4
v_mul_f32 v127, v127, v4
v_cvt_pk_bf16_f32 v24, v112, v113
v_cvt_pk_bf16_f32 v25, v114, v115
v_cvt_pk_bf16_f32 v26, v116, v117
v_cvt_pk_bf16_f32 v27, v118, v119
buffer_store_dwordx4 v[24:27], v1, s[4:7], s28 offen offset:2048 sc1
v_cvt_pk_bf16_f32 v28, v120, v121
v_cvt_pk_bf16_f32 v29, v122, v123
v_cvt_pk_bf16_f32 v30, v124, v125
v_cvt_pk_bf16_f32 v31, v126, v127
buffer_store_dwordx4 v[28:31], v1, s[4:7], s28 offen offset:3072 sc1
s_cmp_ge_u32 s19, s18
s_cbranch_scc1 L_ldr_fin
s_waitcnt vmcnt(16)
s_barrier
s_mov_b32 m0, s24
s_min_u32 s22, s20, s30
buffer_load_dwordx4 v1, s[4:7], s22 offen sc1 lds
buffer_load_dwordx4 v1, s[4:7], s22 offen offset:1024 sc1 lds
buffer_load_dwordx4 v1, s[4:7], s22 offen offset:2048 sc1 lds
buffer_load_dwordx4 v1, s[4:7], s22 offen offset:3072 sc1 lds
s_add_u32 s21, s24, 114688
s_and_b32 m0, s21, 0x1ffff
s_add_u32 s24, s24, 32768
s_min_u32 s21, s23, s31
buffer_load_dwordx4 v1, s[4:7], s21 offen sc1 lds
buffer_load_dwordx4 v1, s[4:7], s21 offen offset:1024 sc1 lds
buffer_load_dwordx4 v1, s[4:7], s21 offen offset:2048 sc1 lds
buffer_load_dwordx4 v1, s[4:7], s21 offen offset:3072 sc1 lds
s_and_b32 s24, s24, 0x1ffff
s_add_u32 s20, s20, 32768
s_add_u32 s23, s23, 32768
s_add_u32 s19, s19, 1
s_cmp_ge_u32 s19, s18
s_cbranch_scc1 L_ldr_fin
s_waitcnt vmcnt(16)
s_barrier
s_mov_b32 m0, s24
s_min_u32 s22, s20, s30
buffer_load_dwordx4 v1, s[4:7], s22 offen sc1 lds
buffer_load_dwordx4 v1, s[4:7], s22 offen offset:1024 sc1 lds
buffer_load_dwordx4 v1, s[4:7], s22 offen offset:2048 sc1 lds
buffer_load_dwordx4 v1, s[4:7], s22 offen offset:3072 sc1 lds
s_add_u32 s21, s24, 114688
s_and_b32 m0, s21, 0x1ffff
s_add_u32 s24, s24, 32768
s_min_u32 s21, s23, s31
buffer_load_dwordx4 v1, s[4:7], s21 offen sc1 lds
buffer_load_dwordx4 v1, s[4:7], s21 offen offset:1024 sc1 lds
buffer_load_dwordx4 v1, s[4:7], s21 offen offset:2048 sc1 lds
buffer_load_dwordx4 v1, s[4:7], s21 offen offset:3072 sc1 lds
s_and_b32 s24, s24, 0x1ffff
s_add_u32 s20, s20, 32768
s_add_u32 s23, s23, 32768
s_add_u32 s19, s19, 1
L_ldr_loop:
s_cmp_ge_u32 s19, s18
s_cbranch_scc1 L_ldr_fin
s_waitcnt vmcnt(8)
s_barrier
s_mov_b32 m0, s24
s_min_u32 s22, s20, s30
buffer_load_dwordx4 v1, s[4:7], s22 offen sc1 lds
buffer_load_dwordx4 v1, s[4:7], s22 offen offset:1024 sc1 lds
buffer_load_dwordx4 v1, s[4:7], s22 offen offset:2048 sc1 lds
buffer_load_dwordx4 v1, s[4:7], s22 offen offset:3072 sc1 lds
s_add_u32 s21, s24, 114688
s_and_b32 m0, s21, 0x1ffff
s_add_u32 s24, s24, 32768
s_min_u32 s21, s23, s31
buffer_load_dwordx4 v1, s[4:7], s21 offen sc1 lds
buffer_load_dwordx4 v1, s[4:7], s21 offen offset:1024 sc1 lds
buffer_load_dwordx4 v1, s[4:7], s21 offen offset:2048 sc1 lds
buffer_load_dwordx4 v1, s[4:7], s21 offen offset:3072 sc1 lds
s_and_b32 s24, s24, 0x1ffff
s_add_u32 s20, s20, 32768
s_add_u32 s23, s23, 32768
s_add_u32 s19, s19, 1
s_branch L_ldr_loop
L_ldr_fin:
s_waitcnt vmcnt(0)
s_barrier
s_lshr_b32 s21, s2, 3
s_lshl_b32 s21, s21, 2
s_add_u32 s21, s21, s13
s_lshl_b32 s21, s21, 15
s_and_b32 s22, s2, 1
s_lshl_b32 s22, s22, 9
s_add_u32 s21, s21, s22
v_lshrrev_b32 v5, 6, v1
v_lshlrev_b32 v5, 10, v5
v_bfe_u32 v6, v1, 4, 2
v_lshl_add_u32 v5, v6, 7, v5
s_mov_b32 s92, s84
s_mov_b32 s93, s85
s_mov_b32 s94, 0x400000
s_mov_b32 s95, 0x00020000
buffer_load_dword v7, v5, s[92:95], s21 offen
s_add_u32 s21, s21, 16384
buffer_load_dword v7, v5, s[92:95], s21 offen
s_branch L_k2_fin
L_slow_fL:
s_nop 15
s_nop 3
v_max3_f32 v6, v16, v17, v18
v_max3_f32 v6, v6, v19, v20
v_max3_f32 v6, v6, v21, v22
v_max3_f32 v6, v6, v23, v24
v_max3_f32 v6, v6, v25, v26
v_max3_f32 v6, v6, v27, v28
v_max3_f32 v6, v6, v29, v30
v_max_f32 v6, v6, v31
v_mov_b32 v7, v6
s_nop 1
v_permlane32_swap_b32 v6, v7
s_nop 1
v_max_f32 v6, v6, v7
v_max_f32 v6, 0, v6
v_sub_f32 v7, 0, v6
v_exp_f32 v7, v7
v_sub_f32 v48, v48, v6
v_sub_f32 v49, v49, v6
v_sub_f32 v50, v50, v6
v_sub_f32 v51, v51, v6
v_sub_f32 v52, v52, v6
v_sub_f32 v53, v53, v6
v_sub_f32 v54, v54, v6
v_sub_f32 v55, v55, v6
v_sub_f32 v56, v56, v6
v_sub_f32 v57, v57, v6
v_sub_f32 v58, v58, v6
v_sub_f32 v59, v59, v6
v_sub_f32 v60, v60, v6
v_sub_f32 v61, v61, v6
v_sub_f32 v62, v62, v6
v_sub_f32 v63, v63, v6
v_sub_f32 v16, v16, v6
v_sub_f32 v17, v17, v6
v_sub_f32 v18, v18, v6
v_sub_f32 v19, v19, v6
v_sub_f32 v20, v20, v6
v_sub_f32 v21, v21, v6
v_sub_f32 v22, v22, v6
v_sub_f32 v23, v23, v6
v_sub_f32 v24, v24, v6
v_sub_f32 v25, v25, v6
v_sub_f32 v26, v26, v6
v_sub_f32 v27, v27, v6
v_sub_f32 v28, v28, v6
v_sub_f32 v29, v29, v6
v_sub_f32 v30, v30, v6
v_sub_f32 v31, v31, v6
v_sub_f32 v32, v32, v6
v_sub_f32 v33, v33, v6
v_sub_f32 v34, v34, v6
v_sub_f32 v35, v35, v6
v_sub_f32 v36, v36, v6
v_sub_f32 v37, v37, v6
v_sub_f32 v38, v38, v6
v_sub_f32 v39, v39, v6
v_sub_f32 v40, v40, v6
v_sub_f32 v41, v41, v6
v_sub_f32 v42, v42, v6
v_sub_f32 v43, v43, v6
v_sub_f32 v44, v44, v6
v_sub_f32 v45, v45, v6
v_sub_f32 v46, v46, v6
v_sub_f32 v47, v47, v6
v_mul_f32 v64, v64, v7
v_mul_f32 v65, v65, v7
v_mul_f32 v66, v66, v7
v_mul_f32 v67, v67, v7
v_mul_f32 v68, v68, v7
v_mul_f32 v69, v69, v7
v_mul_f32 v70, v70, v7
v_mul_f32 v71, v71, v7
v_mul_f32 v72, v72, v7
v_mul_f32 v73, v73, v7
v_mul_f32 v74, v74, v7
v_mul_f32 v75, v75, v7
v_mul_f32 v76, v76, v7
v_mul_f32 v77, v77, v7
v_mul_f32 v78, v78, v7
v_mul_f32 v79, v79, v7
v_mul_f32 v80, v80, v7
v_mul_f32 v81, v81, v7
v_mul_f32 v82, v82, v7
v_mul_f32 v83, v83, v7
v_mul_f32 v84, v84, v7
v_mul_f32 v85, v85, v7
v_mul_f32 v86, v86, v7
v_mul_f32 v87, v87, v7
v_mul_f32 v88, v88, v7
v_mul_f32 v89, v89, v7
v_mul_f32 v90, v90, v7
v_mul_f32 v91, v91, v7
v_mul_f32 v92, v92, v7
v_mul_f32 v93, v93, v7
v_mul_f32 v94, v94, v7
v_mul_f32 v95, v95, v7
v_mul_f32 v96, v96, v7
v_mul_f32 v97, v97, v7
v_mul_f32 v98, v98, v7
v_mul_f32 v99, v99, v7
v_mul_f32 v100, v100, v7
v_mul_f32 v101, v101, v7
v_mul_f32 v102, v102, v7
v_mul_f32 v103, v103, v7
v_mul_f32 v104, v104, v7
v_mul_f32 v105, v105, v7
v_mul_f32 v106, v106, v7
v_mul_f32 v107, v107, v7
v_mul_f32 v108, v108, v7
v_mul_f32 v109, v109, v7
v_mul_f32 v110, v110, v7
v_mul_f32 v111, v111, v7
v_mul_f32 v112, v112, v7
v_mul_f32 v113, v113, v7
v_mul_f32 v114, v114, v7
v_mul_f32 v115, v115, v7
v_mul_f32 v116, v116, v7
v_mul_f32 v117, v117, v7
v_mul_f32 v118, v118, v7
v_mul_f32 v119, v119, v7
v_mul_f32 v120, v120, v7
v_mul_f32 v121, v121, v7
v_mul_f32 v122, v122, v7
v_mul_f32 v123, v123, v7
v_mul_f32 v124, v124, v7
v_mul_f32 v125, v125, v7
v_mul_f32 v126, v126, v7
v_mul_f32 v127, v127, v7
v_mul_f32 v4, v4, v7
v_exp_f32 v208, v16
v_exp_f32 v209, v17
v_exp_f32 v210, v18
v_exp_f32 v211, v19
v_add_f32 v9, v208, v210
v_add_f32 v11, v209, v211
v_exp_f32 v212, v20
v_exp_f32 v213, v21
v_add_f32 v9, v9, v212
v_add_f32 v11, v11, v213
v_exp_f32 v214, v22
v_exp_f32 v215, v23
v_add_f32 v9, v9, v214
v_add_f32 v11, v11, v215
v_cvt_pk_bf16_f32 v192, v208, v209
v_exp_f32 v208, v24
v_exp_f32 v209, v25
v_add_f32 v9, v9, v208
v_add_f32 v11, v11, v209
v_cvt_pk_bf16_f32 v193, v210, v211
v_exp_f32 v210, v26
v_exp_f32 v211, v27
v_add_f32 v9, v9, v210
v_add_f32 v11, v11, v211
v_cvt_pk_bf16_f32 v194, v212, v213
v_exp_f32 v212, v28
v_exp_f32 v213, v29
v_add_f32 v9, v9, v212
v_add_f32 v11, v11, v213
v_cvt_pk_bf16_f32 v195, v214, v215
v_exp_f32 v214, v30
v_exp_f32 v215, v31
v_add_f32 v9, v9, v214
v_add_f32 v11, v11, v215
v_add_f32 v13, v9, v11
v_cvt_pk_bf16_f32 v196, v208, v209
v_cvt_pk_bf16_f32 v197, v210, v211
v_cvt_pk_bf16_f32 v198, v212, v213
v_cvt_pk_bf16_f32 v199, v214, v215
s_nop 7
s_branch L_back_fL
L_slow_oL:
s_nop 15
s_nop 3
v_max3_f32 v6, v32, v33, v34
v_max3_f32 v6, v6, v35, v36
v_max3_f32 v6, v6, v37, v38
v_max3_f32 v6, v6, v39, v40
v_max3_f32 v6, v6, v41, v42
v_max3_f32 v6, v6, v43, v44
v_max3_f32 v6, v6, v45, v46
v_max_f32 v6, v6, v47
v_mov_b32 v7, v6
s_nop 1
v_permlane32_swap_b32 v6, v7
s_nop 1
v_max_f32 v6, v6, v7
v_max_f32 v6, 0, v6
v_sub_f32 v7, 0, v6
v_exp_f32 v7, v7
v_sub_f32 v48, v48, v6
v_sub_f32 v49, v49, v6
v_sub_f32 v50, v50, v6
v_sub_f32 v51, v51, v6
v_sub_f32 v52, v52, v6
v_sub_f32 v53, v53, v6
v_sub_f32 v54, v54, v6
v_sub_f32 v55, v55, v6
v_sub_f32 v56, v56, v6
v_sub_f32 v57, v57, v6
v_sub_f32 v58, v58, v6
v_sub_f32 v59, v59, v6
v_sub_f32 v60, v60, v6
v_sub_f32 v61, v61, v6
v_sub_f32 v62, v62, v6
v_sub_f32 v63, v63, v6
v_sub_f32 v32, v32, v6
v_sub_f32 v33, v33, v6
v_sub_f32 v34, v34, v6
v_sub_f32 v35, v35, v6
v_sub_f32 v36, v36, v6
v_sub_f32 v37, v37, v6
v_sub_f32 v38, v38, v6
v_sub_f32 v39, v39, v6
v_sub_f32 v40, v40, v6
v_sub_f32 v41, v41, v6
v_sub_f32 v42, v42, v6
v_sub_f32 v43, v43, v6
v_sub_f32 v44, v44, v6
v_sub_f32 v45, v45, v6
v_sub_f32 v46, v46, v6
v_sub_f32 v47, v47, v6
v_sub_f32 v16, v16, v6
v_sub_f32 v17, v17, v6
v_sub_f32 v18, v18, v6
v_sub_f32 v19, v19, v6
v_sub_f32 v20, v20, v6
v_sub_f32 v21, v21, v6
v_sub_f32 v22, v22, v6
v_sub_f32 v23, v23, v6
v_sub_f32 v24, v24, v6
v_sub_f32 v25, v25, v6
v_sub_f32 v26, v26, v6
v_sub_f32 v27, v27, v6
v_sub_f32 v28, v28, v6
v_sub_f32 v29, v29, v6
v_sub_f32 v30, v30, v6
v_sub_f32 v31, v31, v6
v_mul_f32 v64, v64, v7
v_mul_f32 v65, v65, v7
v_mul_f32 v66, v66, v7
v_mul_f32 v67, v67, v7
v_mul_f32 v68, v68, v7
v_mul_f32 v69, v69, v7
v_mul_f32 v70, v70, v7
v_mul_f32 v71, v71, v7
v_mul_f32 v72, v72, v7
v_mul_f32 v73, v73, v7
v_mul_f32 v74, v74, v7
v_mul_f32 v75, v75, v7
v_mul_f32 v76, v76, v7
v_mul_f32 v77, v77, v7
v_mul_f32 v78, v78, v7
v_mul_f32 v79, v79, v7
v_mul_f32 v80, v80, v7
v_mul_f32 v81, v81, v7
v_mul_f32 v82, v82, v7
v_mul_f32 v83, v83, v7
v_mul_f32 v84, v84, v7
v_mul_f32 v85, v85, v7
v_mul_f32 v86, v86, v7
v_mul_f32 v87, v87, v7
v_mul_f32 v88, v88, v7
v_mul_f32 v89, v89, v7
v_mul_f32 v90, v90, v7
v_mul_f32 v91, v91, v7
v_mul_f32 v92, v92, v7
v_mul_f32 v93, v93, v7
v_mul_f32 v94, v94, v7
v_mul_f32 v95, v95, v7
v_mul_f32 v96, v96, v7
v_mul_f32 v97, v97, v7
v_mul_f32 v98, v98, v7
v_mul_f32 v99, v99, v7
v_mul_f32 v100, v100, v7
v_mul_f32 v101, v101, v7
v_mul_f32 v102, v102, v7
v_mul_f32 v103, v103, v7
v_mul_f32 v104, v104, v7
v_mul_f32 v105, v105, v7
v_mul_f32 v106, v106, v7
v_mul_f32 v107, v107, v7
v_mul_f32 v108, v108, v7
v_mul_f32 v109, v109, v7
v_mul_f32 v110, v110, v7
v_mul_f32 v111, v111, v7
v_mul_f32 v112, v112, v7
v_mul_f32 v113, v113, v7
v_mul_f32 v114, v114, v7
v_mul_f32 v115, v115, v7
v_mul_f32 v116, v116, v7
v_mul_f32 v117, v117, v7
v_mul_f32 v118, v118, v7
v_mul_f32 v119, v119, v7
v_mul_f32 v120, v120, v7
v_mul_f32 v121, v121, v7
v_mul_f32 v122, v122, v7
v_mul_f32 v123, v123, v7
v_mul_f32 v124, v124, v7
v_mul_f32 v125, v125, v7
v_mul_f32 v126, v126, v7
v_mul_f32 v127, v127, v7
v_mul_f32 v4, v4, v7
v_exp_f32 v208, v32
v_exp_f32 v209, v33
v_exp_f32 v210, v34
v_exp_f32 v211, v35
v_add_f32 v10, v208, v210
v_add_f32 v12, v209, v211
v_exp_f32 v212, v36
v_exp_f32 v213, v37
v_add_f32 v10, v10, v212
v_add_f32 v12, v12, v213
v_exp_f32 v214, v38
v_exp_f32 v215, v39
v_add_f32 v10, v10, v214
v_add_f32 v12, v12, v215
v_cvt_pk_bf16_f32 v200, v208, v209
v_exp_f32 v208, v40
v_exp_f32 v209, v41
v_add_f32 v10, v10, v208
v_add_f32 v12, v12, v209
v_cvt_pk_bf16_f32 v201, v210, v211
v_exp_f32 v210, v42
v_exp_f32 v211, v43
v_add_f32 v10, v10, v210
v_add_f32 v12, v12, v211
v_cvt_pk_bf16_f32 v202, v212, v213
v_exp_f32 v212, v44
v_exp_f32 v213, v45
v_add_f32 v10, v10, v212
v_add_f32 v12, v12, v213
v_cvt_pk_bf16_f32 v203, v214, v215
v_exp_f32 v214, v46
v_exp_f32 v215, v47
v_add_f32 v10, v10, v214
v_add_f32 v12, v12, v215
v_add_f32 v13, v10, v12
v_cvt_pk_bf16_f32 v204, v208, v209
v_cvt_pk_bf16_f32 v205, v210, v211
v_cvt_pk_bf16_f32 v206, v212, v213
v_cvt_pk_bf16_f32 v207, v214, v215
s_nop 7
s_branch L_back_oL
L_slow_eL:
s_nop 15
s_nop 3
v_max3_f32 v6, v16, v17, v18
v_max3_f32 v6, v6, v19, v20
v_max3_f32 v6, v6, v21, v22
v_max3_f32 v6, v6, v23, v24
v_max3_f32 v6, v6, v25, v26
v_max3_f32 v6, v6, v27, v28
v_max3_f32 v6, v6, v29, v30
v_max_f32 v6, v6, v31
v_mov_b32 v7, v6
s_nop 1
v_permlane32_swap_b32 v6, v7
s_nop 1
v_max_f32 v6, v6, v7
v_max_f32 v6, 0, v6
v_sub_f32 v7, 0, v6
v_exp_f32 v7, v7
v_sub_f32 v48, v48, v6
v_sub_f32 v49, v49, v6
v_sub_f32 v50, v50, v6
v_sub_f32 v51, v51, v6
v_sub_f32 v52, v52, v6
v_sub_f32 v53, v53, v6
v_sub_f32 v54, v54, v6
v_sub_f32 v55, v55, v6
v_sub_f32 v56, v56, v6
v_sub_f32 v57, v57, v6
v_sub_f32 v58, v58, v6
v_sub_f32 v59, v59, v6
v_sub_f32 v60, v60, v6
v_sub_f32 v61, v61, v6
v_sub_f32 v62, v62, v6
v_sub_f32 v63, v63, v6
v_sub_f32 v16, v16, v6
v_sub_f32 v17, v17, v6
v_sub_f32 v18, v18, v6
v_sub_f32 v19, v19, v6
v_sub_f32 v20, v20, v6
v_sub_f32 v21, v21, v6
v_sub_f32 v22, v22, v6
v_sub_f32 v23, v23, v6
v_sub_f32 v24, v24, v6
v_sub_f32 v25, v25, v6
v_sub_f32 v26, v26, v6
v_sub_f32 v27, v27, v6
v_sub_f32 v28, v28, v6
v_sub_f32 v29, v29, v6
v_sub_f32 v30, v30, v6
v_sub_f32 v31, v31, v6
v_sub_f32 v32, v32, v6
v_sub_f32 v33, v33, v6
v_sub_f32 v34, v34, v6
v_sub_f32 v35, v35, v6
v_sub_f32 v36, v36, v6
v_sub_f32 v37, v37, v6
v_sub_f32 v38, v38, v6
v_sub_f32 v39, v39, v6
v_sub_f32 v40, v40, v6
v_sub_f32 v41, v41, v6
v_sub_f32 v42, v42, v6
v_sub_f32 v43, v43, v6
v_sub_f32 v44, v44, v6
v_sub_f32 v45, v45, v6
v_sub_f32 v46, v46, v6
v_sub_f32 v47, v47, v6
v_mul_f32 v64, v64, v7
v_mul_f32 v65, v65, v7
v_mul_f32 v66, v66, v7
v_mul_f32 v67, v67, v7
v_mul_f32 v68, v68, v7
v_mul_f32 v69, v69, v7
v_mul_f32 v70, v70, v7
v_mul_f32 v71, v71, v7
v_mul_f32 v72, v72, v7
v_mul_f32 v73, v73, v7
v_mul_f32 v74, v74, v7
v_mul_f32 v75, v75, v7
v_mul_f32 v76, v76, v7
v_mul_f32 v77, v77, v7
v_mul_f32 v78, v78, v7
v_mul_f32 v79, v79, v7
v_mul_f32 v80, v80, v7
v_mul_f32 v81, v81, v7
v_mul_f32 v82, v82, v7
v_mul_f32 v83, v83, v7
v_mul_f32 v84, v84, v7
v_mul_f32 v85, v85, v7
v_mul_f32 v86, v86, v7
v_mul_f32 v87, v87, v7
v_mul_f32 v88, v88, v7
v_mul_f32 v89, v89, v7
v_mul_f32 v90, v90, v7
v_mul_f32 v91, v91, v7
v_mul_f32 v92, v92, v7
v_mul_f32 v93, v93, v7
v_mul_f32 v94, v94, v7
v_mul_f32 v95, v95, v7
v_mul_f32 v96, v96, v7
v_mul_f32 v97, v97, v7
v_mul_f32 v98, v98, v7
v_mul_f32 v99, v99, v7
v_mul_f32 v100, v100, v7
v_mul_f32 v101, v101, v7
v_mul_f32 v102, v102, v7
v_mul_f32 v103, v103, v7
v_mul_f32 v104, v104, v7
v_mul_f32 v105, v105, v7
v_mul_f32 v106, v106, v7
v_mul_f32 v107, v107, v7
v_mul_f32 v108, v108, v7
v_mul_f32 v109, v109, v7
v_mul_f32 v110, v110, v7
v_mul_f32 v111, v111, v7
v_mul_f32 v112, v112, v7
v_mul_f32 v113, v113, v7
v_mul_f32 v114, v114, v7
v_mul_f32 v115, v115, v7
v_mul_f32 v116, v116, v7
v_mul_f32 v117, v117, v7
v_mul_f32 v118, v118, v7
v_mul_f32 v119, v119, v7
v_mul_f32 v120, v120, v7
v_mul_f32 v121, v121, v7
v_mul_f32 v122, v122, v7
v_mul_f32 v123, v123, v7
v_mul_f32 v124, v124, v7
v_mul_f32 v125, v125, v7
v_mul_f32 v126, v126, v7
v_mul_f32 v127, v127, v7
v_mul_f32 v4, v4, v7
v_exp_f32 v208, v16
v_exp_f32 v209, v17
v_exp_f32 v210, v18
v_exp_f32 v211, v19
v_add_f32 v9, v208, v210
v_add_f32 v11, v209, v211
v_exp_f32 v212, v20
v_exp_f32 v213, v21
v_add_f32 v9, v9, v212
v_add_f32 v11, v11, v213
v_exp_f32 v214, v22
v_exp_f32 v215, v23
v_add_f32 v9, v9, v214
v_add_f32 v11, v11, v215
v_cvt_pk_bf16_f32 v192, v208, v209
v_exp_f32 v208, v24
v_exp_f32 v209, v25
v_add_f32 v9, v9, v208
v_add_f32 v11, v11, v209
v_cvt_pk_bf16_f32 v193, v210, v211
v_exp_f32 v210, v26
v_exp_f32 v211, v27
v_add_f32 v9, v9, v210
v_add_f32 v11, v11, v211
v_cvt_pk_bf16_f32 v194, v212, v213
v_exp_f32 v212, v28
v_exp_f32 v213, v29
v_add_f32 v9, v9, v212
v_add_f32 v11, v11, v213
v_cvt_pk_bf16_f32 v195, v214, v215
v_exp_f32 v214, v30
v_exp_f32 v215, v31
v_add_f32 v9, v9, v214
v_add_f32 v11, v11, v215
v_add_f32 v13, v9, v11
v_cvt_pk_bf16_f32 v196, v208, v209
v_cvt_pk_bf16_f32 v197, v210, v211
v_cvt_pk_bf16_f32 v198, v212, v213
v_cvt_pk_bf16_f32 v199, v214, v215
s_nop 7
s_branch L_back_eL
L_slow_l1L:
s_nop 15
s_nop 3
v_max3_f32 v6, v32, v33, v34
v_max3_f32 v6, v6, v35, v36
v_max3_f32 v6, v6, v37, v38
v_max3_f32 v6, v6, v39, v40
v_max3_f32 v6, v6, v41, v42
v_max3_f32 v6, v6, v43, v44
v_max3_f32 v6, v6, v45, v46
v_max_f32 v6, v6, v47
v_mov_b32 v7, v6
s_nop 1
v_permlane32_swap_b32 v6, v7
s_nop 1
v_max_f32 v6, v6, v7
v_max_f32 v6, 0, v6
v_sub_f32 v7, 0, v6
v_exp_f32 v7, v7
v_sub_f32 v48, v48, v6
v_sub_f32 v49, v49, v6
v_sub_f32 v50, v50, v6
v_sub_f32 v51, v51, v6
v_sub_f32 v52, v52, v6
v_sub_f32 v53, v53, v6
v_sub_f32 v54, v54, v6
v_sub_f32 v55, v55, v6
v_sub_f32 v56, v56, v6
v_sub_f32 v57, v57, v6
v_sub_f32 v58, v58, v6
v_sub_f32 v59, v59, v6
v_sub_f32 v60, v60, v6
v_sub_f32 v61, v61, v6
v_sub_f32 v62, v62, v6
v_sub_f32 v63, v63, v6
v_sub_f32 v32, v32, v6
v_sub_f32 v33, v33, v6
v_sub_f32 v34, v34, v6
v_sub_f32 v35, v35, v6
v_sub_f32 v36, v36, v6
v_sub_f32 v37, v37, v6
v_sub_f32 v38, v38, v6
v_sub_f32 v39, v39, v6
v_sub_f32 v40, v40, v6
v_sub_f32 v41, v41, v6
v_sub_f32 v42, v42, v6
v_sub_f32 v43, v43, v6
v_sub_f32 v44, v44, v6
v_sub_f32 v45, v45, v6
v_sub_f32 v46, v46, v6
v_sub_f32 v47, v47, v6
v_mul_f32 v64, v64, v7
v_mul_f32 v65, v65, v7
v_mul_f32 v66, v66, v7
v_mul_f32 v67, v67, v7
v_mul_f32 v68, v68, v7
v_mul_f32 v69, v69, v7
v_mul_f32 v70, v70, v7
v_mul_f32 v71, v71, v7
v_mul_f32 v72, v72, v7
v_mul_f32 v73, v73, v7
v_mul_f32 v74, v74, v7
v_mul_f32 v75, v75, v7
v_mul_f32 v76, v76, v7
v_mul_f32 v77, v77, v7
v_mul_f32 v78, v78, v7
v_mul_f32 v79, v79, v7
v_mul_f32 v80, v80, v7
v_mul_f32 v81, v81, v7
v_mul_f32 v82, v82, v7
v_mul_f32 v83, v83, v7
v_mul_f32 v84, v84, v7
v_mul_f32 v85, v85, v7
v_mul_f32 v86, v86, v7
v_mul_f32 v87, v87, v7
v_mul_f32 v88, v88, v7
v_mul_f32 v89, v89, v7
v_mul_f32 v90, v90, v7
v_mul_f32 v91, v91, v7
v_mul_f32 v92, v92, v7
v_mul_f32 v93, v93, v7
v_mul_f32 v94, v94, v7
v_mul_f32 v95, v95, v7
v_mul_f32 v96, v96, v7
v_mul_f32 v97, v97, v7
v_mul_f32 v98, v98, v7
v_mul_f32 v99, v99, v7
v_mul_f32 v100, v100, v7
v_mul_f32 v101, v101, v7
v_mul_f32 v102, v102, v7
v_mul_f32 v103, v103, v7
v_mul_f32 v104, v104, v7
v_mul_f32 v105, v105, v7
v_mul_f32 v106, v106, v7
v_mul_f32 v107, v107, v7
v_mul_f32 v108, v108, v7
v_mul_f32 v109, v109, v7
v_mul_f32 v110, v110, v7
v_mul_f32 v111, v111, v7
v_mul_f32 v112, v112, v7
v_mul_f32 v113, v113, v7
v_mul_f32 v114, v114, v7
v_mul_f32 v115, v115, v7
v_mul_f32 v116, v116, v7
v_mul_f32 v117, v117, v7
v_mul_f32 v118, v118, v7
v_mul_f32 v119, v119, v7
v_mul_f32 v120, v120, v7
v_mul_f32 v121, v121, v7
v_mul_f32 v122, v122, v7
v_mul_f32 v123, v123, v7
v_mul_f32 v124, v124, v7
v_mul_f32 v125, v125, v7
v_mul_f32 v126, v126, v7
v_mul_f32 v127, v127, v7
v_mul_f32 v4, v4, v7
v_exp_f32 v208, v32
v_exp_f32 v209, v33
v_exp_f32 v210, v34
v_exp_f32 v211, v35
v_add_f32 v10, v208, v210
v_add_f32 v12, v209, v211
v_exp_f32 v212, v36
v_exp_f32 v213, v37
v_add_f32 v10, v10, v212
v_add_f32 v12, v12, v213
v_exp_f32 v214, v38
v_exp_f32 v215, v39
v_add_f32 v10, v10, v214
v_add_f32 v12, v12, v215
v_cvt_pk_bf16_f32 v200, v208, v209
v_exp_f32 v208, v40
v_exp_f32 v209, v41
v_add_f32 v10, v10, v208
v_add_f32 v12, v12, v209
v_cvt_pk_bf16_f32 v201, v210, v211
v_exp_f32 v210, v42
v_exp_f32 v211, v43
v_add_f32 v10, v10, v210
v_add_f32 v12, v12, v211
v_cvt_pk_bf16_f32 v202, v212, v213
v_exp_f32 v212, v44
v_exp_f32 v213, v45
v_add_f32 v10, v10, v212
v_add_f32 v12, v12, v213
v_cvt_pk_bf16_f32 v203, v214, v215
v_exp_f32 v214, v46
v_exp_f32 v215, v47
v_add_f32 v10, v10, v214
v_add_f32 v12, v12, v215
v_add_f32 v13, v10, v12
v_cvt_pk_bf16_f32 v204, v208, v209
v_cvt_pk_bf16_f32 v205, v210, v211
v_cvt_pk_bf16_f32 v206, v212, v213
v_cvt_pk_bf16_f32 v207, v214, v215
s_nop 7
s_branch L_back_l1L
L_slow_l0L:
s_nop 15
s_nop 3
v_max3_f32 v6, v16, v17, v18
v_max3_f32 v6, v6, v19, v20
v_max3_f32 v6, v6, v21, v22
v_max3_f32 v6, v6, v23, v24
v_max3_f32 v6, v6, v25, v26
v_max3_f32 v6, v6, v27, v28
v_max3_f32 v6, v6, v29, v30
v_max_f32 v6, v6, v31
v_mov_b32 v7, v6
s_nop 1
v_permlane32_swap_b32 v6, v7
s_nop 1
v_max_f32 v6, v6, v7
v_max_f32 v6, 0, v6
v_sub_f32 v7, 0, v6
v_exp_f32 v7, v7
v_sub_f32 v48, v48, v6
v_sub_f32 v49, v49, v6
v_sub_f32 v50, v50, v6
v_sub_f32 v51, v51, v6
v_sub_f32 v52, v52, v6
v_sub_f32 v53, v53, v6
v_sub_f32 v54, v54, v6
v_sub_f32 v55, v55, v6
v_sub_f32 v56, v56, v6
v_sub_f32 v57, v57, v6
v_sub_f32 v58, v58, v6
v_sub_f32 v59, v59, v6
v_sub_f32 v60, v60, v6
v_sub_f32 v61, v61, v6
v_sub_f32 v62, v62, v6
v_sub_f32 v63, v63, v6
v_sub_f32 v16, v16, v6
v_sub_f32 v17, v17, v6
v_sub_f32 v18, v18, v6
v_sub_f32 v19, v19, v6
v_sub_f32 v20, v20, v6
v_sub_f32 v21, v21, v6
v_sub_f32 v22, v22, v6
v_sub_f32 v23, v23, v6
v_sub_f32 v24, v24, v6
v_sub_f32 v25, v25, v6
v_sub_f32 v26, v26, v6
v_sub_f32 v27, v27, v6
v_sub_f32 v28, v28, v6
v_sub_f32 v29, v29, v6
v_sub_f32 v30, v30, v6
v_sub_f32 v31, v31, v6
v_mul_f32 v64, v64, v7
v_mul_f32 v65, v65, v7
v_mul_f32 v66, v66, v7
v_mul_f32 v67, v67, v7
v_mul_f32 v68, v68, v7
v_mul_f32 v69, v69, v7
v_mul_f32 v70, v70, v7
v_mul_f32 v71, v71, v7
v_mul_f32 v72, v72, v7
v_mul_f32 v73, v73, v7
v_mul_f32 v74, v74, v7
v_mul_f32 v75, v75, v7
v_mul_f32 v76, v76, v7
v_mul_f32 v77, v77, v7
v_mul_f32 v78, v78, v7
v_mul_f32 v79, v79, v7
v_mul_f32 v80, v80, v7
v_mul_f32 v81, v81, v7
v_mul_f32 v82, v82, v7
v_mul_f32 v83, v83, v7
v_mul_f32 v84, v84, v7
v_mul_f32 v85, v85, v7
v_mul_f32 v86, v86, v7
v_mul_f32 v87, v87, v7
v_mul_f32 v88, v88, v7
v_mul_f32 v89, v89, v7
v_mul_f32 v90, v90, v7
v_mul_f32 v91, v91, v7
v_mul_f32 v92, v92, v7
v_mul_f32 v93, v93, v7
v_mul_f32 v94, v94, v7
v_mul_f32 v95, v95, v7
v_mul_f32 v96, v96, v7
v_mul_f32 v97, v97, v7
v_mul_f32 v98, v98, v7
v_mul_f32 v99, v99, v7
v_mul_f32 v100, v100, v7
v_mul_f32 v101, v101, v7
v_mul_f32 v102, v102, v7
v_mul_f32 v103, v103, v7
v_mul_f32 v104, v104, v7
v_mul_f32 v105, v105, v7
v_mul_f32 v106, v106, v7
v_mul_f32 v107, v107, v7
v_mul_f32 v108, v108, v7
v_mul_f32 v109, v109, v7
v_mul_f32 v110, v110, v7
v_mul_f32 v111, v111, v7
v_mul_f32 v112, v112, v7
v_mul_f32 v113, v113, v7
v_mul_f32 v114, v114, v7
v_mul_f32 v115, v115, v7
v_mul_f32 v116, v116, v7
v_mul_f32 v117, v117, v7
v_mul_f32 v118, v118, v7
v_mul_f32 v119, v119, v7
v_mul_f32 v120, v120, v7
v_mul_f32 v121, v121, v7
v_mul_f32 v122, v122, v7
v_mul_f32 v123, v123, v7
v_mul_f32 v124, v124, v7
v_mul_f32 v125, v125, v7
v_mul_f32 v126, v126, v7
v_mul_f32 v127, v127, v7
v_mul_f32 v4, v4, v7
v_exp_f32 v208, v16
v_exp_f32 v209, v17
v_exp_f32 v210, v18
v_exp_f32 v211, v19
v_add_f32 v9, v208, v210
v_add_f32 v11, v209, v211
v_exp_f32 v212, v20
v_exp_f32 v213, v21
v_add_f32 v9, v9, v212
v_add_f32 v11, v11, v213
v_exp_f32 v214, v22
v_exp_f32 v215, v23
v_add_f32 v9, v9, v214
v_add_f32 v11, v11, v215
v_cvt_pk_bf16_f32 v192, v208, v209
v_exp_f32 v208, v24
v_exp_f32 v209, v25
v_add_f32 v9, v9, v208
v_add_f32 v11, v11, v209
v_cvt_pk_bf16_f32 v193, v210, v211
v_exp_f32 v210, v26
v_exp_f32 v211, v27
v_add_f32 v9, v9, v210
v_add_f32 v11, v11, v211
v_cvt_pk_bf16_f32 v194, v212, v213
v_exp_f32 v212, v28
v_exp_f32 v213, v29
v_add_f32 v9, v9, v212
v_add_f32 v11, v11, v213
v_cvt_pk_bf16_f32 v195, v214, v215
v_exp_f32 v214, v30
v_exp_f32 v215, v31
v_add_f32 v9, v9, v214
v_add_f32 v11, v11, v215
v_add_f32 v13, v9, v11
v_cvt_pk_bf16_f32 v196, v208, v209
v_cvt_pk_bf16_f32 v197, v210, v211
v_cvt_pk_bf16_f32 v198, v212, v213
v_cvt_pk_bf16_f32 v199, v214, v215
s_nop 7
s_branch L_back_l0L
L_slow_fS:
s_nop 15
s_nop 3
v_max3_f32 v6, v16, v17, v18
v_max3_f32 v6, v6, v19, v20
v_max3_f32 v6, v6, v21, v22
v_max3_f32 v6, v6, v23, v24
v_max3_f32 v6, v6, v25, v26
v_max3_f32 v6, v6, v27, v28
v_max3_f32 v6, v6, v29, v30
v_max_f32 v6, v6, v31
v_mov_b32 v7, v6
s_nop 1
v_permlane32_swap_b32 v6, v7
s_nop 1
v_max_f32 v6, v6, v7
v_max_f32 v6, 0, v6
v_sub_f32 v7, 0, v6
v_exp_f32 v7, v7
v_sub_f32 v48, v48, v6
v_sub_f32 v49, v49, v6
v_sub_f32 v50, v50, v6
v_sub_f32 v51, v51, v6
v_sub_f32 v52, v52, v6
v_sub_f32 v53, v53, v6
v_sub_f32 v54, v54, v6
v_sub_f32 v55, v55, v6
v_sub_f32 v56, v56, v6
v_sub_f32 v57, v57, v6
v_sub_f32 v58, v58, v6
v_sub_f32 v59, v59, v6
v_sub_f32 v60, v60, v6
v_sub_f32 v61, v61, v6
v_sub_f32 v62, v62, v6
v_sub_f32 v63, v63, v6
v_sub_f32 v16, v16, v6
v_sub_f32 v17, v17, v6
v_sub_f32 v18, v18, v6
v_sub_f32 v19, v19, v6
v_sub_f32 v20, v20, v6
v_sub_f32 v21, v21, v6
v_sub_f32 v22, v22, v6
v_sub_f32 v23, v23, v6
v_sub_f32 v24, v24, v6
v_sub_f32 v25, v25, v6
v_sub_f32 v26, v26, v6
v_sub_f32 v27, v27, v6
v_sub_f32 v28, v28, v6
v_sub_f32 v29, v29, v6
v_sub_f32 v30, v30, v6
v_sub_f32 v31, v31, v6
v_sub_f32 v32, v32, v6
v_sub_f32 v33, v33, v6
v_sub_f32 v34, v34, v6
v_sub_f32 v35, v35, v6
v_sub_f32 v36, v36, v6
v_sub_f32 v37, v37, v6
v_sub_f32 v38, v38, v6
v_sub_f32 v39, v39, v6
v_sub_f32 v40, v40, v6
v_sub_f32 v41, v41, v6
v_sub_f32 v42, v42, v6
v_sub_f32 v43, v43, v6
v_sub_f32 v44, v44, v6
v_sub_f32 v45, v45, v6
v_sub_f32 v46, v46, v6
v_sub_f32 v47, v47, v6
v_mul_f32 v64, v64, v7
v_mul_f32 v65, v65, v7
v_mul_f32 v66, v66, v7
v_mul_f32 v67, v67, v7
v_mul_f32 v68, v68, v7
v_mul_f32 v69, v69, v7
v_mul_f32 v70, v70, v7
v_mul_f32 v71, v71, v7
v_mul_f32 v72, v72, v7
v_mul_f32 v73, v73, v7
v_mul_f32 v74, v74, v7
v_mul_f32 v75, v75, v7
v_mul_f32 v76, v76, v7
v_mul_f32 v77, v77, v7
v_mul_f32 v78, v78, v7
v_mul_f32 v79, v79, v7
v_mul_f32 v80, v80, v7
v_mul_f32 v81, v81, v7
v_mul_f32 v82, v82, v7
v_mul_f32 v83, v83, v7
v_mul_f32 v84, v84, v7
v_mul_f32 v85, v85, v7
v_mul_f32 v86, v86, v7
v_mul_f32 v87, v87, v7
v_mul_f32 v88, v88, v7
v_mul_f32 v89, v89, v7
v_mul_f32 v90, v90, v7
v_mul_f32 v91, v91, v7
v_mul_f32 v92, v92, v7
v_mul_f32 v93, v93, v7
v_mul_f32 v94, v94, v7
v_mul_f32 v95, v95, v7
v_mul_f32 v96, v96, v7
v_mul_f32 v97, v97, v7
v_mul_f32 v98, v98, v7
v_mul_f32 v99, v99, v7
v_mul_f32 v100, v100, v7
v_mul_f32 v101, v101, v7
v_mul_f32 v102, v102, v7
v_mul_f32 v103, v103, v7
v_mul_f32 v104, v104, v7
v_mul_f32 v105, v105, v7
v_mul_f32 v106, v106, v7
v_mul_f32 v107, v107, v7
v_mul_f32 v108, v108, v7
v_mul_f32 v109, v109, v7
v_mul_f32 v110, v110, v7
v_mul_f32 v111, v111, v7
v_mul_f32 v112, v112, v7
v_mul_f32 v113, v113, v7
v_mul_f32 v114, v114, v7
v_mul_f32 v115, v115, v7
v_mul_f32 v116, v116, v7
v_mul_f32 v117, v117, v7
v_mul_f32 v118, v118, v7
v_mul_f32 v119, v119, v7
v_mul_f32 v120, v120, v7
v_mul_f32 v121, v121, v7
v_mul_f32 v122, v122, v7
v_mul_f32 v123, v123, v7
v_mul_f32 v124, v124, v7
v_mul_f32 v125, v125, v7
v_mul_f32 v126, v126, v7
v_mul_f32 v127, v127, v7
v_mul_f32 v4, v4, v7
v_exp_f32 v208, v16
v_exp_f32 v209, v17
v_exp_f32 v210, v18
v_exp_f32 v211, v19
v_add_f32 v9, v208, v210
v_add_f32 v11, v209, v211
v_exp_f32 v212, v20
v_exp_f32 v213, v21
v_add_f32 v9, v9, v212
v_add_f32 v11, v11, v213
v_exp_f32 v214, v22
v_exp_f32 v215, v23
v_add_f32 v9, v9, v214
v_add_f32 v11, v11, v215
v_cvt_pk_bf16_f32 v192, v208, v209
v_exp_f32 v208, v24
v_exp_f32 v209, v25
v_add_f32 v9, v9, v208
v_add_f32 v11, v11, v209
v_cvt_pk_bf16_f32 v193, v210, v211
v_exp_f32 v210, v26
v_exp_f32 v211, v27
v_add_f32 v9, v9, v210
v_add_f32 v11, v11, v211
v_cvt_pk_bf16_f32 v194, v212, v213
v_exp_f32 v212, v28
v_exp_f32 v213, v29
v_add_f32 v9, v9, v212
v_add_f32 v11, v11, v213
v_cvt_pk_bf16_f32 v195, v214, v215
v_exp_f32 v214, v30
v_exp_f32 v215, v31
v_add_f32 v9, v9, v214
v_add_f32 v11, v11, v215
v_add_f32 v13, v9, v11
v_cvt_pk_bf16_f32 v196, v208, v209
v_cvt_pk_bf16_f32 v197, v210, v211
v_cvt_pk_bf16_f32 v198, v212, v213
v_cvt_pk_bf16_f32 v199, v214, v215
s_nop 7
s_branch L_back_fS
L_slow_oS:
s_nop 15
s_nop 3
v_max3_f32 v6, v32, v33, v34
v_max3_f32 v6, v6, v35, v36
v_max3_f32 v6, v6, v37, v38
v_max3_f32 v6, v6, v39, v40
v_max3_f32 v6, v6, v41, v42
v_max3_f32 v6, v6, v43, v44
v_max3_f32 v6, v6, v45, v46
v_max_f32 v6, v6, v47
v_mov_b32 v7, v6
s_nop 1
v_permlane32_swap_b32 v6, v7
s_nop 1
v_max_f32 v6, v6, v7
v_max_f32 v6, 0, v6
v_sub_f32 v7, 0, v6
v_exp_f32 v7, v7
v_sub_f32 v48, v48, v6
v_sub_f32 v49, v49, v6
v_sub_f32 v50, v50, v6
v_sub_f32 v51, v51, v6
v_sub_f32 v52, v52, v6
v_sub_f32 v53, v53, v6
v_sub_f32 v54, v54, v6
v_sub_f32 v55, v55, v6
v_sub_f32 v56, v56, v6
v_sub_f32 v57, v57, v6
v_sub_f32 v58, v58, v6
v_sub_f32 v59, v59, v6
v_sub_f32 v60, v60, v6
v_sub_f32 v61, v61, v6
v_sub_f32 v62, v62, v6
v_sub_f32 v63, v63, v6
v_sub_f32 v32, v32, v6
v_sub_f32 v33, v33, v6
v_sub_f32 v34, v34, v6
v_sub_f32 v35, v35, v6
v_sub_f32 v36, v36, v6
v_sub_f32 v37, v37, v6
v_sub_f32 v38, v38, v6
v_sub_f32 v39, v39, v6
v_sub_f32 v40, v40, v6
v_sub_f32 v41, v41, v6
v_sub_f32 v42, v42, v6
v_sub_f32 v43, v43, v6
v_sub_f32 v44, v44, v6
v_sub_f32 v45, v45, v6
v_sub_f32 v46, v46, v6
v_sub_f32 v47, v47, v6
v_sub_f32 v16, v16, v6
v_sub_f32 v17, v17, v6
v_sub_f32 v18, v18, v6
v_sub_f32 v19, v19, v6
v_sub_f32 v20, v20, v6
v_sub_f32 v21, v21, v6
v_sub_f32 v22, v22, v6
v_sub_f32 v23, v23, v6
v_sub_f32 v24, v24, v6
v_sub_f32 v25, v25, v6
v_sub_f32 v26, v26, v6
v_sub_f32 v27, v27, v6
v_sub_f32 v28, v28, v6
v_sub_f32 v29, v29, v6
v_sub_f32 v30, v30, v6
v_sub_f32 v31, v31, v6
v_mul_f32 v64, v64, v7
v_mul_f32 v65, v65, v7
v_mul_f32 v66, v66, v7
v_mul_f32 v67, v67, v7
v_mul_f32 v68, v68, v7
v_mul_f32 v69, v69, v7
v_mul_f32 v70, v70, v7
v_mul_f32 v71, v71, v7
v_mul_f32 v72, v72, v7
v_mul_f32 v73, v73, v7
v_mul_f32 v74, v74, v7
v_mul_f32 v75, v75, v7
v_mul_f32 v76, v76, v7
v_mul_f32 v77, v77, v7
v_mul_f32 v78, v78, v7
v_mul_f32 v79, v79, v7
v_mul_f32 v80, v80, v7
v_mul_f32 v81, v81, v7
v_mul_f32 v82, v82, v7
v_mul_f32 v83, v83, v7
v_mul_f32 v84, v84, v7
v_mul_f32 v85, v85, v7
v_mul_f32 v86, v86, v7
v_mul_f32 v87, v87, v7
v_mul_f32 v88, v88, v7
v_mul_f32 v89, v89, v7
v_mul_f32 v90, v90, v7
v_mul_f32 v91, v91, v7
v_mul_f32 v92, v92, v7
v_mul_f32 v93, v93, v7
v_mul_f32 v94, v94, v7
v_mul_f32 v95, v95, v7
v_mul_f32 v96, v96, v7
v_mul_f32 v97, v97, v7
v_mul_f32 v98, v98, v7
v_mul_f32 v99, v99, v7
v_mul_f32 v100, v100, v7
v_mul_f32 v101, v101, v7
v_mul_f32 v102, v102, v7
v_mul_f32 v103, v103, v7
v_mul_f32 v104, v104, v7
v_mul_f32 v105, v105, v7
v_mul_f32 v106, v106, v7
v_mul_f32 v107, v107, v7
v_mul_f32 v108, v108, v7
v_mul_f32 v109, v109, v7
v_mul_f32 v110, v110, v7
v_mul_f32 v111, v111, v7
v_mul_f32 v112, v112, v7
v_mul_f32 v113, v113, v7
v_mul_f32 v114, v114, v7
v_mul_f32 v115, v115, v7
v_mul_f32 v116, v116, v7
v_mul_f32 v117, v117, v7
v_mul_f32 v118, v118, v7
v_mul_f32 v119, v119, v7
v_mul_f32 v120, v120, v7
v_mul_f32 v121, v121, v7
v_mul_f32 v122, v122, v7
v_mul_f32 v123, v123, v7
v_mul_f32 v124, v124, v7
v_mul_f32 v125, v125, v7
v_mul_f32 v126, v126, v7
v_mul_f32 v127, v127, v7
v_mul_f32 v4, v4, v7
v_exp_f32 v208, v32
v_exp_f32 v209, v33
v_exp_f32 v210, v34
v_exp_f32 v211, v35
v_add_f32 v10, v208, v210
v_add_f32 v12, v209, v211
v_exp_f32 v212, v36
v_exp_f32 v213, v37
v_add_f32 v10, v10, v212
v_add_f32 v12, v12, v213
v_exp_f32 v214, v38
v_exp_f32 v215, v39
v_add_f32 v10, v10, v214
v_add_f32 v12, v12, v215
v_cvt_pk_bf16_f32 v200, v208, v209
v_exp_f32 v208, v40
v_exp_f32 v209, v41
v_add_f32 v10, v10, v208
v_add_f32 v12, v12, v209
v_cvt_pk_bf16_f32 v201, v210, v211
v_exp_f32 v210, v42
v_exp_f32 v211, v43
v_add_f32 v10, v10, v210
v_add_f32 v12, v12, v211
v_cvt_pk_bf16_f32 v202, v212, v213
v_exp_f32 v212, v44
v_exp_f32 v213, v45
v_add_f32 v10, v10, v212
v_add_f32 v12, v12, v213
v_cvt_pk_bf16_f32 v203, v214, v215
v_exp_f32 v214, v46
v_exp_f32 v215, v47
v_add_f32 v10, v10, v214
v_add_f32 v12, v12, v215
v_add_f32 v13, v10, v12
v_cvt_pk_bf16_f32 v204, v208, v209
v_cvt_pk_bf16_f32 v205, v210, v211
v_cvt_pk_bf16_f32 v206, v212, v213
v_cvt_pk_bf16_f32 v207, v214, v215
s_nop 7
s_branch L_back_oS
L_slow_eS:
s_nop 15
s_nop 3
v_max3_f32 v6, v16, v17, v18
v_max3_f32 v6, v6, v19, v20
v_max3_f32 v6, v6, v21, v22
v_max3_f32 v6, v6, v23, v24
v_max3_f32 v6, v6, v25, v26
v_max3_f32 v6, v6, v27, v28
v_max3_f32 v6, v6, v29, v30
v_max_f32 v6, v6, v31
v_mov_b32 v7, v6
s_nop 1
v_permlane32_swap_b32 v6, v7
s_nop 1
v_max_f32 v6, v6, v7
v_max_f32 v6, 0, v6
v_sub_f32 v7, 0, v6
v_exp_f32 v7, v7
v_sub_f32 v48, v48, v6
v_sub_f32 v49, v49, v6
v_sub_f32 v50, v50, v6
v_sub_f32 v51, v51, v6
v_sub_f32 v52, v52, v6
v_sub_f32 v53, v53, v6
v_sub_f32 v54, v54, v6
v_sub_f32 v55, v55, v6
v_sub_f32 v56, v56, v6
v_sub_f32 v57, v57, v6
v_sub_f32 v58, v58, v6
v_sub_f32 v59, v59, v6
v_sub_f32 v60, v60, v6
v_sub_f32 v61, v61, v6
v_sub_f32 v62, v62, v6
v_sub_f32 v63, v63, v6
v_sub_f32 v16, v16, v6
v_sub_f32 v17, v17, v6
v_sub_f32 v18, v18, v6
v_sub_f32 v19, v19, v6
v_sub_f32 v20, v20, v6
v_sub_f32 v21, v21, v6
v_sub_f32 v22, v22, v6
v_sub_f32 v23, v23, v6
v_sub_f32 v24, v24, v6
v_sub_f32 v25, v25, v6
v_sub_f32 v26, v26, v6
v_sub_f32 v27, v27, v6
v_sub_f32 v28, v28, v6
v_sub_f32 v29, v29, v6
v_sub_f32 v30, v30, v6
v_sub_f32 v31, v31, v6
v_sub_f32 v32, v32, v6
v_sub_f32 v33, v33, v6
v_sub_f32 v34, v34, v6
v_sub_f32 v35, v35, v6
v_sub_f32 v36, v36, v6
v_sub_f32 v37, v37, v6
v_sub_f32 v38, v38, v6
v_sub_f32 v39, v39, v6
v_sub_f32 v40, v40, v6
v_sub_f32 v41, v41, v6
v_sub_f32 v42, v42, v6
v_sub_f32 v43, v43, v6
v_sub_f32 v44, v44, v6
v_sub_f32 v45, v45, v6
v_sub_f32 v46, v46, v6
v_sub_f32 v47, v47, v6
v_mul_f32 v64, v64, v7
v_mul_f32 v65, v65, v7
v_mul_f32 v66, v66, v7
v_mul_f32 v67, v67, v7
v_mul_f32 v68, v68, v7
v_mul_f32 v69, v69, v7
v_mul_f32 v70, v70, v7
v_mul_f32 v71, v71, v7
v_mul_f32 v72, v72, v7
v_mul_f32 v73, v73, v7
v_mul_f32 v74, v74, v7
v_mul_f32 v75, v75, v7
v_mul_f32 v76, v76, v7
v_mul_f32 v77, v77, v7
v_mul_f32 v78, v78, v7
v_mul_f32 v79, v79, v7
v_mul_f32 v80, v80, v7
v_mul_f32 v81, v81, v7
v_mul_f32 v82, v82, v7
v_mul_f32 v83, v83, v7
v_mul_f32 v84, v84, v7
v_mul_f32 v85, v85, v7
v_mul_f32 v86, v86, v7
v_mul_f32 v87, v87, v7
v_mul_f32 v88, v88, v7
v_mul_f32 v89, v89, v7
v_mul_f32 v90, v90, v7
v_mul_f32 v91, v91, v7
v_mul_f32 v92, v92, v7
v_mul_f32 v93, v93, v7
v_mul_f32 v94, v94, v7
v_mul_f32 v95, v95, v7
v_mul_f32 v96, v96, v7
v_mul_f32 v97, v97, v7
v_mul_f32 v98, v98, v7
v_mul_f32 v99, v99, v7
v_mul_f32 v100, v100, v7
v_mul_f32 v101, v101, v7
v_mul_f32 v102, v102, v7
v_mul_f32 v103, v103, v7
v_mul_f32 v104, v104, v7
v_mul_f32 v105, v105, v7
v_mul_f32 v106, v106, v7
v_mul_f32 v107, v107, v7
v_mul_f32 v108, v108, v7
v_mul_f32 v109, v109, v7
v_mul_f32 v110, v110, v7
v_mul_f32 v111, v111, v7
v_mul_f32 v112, v112, v7
v_mul_f32 v113, v113, v7
v_mul_f32 v114, v114, v7
v_mul_f32 v115, v115, v7
v_mul_f32 v116, v116, v7
v_mul_f32 v117, v117, v7
v_mul_f32 v118, v118, v7
v_mul_f32 v119, v119, v7
v_mul_f32 v120, v120, v7
v_mul_f32 v121, v121, v7
v_mul_f32 v122, v122, v7
v_mul_f32 v123, v123, v7
v_mul_f32 v124, v124, v7
v_mul_f32 v125, v125, v7
v_mul_f32 v126, v126, v7
v_mul_f32 v127, v127, v7
v_mul_f32 v4, v4, v7
v_exp_f32 v208, v16
v_exp_f32 v209, v17
v_exp_f32 v210, v18
v_exp_f32 v211, v19
v_add_f32 v9, v208, v210
v_add_f32 v11, v209, v211
v_exp_f32 v212, v20
v_exp_f32 v213, v21
v_add_f32 v9, v9, v212
v_add_f32 v11, v11, v213
v_exp_f32 v214, v22
v_exp_f32 v215, v23
v_add_f32 v9, v9, v214
v_add_f32 v11, v11, v215
v_cvt_pk_bf16_f32 v192, v208, v209
v_exp_f32 v208, v24
v_exp_f32 v209, v25
v_add_f32 v9, v9, v208
v_add_f32 v11, v11, v209
v_cvt_pk_bf16_f32 v193, v210, v211
v_exp_f32 v210, v26
v_exp_f32 v211, v27
v_add_f32 v9, v9, v210
v_add_f32 v11, v11, v211
v_cvt_pk_bf16_f32 v194, v212, v213
v_exp_f32 v212, v28
v_exp_f32 v213, v29
v_add_f32 v9, v9, v212
v_add_f32 v11, v11, v213
v_cvt_pk_bf16_f32 v195, v214, v215
v_exp_f32 v214, v30
v_exp_f32 v215, v31
v_add_f32 v9, v9, v214
v_add_f32 v11, v11, v215
v_add_f32 v13, v9, v11
v_cvt_pk_bf16_f32 v196, v208, v209
v_cvt_pk_bf16_f32 v197, v210, v211
v_cvt_pk_bf16_f32 v198, v212, v213
v_cvt_pk_bf16_f32 v199, v214, v215
s_nop 7
s_branch L_back_eS
L_slow_l1S:
s_nop 15
s_nop 3
v_max3_f32 v6, v32, v33, v34
v_max3_f32 v6, v6, v35, v36
v_max3_f32 v6, v6, v37, v38
v_max3_f32 v6, v6, v39, v40
v_max3_f32 v6, v6, v41, v42
v_max3_f32 v6, v6, v43, v44
v_max3_f32 v6, v6, v45, v46
v_max_f32 v6, v6, v47
v_mov_b32 v7, v6
s_nop 1
v_permlane32_swap_b32 v6, v7
s_nop 1
v_max_f32 v6, v6, v7
v_max_f32 v6, 0, v6
v_sub_f32 v7, 0, v6
v_exp_f32 v7, v7
v_sub_f32 v48, v48, v6
v_sub_f32 v49, v49, v6
v_sub_f32 v50, v50, v6
v_sub_f32 v51, v51, v6
v_sub_f32 v52, v52, v6
v_sub_f32 v53, v53, v6
v_sub_f32 v54, v54, v6
v_sub_f32 v55, v55, v6
v_sub_f32 v56, v56, v6
v_sub_f32 v57, v57, v6
v_sub_f32 v58, v58, v6
v_sub_f32 v59, v59, v6
v_sub_f32 v60, v60, v6
v_sub_f32 v61, v61, v6
v_sub_f32 v62, v62, v6
v_sub_f32 v63, v63, v6
v_sub_f32 v32, v32, v6
v_sub_f32 v33, v33, v6
v_sub_f32 v34, v34, v6
v_sub_f32 v35, v35, v6
v_sub_f32 v36, v36, v6
v_sub_f32 v37, v37, v6
v_sub_f32 v38, v38, v6
v_sub_f32 v39, v39, v6
v_sub_f32 v40, v40, v6
v_sub_f32 v41, v41, v6
v_sub_f32 v42, v42, v6
v_sub_f32 v43, v43, v6
v_sub_f32 v44, v44, v6
v_sub_f32 v45, v45, v6
v_sub_f32 v46, v46, v6
v_sub_f32 v47, v47, v6
v_mul_f32 v64, v64, v7
v_mul_f32 v65, v65, v7
v_mul_f32 v66, v66, v7
v_mul_f32 v67, v67, v7
v_mul_f32 v68, v68, v7
v_mul_f32 v69, v69, v7
v_mul_f32 v70, v70, v7
v_mul_f32 v71, v71, v7
v_mul_f32 v72, v72, v7
v_mul_f32 v73, v73, v7
v_mul_f32 v74, v74, v7
v_mul_f32 v75, v75, v7
v_mul_f32 v76, v76, v7
v_mul_f32 v77, v77, v7
v_mul_f32 v78, v78, v7
v_mul_f32 v79, v79, v7
v_mul_f32 v80, v80, v7
v_mul_f32 v81, v81, v7
v_mul_f32 v82, v82, v7
v_mul_f32 v83, v83, v7
v_mul_f32 v84, v84, v7
v_mul_f32 v85, v85, v7
v_mul_f32 v86, v86, v7
v_mul_f32 v87, v87, v7
v_mul_f32 v88, v88, v7
v_mul_f32 v89, v89, v7
v_mul_f32 v90, v90, v7
v_mul_f32 v91, v91, v7
v_mul_f32 v92, v92, v7
v_mul_f32 v93, v93, v7
v_mul_f32 v94, v94, v7
v_mul_f32 v95, v95, v7
v_mul_f32 v96, v96, v7
v_mul_f32 v97, v97, v7
v_mul_f32 v98, v98, v7
v_mul_f32 v99, v99, v7
v_mul_f32 v100, v100, v7
v_mul_f32 v101, v101, v7
v_mul_f32 v102, v102, v7
v_mul_f32 v103, v103, v7
v_mul_f32 v104, v104, v7
v_mul_f32 v105, v105, v7
v_mul_f32 v106, v106, v7
v_mul_f32 v107, v107, v7
v_mul_f32 v108, v108, v7
v_mul_f32 v109, v109, v7
v_mul_f32 v110, v110, v7
v_mul_f32 v111, v111, v7
v_mul_f32 v112, v112, v7
v_mul_f32 v113, v113, v7
v_mul_f32 v114, v114, v7
v_mul_f32 v115, v115, v7
v_mul_f32 v116, v116, v7
v_mul_f32 v117, v117, v7
v_mul_f32 v118, v118, v7
v_mul_f32 v119, v119, v7
v_mul_f32 v120, v120, v7
v_mul_f32 v121, v121, v7
v_mul_f32 v122, v122, v7
v_mul_f32 v123, v123, v7
v_mul_f32 v124, v124, v7
v_mul_f32 v125, v125, v7
v_mul_f32 v126, v126, v7
v_mul_f32 v127, v127, v7
v_mul_f32 v4, v4, v7
v_exp_f32 v208, v32
v_exp_f32 v209, v33
v_exp_f32 v210, v34
v_exp_f32 v211, v35
v_add_f32 v10, v208, v210
v_add_f32 v12, v209, v211
v_exp_f32 v212, v36
v_exp_f32 v213, v37
v_add_f32 v10, v10, v212
v_add_f32 v12, v12, v213
v_exp_f32 v214, v38
v_exp_f32 v215, v39
v_add_f32 v10, v10, v214
v_add_f32 v12, v12, v215
v_cvt_pk_bf16_f32 v200, v208, v209
v_exp_f32 v208, v40
v_exp_f32 v209, v41
v_add_f32 v10, v10, v208
v_add_f32 v12, v12, v209
v_cvt_pk_bf16_f32 v201, v210, v211
v_exp_f32 v210, v42
v_exp_f32 v211, v43
v_add_f32 v10, v10, v210
v_add_f32 v12, v12, v211
v_cvt_pk_bf16_f32 v202, v212, v213
v_exp_f32 v212, v44
v_exp_f32 v213, v45
v_add_f32 v10, v10, v212
v_add_f32 v12, v12, v213
v_cvt_pk_bf16_f32 v203, v214, v215
v_exp_f32 v214, v46
v_exp_f32 v215, v47
v_add_f32 v10, v10, v214
v_add_f32 v12, v12, v215
v_add_f32 v13, v10, v12
v_cvt_pk_bf16_f32 v204, v208, v209
v_cvt_pk_bf16_f32 v205, v210, v211
v_cvt_pk_bf16_f32 v206, v212, v213
v_cvt_pk_bf16_f32 v207, v214, v215
s_nop 7
s_branch L_back_l1S
L_slow_l0S:
s_nop 15
s_nop 3
v_max3_f32 v6, v16, v17, v18
v_max3_f32 v6, v6, v19, v20
v_max3_f32 v6, v6, v21, v22
v_max3_f32 v6, v6, v23, v24
v_max3_f32 v6, v6, v25, v26
v_max3_f32 v6, v6, v27, v28
v_max3_f32 v6, v6, v29, v30
v_max_f32 v6, v6, v31
v_mov_b32 v7, v6
s_nop 1
v_permlane32_swap_b32 v6, v7
s_nop 1
v_max_f32 v6, v6, v7
v_max_f32 v6, 0, v6
v_sub_f32 v7, 0, v6
v_exp_f32 v7, v7
v_sub_f32 v48, v48, v6
v_sub_f32 v49, v49, v6
v_sub_f32 v50, v50, v6
v_sub_f32 v51, v51, v6
v_sub_f32 v52, v52, v6
v_sub_f32 v53, v53, v6
v_sub_f32 v54, v54, v6
v_sub_f32 v55, v55, v6
v_sub_f32 v56, v56, v6
v_sub_f32 v57, v57, v6
v_sub_f32 v58, v58, v6
v_sub_f32 v59, v59, v6
v_sub_f32 v60, v60, v6
v_sub_f32 v61, v61, v6
v_sub_f32 v62, v62, v6
v_sub_f32 v63, v63, v6
v_sub_f32 v16, v16, v6
v_sub_f32 v17, v17, v6
v_sub_f32 v18, v18, v6
v_sub_f32 v19, v19, v6
v_sub_f32 v20, v20, v6
v_sub_f32 v21, v21, v6
v_sub_f32 v22, v22, v6
v_sub_f32 v23, v23, v6
v_sub_f32 v24, v24, v6
v_sub_f32 v25, v25, v6
v_sub_f32 v26, v26, v6
v_sub_f32 v27, v27, v6
v_sub_f32 v28, v28, v6
v_sub_f32 v29, v29, v6
v_sub_f32 v30, v30, v6
v_sub_f32 v31, v31, v6
v_mul_f32 v64, v64, v7
v_mul_f32 v65, v65, v7
v_mul_f32 v66, v66, v7
v_mul_f32 v67, v67, v7
v_mul_f32 v68, v68, v7
v_mul_f32 v69, v69, v7
v_mul_f32 v70, v70, v7
v_mul_f32 v71, v71, v7
v_mul_f32 v72, v72, v7
v_mul_f32 v73, v73, v7
v_mul_f32 v74, v74, v7
v_mul_f32 v75, v75, v7
v_mul_f32 v76, v76, v7
v_mul_f32 v77, v77, v7
v_mul_f32 v78, v78, v7
v_mul_f32 v79, v79, v7
v_mul_f32 v80, v80, v7
v_mul_f32 v81, v81, v7
v_mul_f32 v82, v82, v7
v_mul_f32 v83, v83, v7
v_mul_f32 v84, v84, v7
v_mul_f32 v85, v85, v7
v_mul_f32 v86, v86, v7
v_mul_f32 v87, v87, v7
v_mul_f32 v88, v88, v7
v_mul_f32 v89, v89, v7
v_mul_f32 v90, v90, v7
v_mul_f32 v91, v91, v7
v_mul_f32 v92, v92, v7
v_mul_f32 v93, v93, v7
v_mul_f32 v94, v94, v7
v_mul_f32 v95, v95, v7
v_mul_f32 v96, v96, v7
v_mul_f32 v97, v97, v7
v_mul_f32 v98, v98, v7
v_mul_f32 v99, v99, v7
v_mul_f32 v100, v100, v7
v_mul_f32 v101, v101, v7
v_mul_f32 v102, v102, v7
v_mul_f32 v103, v103, v7
v_mul_f32 v104, v104, v7
v_mul_f32 v105, v105, v7
v_mul_f32 v106, v106, v7
v_mul_f32 v107, v107, v7
v_mul_f32 v108, v108, v7
v_mul_f32 v109, v109, v7
v_mul_f32 v110, v110, v7
v_mul_f32 v111, v111, v7
v_mul_f32 v112, v112, v7
v_mul_f32 v113, v113, v7
v_mul_f32 v114, v114, v7
v_mul_f32 v115, v115, v7
v_mul_f32 v116, v116, v7
v_mul_f32 v117, v117, v7
v_mul_f32 v118, v118, v7
v_mul_f32 v119, v119, v7
v_mul_f32 v120, v120, v7
v_mul_f32 v121, v121, v7
v_mul_f32 v122, v122, v7
v_mul_f32 v123, v123, v7
v_mul_f32 v124, v124, v7
v_mul_f32 v125, v125, v7
v_mul_f32 v126, v126, v7
v_mul_f32 v127, v127, v7
v_mul_f32 v4, v4, v7
v_exp_f32 v208, v16
v_exp_f32 v209, v17
v_exp_f32 v210, v18
v_exp_f32 v211, v19
v_add_f32 v9, v208, v210
v_add_f32 v11, v209, v211
v_exp_f32 v212, v20
v_exp_f32 v213, v21
v_add_f32 v9, v9, v212
v_add_f32 v11, v11, v213
v_exp_f32 v214, v22
v_exp_f32 v215, v23
v_add_f32 v9, v9, v214
v_add_f32 v11, v11, v215
v_cvt_pk_bf16_f32 v192, v208, v209
v_exp_f32 v208, v24
v_exp_f32 v209, v25
v_add_f32 v9, v9, v208
v_add_f32 v11, v11, v209
v_cvt_pk_bf16_f32 v193, v210, v211
v_exp_f32 v210, v26
v_exp_f32 v211, v27
v_add_f32 v9, v9, v210
v_add_f32 v11, v11, v211
v_cvt_pk_bf16_f32 v194, v212, v213
v_exp_f32 v212, v28
v_exp_f32 v213, v29
v_add_f32 v9, v9, v212
v_add_f32 v11, v11, v213
v_cvt_pk_bf16_f32 v195, v214, v215
v_exp_f32 v214, v30
v_exp_f32 v215, v31
v_add_f32 v9, v9, v214
v_add_f32 v11, v11, v215
v_add_f32 v13, v9, v11
v_cvt_pk_bf16_f32 v196, v208, v209
v_cvt_pk_bf16_f32 v197, v210, v211
v_cvt_pk_bf16_f32 v198, v212, v213
v_cvt_pk_bf16_f32 v199, v214, v215
s_nop 7
s_branch L_back_l0S
L_k2_fin:
L_k2_end:
s_endpgm
.section .rodata,"a"
.p2align 6
.amdhsa_kernel front_kernel
  .amdhsa_next_free_vgpr 256
  .amdhsa_next_free_sgpr 102
  .amdhsa_accum_offset 256
  .amdhsa_group_segment_fixed_size 0
  .amdhsa_kernarg_size 104
  .amdhsa_user_sgpr_count 2
  .amdhsa_user_sgpr_kernarg_segment_ptr 1
  .amdhsa_system_sgpr_workgroup_id_x 1
  .amdhsa_float_denorm_mode_32 3
.end_amdhsa_kernel
.text
.globl tail_kernel
.p2align 8
.type tail_kernel,@function
tail_kernel:
s_cmp_ge_u32 s2, 256
s_cbranch_scc1 L_tail_end
s_load_dwordx2 s[40:41], s[0:1], 0
s_load_dwordx2 s[42:43], s[0:1], 40
s_load_dwordx4 s[44:47], s[0:1], 56
s_load_dwordx4 s[48:51], s[0:1], 72
s_load_dwordx2 s[52:53], s[0:1], 96
v_and_b32 v10, 63, v0
v_lshrrev_b32 v11, 6, v0
v_lshlrev_b32 v1, 4, v10
v_readfirstlane_b32 s24, v11
s_and_b32 s27, s2, 7
s_lshr_b32 s28, s2, 3
s_and_b32 s25, s28, 3
s_and_b32 s26, s27, 1
s_lshl_b32 s26, s26, 2
s_add_u32 s25, s25, s26
s_lshr_b32 s26, s27, 1
s_lshl_b32 s26, s26, 3
s_lshr_b32 s28, s28, 2
s_add_u32 s26, s26, s28
v_lshrrev_b32 v12, 3, v10
v_and_b32 v13, 7, v10
v_bfe_u32 v14, v10, 4, 1
v_lshlrev_b32 v14, 2, v14
v_xor_b32 v13, v13, v14
v_lshlrev_b32 v13, 4, v13
v_lshl_add_u32 v2, v12, 10, v13
v_add_u32 v3, 7168, v2
s_and_b32 s28, s24, 1
s_lshl_b32 s34, s26, 1
s_xor_b32 s35, s28, 1
s_add_u32 s35, s35, s34
s_add_u32 s34, s34, s28
s_mul_i32 s27, s24, 65536
s_mul_i32 s29, s34, 262144
s_add_u32 s29, s29, s27
s_mul_i32 s30, s35, 262144
s_add_u32 s30, s30, s27
s_mul_i32 s31, s24, 1048576
s_lshl_b32 s27, s25, 7
s_add_u32 s31, s31, s27
s_lshl_b32 s32, s24, 15
s_lshr_b32 s27, s24, 1
s_lshl_b32 s35, s25, 1
s_add_u32 s35, s35, s27
s_waitcnt lgkmcnt(0)
s_mov_b32 s4, s52
s_mov_b32 s5, s53
s_mov_b32 s6, 0x10000000
s_mov_b32 s7, 0x00020000
s_mov_b32 s8, s42
s_mov_b32 s9, s43
s_mov_b32 s10, 0x400000
s_mov_b32 s11, 0x00020000
s_add_u32 s12, s52, 0x2600000
s_addc_u32 s13, s53, 0
s_mov_b32 s14, 0x1000000
s_mov_b32 s15, 0x00020000
s_mov_b32 s16, s40
s_mov_b32 s17, s41
s_mov_b32 s18, 0x200000
s_mov_b32 s19, 0x00020000
s_add_u32 m0, s32, 0
buffer_load_dwordx4 v[80:83], v1, s[12:15], s29 offen
buffer_load_dwordx4 v2, s[8:11], s31 offen lds
buffer_load_dwordx4 v[84:87], v1, s[12:15], s30 offen
buffer_load_dwordx4 v3, s[8:11], s31 offen offset:1024 lds
s_add_u32 s29, s29, 1024
s_add_u32 s30, s30, 1024
s_add_u32 s31, s31, 16384
s_add_u32 m0, s32, 2048
buffer_load_dwordx4 v[88:91], v1, s[12:15], s29 offen
buffer_load_dwordx4 v2, s[8:11], s31 offen lds
buffer_load_dwordx4 v[92:95], v1, s[12:15], s30 offen
buffer_load_dwordx4 v3, s[8:11], s31 offen offset:1024 lds
s_add_u32 s29, s29, 1024
s_add_u32 s30, s30, 1024
s_add_u32 s31, s31, 16384
v_and_b32 v12, 31, v10
v_lshrrev_b32 v13, 5, v10
v_and_b32 v14, 15, v10
v_lshrrev_b32 v15, 2, v14
v_lshl_add_u32 v15, v13, 2, v15
v_lshlrev_b32 v15, 7, v15
v_bfe_u32 v8, v10, 4, 1
v_lshlrev_b32 v8, 1, v8
v_bfe_u32 v9, v14, 1, 1
v_add_u32 v8, v8, v9
v_lshrrev_b32 v9, 3, v14
v_lshlrev_b32 v9, 2, v9
v_xor_b32 v8, v8, v9
v_lshl_add_u32 v15, v8, 4, v15
v_and_b32 v9, 1, v14
v_lshl_add_u32 v15, v9, 3, v15
v_add_u32 v15, s32, v15
s_lshr_b32 s27, s24, 1
s_lshl_b32 s27, s27, 6
v_xor_b32 v4, s27, v15
v_xor_b32 v5, 64, v4
v_mov_b32 v16, 0
v_mov_b32 v17, 0
v_mov_b32 v18, 0
v_mov_b32 v19, 0
v_mov_b32 v20, 0
v_mov_b32 v21, 0
v_mov_b32 v22, 0
v_mov_b32 v23, 0
v_mov_b32 v24, 0
v_mov_b32 v25, 0
v_mov_b32 v26, 0
v_mov_b32 v27, 0
v_mov_b32 v28, 0
v_mov_b32 v29, 0
v_mov_b32 v30, 0
v_mov_b32 v31, 0
v_mov_b32 v32, 0
v_mov_b32 v33, 0
v_mov_b32 v34, 0
v_mov_b32 v35, 0
v_mov_b32 v36, 0
v_mov_b32 v37, 0
v_mov_b32 v38, 0
v_mov_b32 v39, 0
v_mov_b32 v40, 0
v_mov_b32 v41, 0
v_mov_b32 v42, 0
v_mov_b32 v43, 0
v_mov_b32 v44, 0
v_mov_b32 v45, 0
v_mov_b32 v46, 0
v_mov_b32 v47, 0
v_mov_b32 v48, 0
v_mov_b32 v49, 0
v_mov_b32 v50, 0
v_mov_b32 v51, 0
v_mov_b32 v52, 0
v_mov_b32 v53, 0
v_mov_b32 v54, 0
v_mov_b32 v55, 0
v_mov_b32 v56, 0
v_mov_b32 v57, 0
v_mov_b32 v58, 0
v_mov_b32 v59, 0
v_mov_b32 v60, 0
v_mov_b32 v61, 0
v_mov_b32 v62, 0
v_mov_b32 v63, 0
v_mov_b32 v64, 0
v_mov_b32 v65, 0
v_mov_b32 v66, 0
v_mov_b32 v67, 0
v_mov_b32 v68, 0
v_mov_b32 v69, 0
v_mov_b32 v70, 0
v_mov_b32 v71, 0
v_mov_b32 v72, 0
v_mov_b32 v73, 0
v_mov_b32 v74, 0
v_mov_b32 v75, 0
v_mov_b32 v76, 0
v_mov_b32 v77, 0
v_mov_b32 v78, 0
v_mov_b32 v79, 0
s_add_u32 m0, s32, 4096
buffer_load_dwordx4 v[96:99], v1, s[12:15], s29 offen
buffer_load_dwordx4 v2, s[8:11], s31 offen lds
buffer_load_dwordx4 v[100:103], v1, s[12:15], s30 offen
buffer_load_dwordx4 v3, s[8:11], s31 offen offset:1024 lds
s_add_u32 s29, s29, 1024
s_add_u32 s30, s30, 1024
s_add_u32 s31, s31, 16384
s_add_u32 m0, s32, 6144
buffer_load_dwordx4 v[104:107], v1, s[12:15], s29 offen
buffer_load_dwordx4 v2, s[8:11], s31 offen lds
buffer_load_dwordx4 v[108:111], v1, s[12:15], s30 offen
buffer_load_dwordx4 v3, s[8:11], s31 offen offset:1024 lds
s_add_u32 s29, s29, 1024
s_add_u32 s30, s30, 1024
s_add_u32 s31, s31, 16384
s_add_u32 m0, s32, 8192
buffer_load_dwordx4 v[112:115], v1, s[12:15], s29 offen
buffer_load_dwordx4 v2, s[8:11], s31 offen lds
buffer_load_dwordx4 v[116:119], v1, s[12:15], s30 offen
buffer_load_dwordx4 v3, s[8:11], s31 offen offset:1024 lds
s_add_u32 s29, s29, 1024
s_add_u32 s30, s30, 1024
s_add_u32 s31, s31, 16384
s_add_u32 m0, s32, 10240
buffer_load_dwordx4 v[120:123], v1, s[12:15], s29 offen
buffer_load_dwordx4 v2, s[8:11], s31 offen lds
buffer_load_dwordx4 v[124:127], v1, s[12:15], s30 offen
buffer_load_dwordx4 v3, s[8:11], s31 offen offset:1024 lds
s_add_u32 s29, s29, 1024
s_add_u32 s30, s30, 1024
s_add_u32 s31, s31, 16384
s_add_u32 m0, s32, 12288
buffer_load_dwordx4 v[128:131], v1, s[12:15], s29 offen
buffer_load_dwordx4 v2, s[8:11], s31 offen lds
buffer_load_dwordx4 v[132:135], v1, s[12:15], s30 offen
buffer_load_dwordx4 v3, s[8:11], s31 offen offset:1024 lds
s_add_u32 s29, s29, 1024
s_add_u32 s30, s30, 1024
s_add_u32 s31, s31, 16384
s_add_u32 m0, s32, 14336
buffer_load_dwordx4 v[136:139], v1, s[12:15], s29 offen
buffer_load_dwordx4 v2, s[8:11], s31 offen lds
buffer_load_dwordx4 v[140:143], v1, s[12:15], s30 offen
buffer_load_dwordx4 v3, s[8:11], s31 offen offset:1024 lds
s_add_u32 s29, s29, 1024
s_add_u32 s30, s30, 1024
s_add_u32 s31, s31, 16384
s_add_u32 m0, s32, 16384
buffer_load_dwordx4 v[144:147], v1, s[12:15], s29 offen
buffer_load_dwordx4 v2, s[8:11], s31 offen lds
buffer_load_dwordx4 v[148:151], v1, s[12:15], s30 offen
buffer_load_dwordx4 v3, s[8:11], s31 offen offset:1024 lds
s_add_u32 s29, s29, 1024
s_add_u32 s30, s30, 1024
s_add_u32 s31, s31, 16384
s_add_u32 m0, s32, 18432
buffer_load_dwordx4 v[152:155], v1, s[12:15], s29 offen
buffer_load_dwordx4 v2, s[8:11], s31 offen lds
buffer_load_dwordx4 v[156:159], v1, s[12:15], s30 offen
buffer_load_dwordx4 v3, s[8:11], s31 offen offset:1024 lds
s_add_u32 s29, s29, 1024
s_add_u32 s30, s30, 1024
s_add_u32 s31, s31, 16384
s_add_u32 m0, s32, 20480
buffer_load_dwordx4 v[160:163], v1, s[12:15], s29 offen
buffer_load_dwordx4 v2, s[8:11], s31 offen lds
buffer_load_dwordx4 v[164:167], v1, s[12:15], s30 offen
buffer_load_dwordx4 v3, s[8:11], s31 offen offset:1024 lds
s_add_u32 s29, s29, 1024
s_add_u32 s30, s30, 1024
s_add_u32 s31, s31, 16384
s_add_u32 m0, s32, 22528
buffer_load_dwordx4 v[168:171], v1, s[12:15], s29 offen
buffer_load_dwordx4 v2, s[8:11], s31 offen lds
buffer_load_dwordx4 v[172:175], v1, s[12:15], s30 offen
buffer_load_dwordx4 v3, s[8:11], s31 offen offset:1024 lds
s_add_u32 s29, s29, 1024
s_add_u32 s30, s30, 1024
s_add_u32 s31, s31, 16384
s_add_u32 m0, s32, 24576
buffer_load_dwordx4 v[176:179], v1, s[12:15], s29 offen
buffer_load_dwordx4 v2, s[8:11], s31 offen lds
buffer_load_dwordx4 v[180:183], v1, s[12:15], s30 offen
buffer_load_dwordx4 v3, s[8:11], s31 offen offset:1024 lds
s_add_u32 s29, s29, 1024
s_add_u32 s30, s30, 1024
s_add_u32 s31, s31, 16384
s_add_u32 m0, s32, 26624
buffer_load_dwordx4 v[184:187], v1, s[12:15], s29 offen
buffer_load_dwordx4 v2, s[8:11], s31 offen lds
buffer_load_dwordx4 v[188:191], v1, s[12:15], s30 offen
buffer_load_dwordx4 v3, s[8:11], s31 offen offset:1024 lds
s_add_u32 s29, s29, 1024
s_add_u32 s30, s30, 1024
s_add_u32 s31, s31, 16384
s_add_u32 m0, s32, 28672
buffer_load_dwordx4 v[192:195], v1, s[12:15], s29 offen
buffer_load_dwordx4 v2, s[8:11], s31 offen lds
buffer_load_dwordx4 v[196:199], v1, s[12:15], s30 offen
buffer_load_dwordx4 v3, s[8:11], s31 offen offset:1024 lds
s_add_u32 s29, s29, 1024
s_add_u32 s30, s30, 1024
s_add_u32 s31, s31, 16384
s_lshr_b32 s38, s26, 1
s_lshl_b32 s38, s38, 7
s_and_b32 s39, s26, 1
s_lshl_b32 s39, s39, 3
s_add_u32 s39, s39, s25
s_lshl_b32 s39, s39, 2
s_add_u32 s38, s38, s39
s_add_u32 s38, s38, 0x3f00000
s_waitcnt vmcnt(56)
ds_read_b64_tr_b16 v[208:209], v4 offset:0
ds_read_b64_tr_b16 v[210:211], v4 offset:1024
ds_read_b64_tr_b16 v[212:213], v5 offset:0
ds_read_b64_tr_b16 v[214:215], v5 offset:1024
s_mov_b32 s33, 3
.p2align 6
L_tail_loop:
s_waitcnt vmcnt(52)
ds_read_b64_tr_b16 v[216:217], v4 offset:2048
ds_read_b64_tr_b16 v[218:219], v4 offset:3072
ds_read_b64_tr_b16 v[220:221], v5 offset:2048
ds_read_b64_tr_b16 v[222:223], v5 offset:3072
s_waitcnt lgkmcnt(4)
v_mfma_f32_32x32x16_bf16 v[16:31], v[208:211], v[80:83], v[16:31]
s_add_u32 m0, s32, 30720
buffer_load_dwordx4 v[200:203], v1, s[12:15], s29 offen
v_mfma_f32_32x32x16_bf16 v[32:47], v[208:211], v[84:87], v[32:47]
buffer_load_dwordx4 v2, s[8:11], s31 offen lds
v_mfma_f32_32x32x16_bf16 v[48:63], v[212:215], v[80:83], v[48:63]
buffer_load_dwordx4 v[204:207], v1, s[12:15], s30 offen
v_mfma_f32_32x32x16_bf16 v[64:79], v[212:215], v[84:87], v[64:79]
buffer_load_dwordx4 v3, s[8:11], s31 offen offset:1024 lds
s_add_u32 s29, s29, 1024
s_add_u32 s30, s30, 1024
s_add_u32 s31, s31, 16384
s_waitcnt vmcnt(52)
ds_read_b64_tr_b16 v[208:209], v4 offset:4096
ds_read_b64_tr_b16 v[210:211], v4 offset:5120
ds_read_b64_tr_b16 v[212:213], v5 offset:4096
ds_read_b64_tr_b16 v[214:215], v5 offset:5120
s_waitcnt lgkmcnt(4)
v_mfma_f32_32x32x16_bf16 v[16:31], v[216:219], v[88:91], v[16:31]
s_add_u32 m0, s32, 0
buffer_load_dwordx4 v[80:83], v1, s[12:15], s29 offen
v_mfma_f32_32x32x16_bf16 v[32:47], v[216:219], v[92:95], v[32:47]
buffer_load_dwordx4 v2, s[8:11], s31 offen lds
v_mfma_f32_32x32x16_bf16 v[48:63], v[220:223], v[88:91], v[48:63]
buffer_load_dwordx4 v[84:87], v1, s[12:15], s30 offen
v_mfma_f32_32x32x16_bf16 v[64:79], v[220:223], v[92:95], v[64:79]
buffer_load_dwordx4 v3, s[8:11], s31 offen offset:1024 lds
s_add_u32 s29, s29, 1024
s_add_u32 s30, s30, 1024
s_add_u32 s31, s31, 16384
s_waitcnt vmcnt(52)
ds_read_b64_tr_b16 v[216:217], v4 offset:6144
ds_read_b64_tr_b16 v[218:219], v4 offset:7168
ds_read_b64_tr_b16 v[220:221], v5 offset:6144
ds_read_b64_tr_b16 v[222:223], v5 offset:7168
s_waitcnt lgkmcnt(4)
v_mfma_f32_32x32x16_bf16 v[16:31], v[208:211], v[96:99], v[16:31]
s_add_u32 m0, s32, 2048
buffer_load_dwordx4 v[88:91], v1, s[12:15], s29 offen
v_mfma_f32_32x32x16_bf16 v[32:47], v[208:211], v[100:103], v[32:47]
buffer_load_dwordx4 v2, s[8:11], s31 offen lds
v_mfma_f32_32x32x16_bf16 v[48:63], v[212:215], v[96:99], v[48:63]
buffer_load_dwordx4 v[92:95], v1, s[12:15], s30 offen
v_mfma_f32_32x32x16_bf16 v[64:79], v[212:215], v[100:103], v[64:79]
buffer_load_dwordx4 v3, s[8:11], s31 offen offset:1024 lds
s_add_u32 s29, s29, 1024
s_add_u32 s30, s30, 1024
s_add_u32 s31, s31, 16384
s_waitcnt vmcnt(52)
ds_read_b64_tr_b16 v[208:209], v4 offset:8192
ds_read_b64_tr_b16 v[210:211], v4 offset:9216
ds_read_b64_tr_b16 v[212:213], v5 offset:8192
ds_read_b64_tr_b16 v[214:215], v5 offset:9216
s_waitcnt lgkmcnt(4)
v_mfma_f32_32x32x16_bf16 v[16:31], v[216:219], v[104:107], v[16:31]
s_add_u32 m0, s32, 4096
buffer_load_dwordx4 v[96:99], v1, s[12:15], s29 offen
v_mfma_f32_32x32x16_bf16 v[32:47], v[216:219], v[108:111], v[32:47]
buffer_load_dwordx4 v2, s[8:11], s31 offen lds
v_mfma_f32_32x32x16_bf16 v[48:63], v[220:223], v[104:107], v[48:63]
buffer_load_dwordx4 v[100:103], v1, s[12:15], s30 offen
v_mfma_f32_32x32x16_bf16 v[64:79], v[220:223], v[108:111], v[64:79]
buffer_load_dwordx4 v3, s[8:11], s31 offen offset:1024 lds
s_add_u32 s29, s29, 1024
s_add_u32 s30, s30, 1024
s_add_u32 s31, s31, 16384
s_waitcnt vmcnt(52)
ds_read_b64_tr_b16 v[216:217], v4 offset:10240
ds_read_b64_tr_b16 v[218:219], v4 offset:11264
ds_read_b64_tr_b16 v[220:221], v5 offset:10240
ds_read_b64_tr_b16 v[222:223], v5 offset:11264
s_waitcnt lgkmcnt(4)
v_mfma_f32_32x32x16_bf16 v[16:31], v[208:211], v[112:115], v[16:31]
s_add_u32 m0, s32, 6144
buffer_load_dwordx4 v[104:107], v1, s[12:15], s29 offen
v_mfma_f32_32x32x16_bf16 v[32:47], v[208:211], v[116:119], v[32:47]
buffer_load_dwordx4 v2, s[8:11], s31 offen lds
v_mfma_f32_32x32x16_bf16 v[48:63], v[212:215], v[112:115], v[48:63]
buffer_load_dwordx4 v[108:111], v1, s[12:15], s30 offen
v_mfma_f32_32x32x16_bf16 v[64:79], v[212:215], v[116:119], v[64:79]
buffer_load_dwordx4 v3, s[8:11], s31 offen offset:1024 lds
s_add_u32 s29, s29, 1024
s_add_u32 s30, s30, 1024
s_add_u32 s31, s31, 16384
s_waitcnt vmcnt(52)
ds_read_b64_tr_b16 v[208:209], v4 offset:12288
ds_read_b64_tr_b16 v[210:211], v4 offset:13312
ds_read_b64_tr_b16 v[212:213], v5 offset:12288
ds_read_b64_tr_b16 v[214:215], v5 offset:13312
s_waitcnt lgkmcnt(4)
v_mfma_f32_32x32x16_bf16 v[16:31], v[216:219], v[120:123], v[16:31]
s_add_u32 m0, s32, 8192
buffer_load_dwordx4 v[112:115], v1, s[12:15], s29 offen
v_mfma_f32_32x32x16_bf16 v[32:47], v[216:219], v[124:127], v[32:47]
buffer_load_dwordx4 v2, s[8:11], s31 offen lds
v_mfma_f32_32x32x16_bf16 v[48:63], v[220:223], v[120:123], v[48:63]
buffer_load_dwordx4 v[116:119], v1, s[12:15], s30 offen
v_mfma_f32_32x32x16_bf16 v[64:79], v[220:223], v[124:127], v[64:79]
buffer_load_dwordx4 v3, s[8:11], s31 offen offset:1024 lds
s_add_u32 s29, s29, 1024
s_add_u32 s30, s30, 1024
s_add_u32 s31, s31, 16384
s_waitcnt vmcnt(52)
ds_read_b64_tr_b16 v[216:217], v4 offset:14336
ds_read_b64_tr_b16 v[218:219], v4 offset:15360
ds_read_b64_tr_b16 v[220:221], v5 offset:14336
ds_read_b64_tr_b16 v[222:223], v5 offset:15360
s_waitcnt lgkmcnt(4)
v_mfma_f32_32x32x16_bf16 v[16:31], v[208:211], v[128:131], v[16:31]
s_add_u32 m0, s32, 10240
buffer_load_dwordx4 v[120:123], v1, s[12:15], s29 offen
v_mfma_f32_32x32x16_bf16 v[32:47], v[208:211], v[132:135], v[32:47]
buffer_load_dwordx4 v2, s[8:11], s31 offen lds
v_mfma_f32_32x32x16_bf16 v[48:63], v[212:215], v[128:131], v[48:63]
buffer_load_dwordx4 v[124:127], v1, s[12:15], s30 offen
v_mfma_f32_32x32x16_bf16 v[64:79], v[212:215], v[132:135], v[64:79]
buffer_load_dwordx4 v3, s[8:11], s31 offen offset:1024 lds
s_add_u32 s29, s29, 1024
s_add_u32 s30, s30, 1024
s_add_u32 s31, s31, 16384
s_waitcnt vmcnt(52)
ds_read_b64_tr_b16 v[208:209], v4 offset:16384
ds_read_b64_tr_b16 v[210:211], v4 offset:17408
ds_read_b64_tr_b16 v[212:213], v5 offset:16384
ds_read_b64_tr_b16 v[214:215], v5 offset:17408
s_waitcnt lgkmcnt(4)
v_mfma_f32_32x32x16_bf16 v[16:31], v[216:219], v[136:139], v[16:31]
s_add_u32 m0, s32, 12288
buffer_load_dwordx4 v[128:131], v1, s[12:15], s29 offen
v_mfma_f32_32x32x16_bf16 v[32:47], v[216:219], v[140:143], v[32:47]
buffer_load_dwordx4 v2, s[8:11], s31 offen lds
v_mfma_f32_32x32x16_bf16 v[48:63], v[220:223], v[136:139], v[48:63]
buffer_load_dwordx4 v[132:135], v1, s[12:15], s30 offen
v_mfma_f32_32x32x16_bf16 v[64:79], v[220:223], v[140:143], v[64:79]
buffer_load_dwordx4 v3, s[8:11], s31 offen offset:1024 lds
s_add_u32 s29, s29, 1024
s_add_u32 s30, s30, 1024
s_add_u32 s31, s31, 16384
s_waitcnt vmcnt(52)
ds_read_b64_tr_b16 v[216:217], v4 offset:18432
ds_read_b64_tr_b16 v[218:219], v4 offset:19456
ds_read_b64_tr_b16 v[220:221], v5 offset:18432
ds_read_b64_tr_b16 v[222:223], v5 offset:19456
s_waitcnt lgkmcnt(4)
v_mfma_f32_32x32x16_bf16 v[16:31], v[208:211], v[144:147], v[16:31]
s_add_u32 m0, s32, 14336
buffer_load_dwordx4 v[136:139], v1, s[12:15], s29 offen
v_mfma_f32_32x32x16_bf16 v[32:47], v[208:211], v[148:151], v[32:47]
buffer_load_dwordx4 v2, s[8:11], s31 offen lds
v_mfma_f32_32x32x16_bf16 v[48:63], v[212:215], v[144:147], v[48:63]
buffer_load_dwordx4 v[140:143], v1, s[12:15], s30 offen
v_mfma_f32_32x32x16_bf16 v[64:79], v[212:215], v[148:151], v[64:79]
buffer_load_dwordx4 v3, s[8:11], s31 offen offset:1024 lds
s_add_u32 s29, s29, 1024
s_add_u32 s30, s30, 1024
s_add_u32 s31, s31, 16384
s_waitcnt vmcnt(52)
ds_read_b64_tr_b16 v[208:209], v4 offset:20480
ds_read_b64_tr_b16 v[210:211], v4 offset:21504
ds_read_b64_tr_b16 v[212:213], v5 offset:20480
ds_read_b64_tr_b16 v[214:215], v5 offset:21504
s_waitcnt lgkmcnt(4)
v_mfma_f32_32x32x16_bf16 v[16:31], v[216:219], v[152:155], v[16:31]
s_add_u32 m0, s32, 16384
buffer_load_dwordx4 v[144:147], v1, s[12:15], s29 offen
v_mfma_f32_32x32x16_bf16 v[32:47], v[216:219], v[156:159], v[32:47]
buffer_load_dwordx4 v2, s[8:11], s31 offen lds
v_mfma_f32_32x32x16_bf16 v[48:63], v[220:223], v[152:155], v[48:63]
buffer_load_dwordx4 v[148:151], v1, s[12:15], s30 offen
v_mfma_f32_32x32x16_bf16 v[64:79], v[220:223], v[156:159], v[64:79]
buffer_load_dwordx4 v3, s[8:11], s31 offen offset:1024 lds
s_add_u32 s29, s29, 1024
s_add_u32 s30, s30, 1024
s_add_u32 s31, s31, 16384
s_waitcnt vmcnt(52)
ds_read_b64_tr_b16 v[216:217], v4 offset:22528
ds_read_b64_tr_b16 v[218:219], v4 offset:23552
ds_read_b64_tr_b16 v[220:221], v5 offset:22528
ds_read_b64_tr_b16 v[222:223], v5 offset:23552
s_waitcnt lgkmcnt(4)
v_mfma_f32_32x32x16_bf16 v[16:31], v[208:211], v[160:163], v[16:31]
s_add_u32 m0, s32, 18432
buffer_load_dwordx4 v[152:155], v1, s[12:15], s29 offen
v_mfma_f32_32x32x16_bf16 v[32:47], v[208:211], v[164:167], v[32:47]
buffer_load_dwordx4 v2, s[8:11], s31 offen lds
v_mfma_f32_32x32x16_bf16 v[48:63], v[212:215], v[160:163], v[48:63]
buffer_load_dwordx4 v[156:159], v1, s[12:15], s30 offen
v_mfma_f32_32x32x16_bf16 v[64:79], v[212:215], v[164:167], v[64:79]
buffer_load_dwordx4 v3, s[8:11], s31 offen offset:1024 lds
s_add_u32 s29, s29, 1024
s_add_u32 s30, s30, 1024
s_add_u32 s31, s31, 16384
s_waitcnt vmcnt(52)
ds_read_b64_tr_b16 v[208:209], v4 offset:24576
ds_read_b64_tr_b16 v[210:211], v4 offset:25600
ds_read_b64_tr_b16 v[212:213], v5 offset:24576
ds_read_b64_tr_b16 v[214:215], v5 offset:25600
s_waitcnt lgkmcnt(4)
v_mfma_f32_32x32x16_bf16 v[16:31], v[216:219], v[168:171], v[16:31]
s_add_u32 m0, s32, 20480
buffer_load_dwordx4 v[160:163], v1, s[12:15], s29 offen
v_mfma_f32_32x32x16_bf16 v[32:47], v[216:219], v[172:175], v[32:47]
buffer_load_dwordx4 v2, s[8:11], s31 offen lds
v_mfma_f32_32x32x16_bf16 v[48:63], v[220:223], v[168:171], v[48:63]
buffer_load_dwordx4 v[164:167], v1, s[12:15], s30 offen
v_mfma_f32_32x32x16_bf16 v[64:79], v[220:223], v[172:175], v[64:79]
buffer_load_dwordx4 v3, s[8:11], s31 offen offset:1024 lds
s_add_u32 s29, s29, 1024
s_add_u32 s30, s30, 1024
s_add_u32 s31, s31, 16384
s_waitcnt vmcnt(52)
ds_read_b64_tr_b16 v[216:217], v4 offset:26624
ds_read_b64_tr_b16 v[218:219], v4 offset:27648
ds_read_b64_tr_b16 v[220:221], v5 offset:26624
ds_read_b64_tr_b16 v[222:223], v5 offset:27648
s_waitcnt lgkmcnt(4)
v_mfma_f32_32x32x16_bf16 v[16:31], v[208:211], v[176:179], v[16:31]
s_add_u32 m0, s32, 22528
buffer_load_dwordx4 v[168:171], v1, s[12:15], s29 offen
v_mfma_f32_32x32x16_bf16 v[32:47], v[208:211], v[180:183], v[32:47]
buffer_load_dwordx4 v2, s[8:11], s31 offen lds
v_mfma_f32_32x32x16_bf16 v[48:63], v[212:215], v[176:179], v[48:63]
buffer_load_dwordx4 v[172:175], v1, s[12:15], s30 offen
v_mfma_f32_32x32x16_bf16 v[64:79], v[212:215], v[180:183], v[64:79]
buffer_load_dwordx4 v3, s[8:11], s31 offen offset:1024 lds
s_add_u32 s29, s29, 1024
s_add_u32 s30, s30, 1024
s_add_u32 s31, s31, 16384
s_waitcnt vmcnt(52)
ds_read_b64_tr_b16 v[208:209], v4 offset:28672
ds_read_b64_tr_b16 v[210:211], v4 offset:29696
ds_read_b64_tr_b16 v[212:213], v5 offset:28672
ds_read_b64_tr_b16 v[214:215], v5 offset:29696
s_waitcnt lgkmcnt(4)
v_mfma_f32_32x32x16_bf16 v[16:31], v[216:219], v[184:187], v[16:31]
s_add_u32 m0, s32, 24576
buffer_load_dwordx4 v[176:179], v1, s[12:15], s29 offen
v_mfma_f32_32x32x16_bf16 v[32:47], v[216:219], v[188:191], v[32:47]
buffer_load_dwordx4 v2, s[8:11], s31 offen lds
v_mfma_f32_32x32x16_bf16 v[48:63], v[220:223], v[184:187], v[48:63]
buffer_load_dwordx4 v[180:183], v1, s[12:15], s30 offen
v_mfma_f32_32x32x16_bf16 v[64:79], v[220:223], v[188:191], v[64:79]
buffer_load_dwordx4 v3, s[8:11], s31 offen offset:1024 lds
s_add_u32 s29, s29, 1024
s_add_u32 s30, s30, 1024
s_add_u32 s31, s31, 16384
s_waitcnt vmcnt(52)
ds_read_b64_tr_b16 v[216:217], v4 offset:30720
ds_read_b64_tr_b16 v[218:219], v4 offset:31744
ds_read_b64_tr_b16 v[220:221], v5 offset:30720
ds_read_b64_tr_b16 v[222:223], v5 offset:31744
s_waitcnt lgkmcnt(4)
v_mfma_f32_32x32x16_bf16 v[16:31], v[208:211], v[192:195], v[16:31]
s_add_u32 m0, s32, 26624
buffer_load_dwordx4 v[184:187], v1, s[12:15], s29 offen
v_mfma_f32_32x32x16_bf16 v[32:47], v[208:211], v[196:199], v[32:47]
buffer_load_dwordx4 v2, s[8:11], s31 offen lds
v_mfma_f32_32x32x16_bf16 v[48:63], v[212:215], v[192:195], v[48:63]
buffer_load_dwordx4 v[188:191], v1, s[12:15], s30 offen
v_mfma_f32_32x32x16_bf16 v[64:79], v[212:215], v[196:199], v[64:79]
buffer_load_dwordx4 v3, s[8:11], s31 offen offset:1024 lds
s_add_u32 s29, s29, 1024
s_add_u32 s30, s30, 1024
s_add_u32 s31, s31, 16384
s_waitcnt vmcnt(52)
ds_read_b64_tr_b16 v[208:209], v4 offset:0
ds_read_b64_tr_b16 v[210:211], v4 offset:1024
ds_read_b64_tr_b16 v[212:213], v5 offset:0
ds_read_b64_tr_b16 v[214:215], v5 offset:1024
s_waitcnt lgkmcnt(4)
v_mfma_f32_32x32x16_bf16 v[16:31], v[216:219], v[200:203], v[16:31]
s_add_u32 m0, s32, 28672
buffer_load_dwordx4 v[192:195], v1, s[12:15], s29 offen
v_mfma_f32_32x32x16_bf16 v[32:47], v[216:219], v[204:207], v[32:47]
buffer_load_dwordx4 v2, s[8:11], s31 offen lds
v_mfma_f32_32x32x16_bf16 v[48:63], v[220:223], v[200:203], v[48:63]
buffer_load_dwordx4 v[196:199], v1, s[12:15], s30 offen
v_mfma_f32_32x32x16_bf16 v[64:79], v[220:223], v[204:207], v[64:79]
buffer_load_dwordx4 v3, s[8:11], s31 offen offset:1024 lds
s_add_u32 s29, s29, 1024
s_add_u32 s30, s30, 1024
s_add_u32 s31, s31, 16384
s_sub_u32 s33, s33, 1
s_cmp_lg_u32 s33, 0
s_cbranch_scc1 L_tail_loop
s_waitcnt vmcnt(52)
ds_read_b64_tr_b16 v[216:217], v4 offset:2048
ds_read_b64_tr_b16 v[218:219], v4 offset:3072
ds_read_b64_tr_b16 v[220:221], v5 offset:2048
ds_read_b64_tr_b16 v[222:223], v5 offset:3072
s_waitcnt lgkmcnt(4)
v_mfma_f32_32x32x16_bf16 v[16:31], v[208:211], v[80:83], v[16:31]
s_add_u32 m0, s32, 30720
buffer_load_dwordx4 v[200:203], v1, s[12:15], s29 offen
v_mfma_f32_32x32x16_bf16 v[32:47], v[208:211], v[84:87], v[32:47]
buffer_load_dwordx4 v2, s[8:11], s31 offen lds
v_mfma_f32_32x32x16_bf16 v[48:63], v[212:215], v[80:83], v[48:63]
buffer_load_dwordx4 v[204:207], v1, s[12:15], s30 offen
v_mfma_f32_32x32x16_bf16 v[64:79], v[212:215], v[84:87], v[64:79]
buffer_load_dwordx4 v3, s[8:11], s31 offen offset:1024 lds
s_add_u32 s29, s29, 1024
s_add_u32 s30, s30, 1024
s_add_u32 s31, s31, 16384
s_waitcnt vmcnt(52)
ds_read_b64_tr_b16 v[208:209], v4 offset:4096
ds_read_b64_tr_b16 v[210:211], v4 offset:5120
ds_read_b64_tr_b16 v[212:213], v5 offset:4096
ds_read_b64_tr_b16 v[214:215], v5 offset:5120
s_waitcnt lgkmcnt(4)
v_mfma_f32_32x32x16_bf16 v[16:31], v[216:219], v[88:91], v[16:31]
v_mfma_f32_32x32x16_bf16 v[32:47], v[216:219], v[92:95], v[32:47]
v_mfma_f32_32x32x16_bf16 v[48:63], v[220:223], v[88:91], v[48:63]
v_mfma_f32_32x32x16_bf16 v[64:79], v[220:223], v[92:95], v[64:79]
v_lshlrev_b32 v14, 10, v12
v_lshl_add_u32 v6, v13, 3, v14
s_lshl_b32 s36, s34, 15
s_lshl_b32 s37, s35, 6
s_add_u32 s36, s36, s37
buffer_load_dwordx2 v[224:225], v6, s[16:19], s36 offen offset:0
buffer_load_dwordx2 v[226:227], v6, s[16:19], s36 offen offset:16
buffer_load_dwordx2 v[228:229], v6, s[16:19], s36 offen offset:32
buffer_load_dwordx2 v[230:231], v6, s[16:19], s36 offen offset:48
s_waitcnt vmcnt(52)
ds_read_b64_tr_b16 v[216:217], v4 offset:6144
ds_read_b64_tr_b16 v[218:219], v4 offset:7168
ds_read_b64_tr_b16 v[220:221], v5 offset:6144
ds_read_b64_tr_b16 v[222:223], v5 offset:7168
s_waitcnt lgkmcnt(4)
v_mfma_f32_32x32x16_bf16 v[16:31], v[208:211], v[96:99], v[16:31]
v_mfma_f32_32x32x16_bf16 v[32:47], v[208:211], v[100:103], v[32:47]
v_mfma_f32_32x32x16_bf16 v[48:63], v[212:215], v[96:99], v[48:63]
v_mfma_f32_32x32x16_bf16 v[64:79], v[212:215], v[100:103], v[64:79]
s_waitcnt vmcnt(48)
ds_read_b64_tr_b16 v[208:209], v4 offset:8192
ds_read_b64_tr_b16 v[210:211], v4 offset:9216
ds_read_b64_tr_b16 v[212:213], v5 offset:8192
ds_read_b64_tr_b16 v[214:215], v5 offset:9216
s_waitcnt lgkmcnt(4)
v_mfma_f32_32x32x16_bf16 v[16:31], v[216:219], v[104:107], v[16:31]
v_mfma_f32_32x32x16_bf16 v[32:47], v[216:219], v[108:111], v[32:47]
v_mfma_f32_32x32x16_bf16 v[48:63], v[220:223], v[104:107], v[48:63]
v_mfma_f32_32x32x16_bf16 v[64:79], v[220:223], v[108:111], v[64:79]
s_waitcnt vmcnt(44)
ds_read_b64_tr_b16 v[216:217], v4 offset:10240
ds_read_b64_tr_b16 v[218:219], v4 offset:11264
ds_read_b64_tr_b16 v[220:221], v5 offset:10240
ds_read_b64_tr_b16 v[222:223], v5 offset:11264
s_waitcnt lgkmcnt(4)
v_mfma_f32_32x32x16_bf16 v[16:31], v[208:211], v[112:115], v[16:31]
v_mfma_f32_32x32x16_bf16 v[32:47], v[208:211], v[116:119], v[32:47]
v_mfma_f32_32x32x16_bf16 v[48:63], v[212:215], v[112:115], v[48:63]
v_mfma_f32_32x32x16_bf16 v[64:79], v[212:215], v[116:119], v[64:79]
s_waitcnt vmcnt(40)
ds_read_b64_tr_b16 v[208:209], v4 offset:12288
ds_read_b64_tr_b16 v[210:211], v4 offset:13312
ds_read_b64_tr_b16 v[212:213], v5 offset:12288
ds_read_b64_tr_b16 v[214:215], v5 offset:13312
s_waitcnt lgkmcnt(4)
v_mfma_f32_32x32x16_bf16 v[16:31], v[216:219], v[120:123], v[16:31]
v_mfma_f32_32x32x16_bf16 v[32:47], v[216:219], v[124:127], v[32:47]
v_mfma_f32_32x32x16_bf16 v[48:63], v[220:223], v[120:123], v[48:63]
v_mfma_f32_32x32x16_bf16 v[64:79], v[220:223], v[124:127], v[64:79]
s_waitcnt vmcnt(36)
ds_read_b64_tr_b16 v[216:217], v4 offset:14336
ds_read_b64_tr_b16 v[218:219], v4 offset:15360
ds_read_b64_tr_b16 v[220:221], v5 offset:14336
ds_read_b64_tr_b16 v[222:223], v5 offset:15360
s_waitcnt lgkmcnt(4)
v_mfma_f32_32x32x16_bf16 v[16:31], v[208:211], v[128:131], v[16:31]
v_mfma_f32_32x32x16_bf16 v[32:47], v[208:211], v[132:135], v[32:47]
v_mfma_f32_32x32x16_bf16 v[48:63], v[212:215], v[128:131], v[48:63]
v_mfma_f32_32x32x16_bf16 v[64:79], v[212:215], v[132:135], v[64:79]
s_waitcnt vmcnt(32)
ds_read_b64_tr_b16 v[208:209], v4 offset:16384
ds_read_b64_tr_b16 v[210:211], v4 offset:17408
ds_read_b64_tr_b16 v[212:213], v5 offset:16384
ds_read_b64_tr_b16 v[214:215], v5 offset:17408
s_waitcnt lgkmcnt(4)
v_mfma_f32_32x32x16_bf16 v[16:31], v[216:219], v[136:139], v[16:31]
v_mfma_f32_32x32x16_bf16 v[32:47], v[216:219], v[140:143], v[32:47]
v_mfma_f32_32x32x16_bf16 v[48:63], v[220:223], v[136:139], v[48:63]
v_mfma_f32_32x32x16_bf16 v[64:79], v[220:223], v[140:143], v[64:79]
s_waitcnt vmcnt(28)
ds_read_b64_tr_b16 v[216:217], v4 offset:18432
ds_read_b64_tr_b16 v[218:219], v4 offset:19456
ds_read_b64_tr_b16 v[220:221], v5 offset:18432
ds_read_b64_tr_b16 v[222:223], v5 offset:19456
s_waitcnt lgkmcnt(4)
v_mfma_f32_32x32x16_bf16 v[16:31], v[208:211], v[144:147], v[16:31]
v_mfma_f32_32x32x16_bf16 v[32:47], v[208:211], v[148:151], v[32:47]
v_mfma_f32_32x32x16_bf16 v[48:63], v[212:215], v[144:147], v[48:63]
v_mfma_f32_32x32x16_bf16 v[64:79], v[212:215], v[148:151], v[64:79]
s_waitcnt vmcnt(24)
ds_read_b64_tr_b16 v[208:209], v4 offset:20480
ds_read_b64_tr_b16 v[210:211], v4 offset:21504
ds_read_b64_tr_b16 v[212:213], v5 offset:20480
ds_read_b64_tr_b16 v[214:215], v5 offset:21504
s_waitcnt lgkmcnt(4)
v_mfma_f32_32x32x16_bf16 v[16:31], v[216:219], v[152:155], v[16:31]
v_mfma_f32_32x32x16_bf16 v[32:47], v[216:219], v[156:159], v[32:47]
v_mfma_f32_32x32x16_bf16 v[48:63], v[220:223], v[152:155], v[48:63]
v_mfma_f32_32x32x16_bf16 v[64:79], v[220:223], v[156:159], v[64:79]
s_waitcnt vmcnt(20)
ds_read_b64_tr_b16 v[216:217], v4 offset:22528
ds_read_b64_tr_b16 v[218:219], v4 offset:23552
ds_read_b64_tr_b16 v[220:221], v5 offset:22528
ds_read_b64_tr_b16 v[222:223], v5 offset:23552
s_waitcnt lgkmcnt(4)
v_mfma_f32_32x32x16_bf16 v[16:31], v[208:211], v[160:163], v[16:31]
v_mfma_f32_32x32x16_bf16 v[32:47], v[208:211], v[164:167], v[32:47]
v_mfma_f32_32x32x16_bf16 v[48:63], v[212:215], v[160:163], v[48:63]
v_mfma_f32_32x32x16_bf16 v[64:79], v[212:215], v[164:167], v[64:79]
s_waitcnt vmcnt(16)
ds_read_b64_tr_b16 v[208:209], v4 offset:24576
ds_read_b64_tr_b16 v[210:211], v4 offset:25600
ds_read_b64_tr_b16 v[212:213], v5 offset:24576
ds_read_b64_tr_b16 v[214:215], v5 offset:25600
s_waitcnt lgkmcnt(4)
v_mfma_f32_32x32x16_bf16 v[16:31], v[216:219], v[168:171], v[16:31]
v_mfma_f32_32x32x16_bf16 v[32:47], v[216:219], v[172:175], v[32:47]
v_mfma_f32_32x32x16_bf16 v[48:63], v[220:223], v[168:171], v[48:63]
v_mfma_f32_32x32x16_bf16 v[64:79], v[220:223], v[172:175], v[64:79]
s_waitcnt vmcnt(12)
ds_read_b64_tr_b16 v[216:217], v4 offset:26624
ds_read_b64_tr_b16 v[218:219], v4 offset:27648
ds_read_b64_tr_b16 v[220:221], v5 offset:26624
ds_read_b64_tr_b16 v[222:223], v5 offset:27648
s_waitcnt lgkmcnt(4)
v_mfma_f32_32x32x16_bf16 v[16:31], v[208:211], v[176:179], v[16:31]
v_mfma_f32_32x32x16_bf16 v[32:47], v[208:211], v[180:183], v[32:47]
v_mfma_f32_32x32x16_bf16 v[48:63], v[212:215], v[176:179], v[48:63]
v_mfma_f32_32x32x16_bf16 v[64:79], v[212:215], v[180:183], v[64:79]
s_waitcnt vmcnt(8)
ds_read_b64_tr_b16 v[208:209], v4 offset:28672
ds_read_b64_tr_b16 v[210:211], v4 offset:29696
ds_read_b64_tr_b16 v[212:213], v5 offset:28672
ds_read_b64_tr_b16 v[214:215], v5 offset:29696
s_waitcnt lgkmcnt(4)
v_mfma_f32_32x32x16_bf16 v[16:31], v[216:219], v[184:187], v[16:31]
v_mfma_f32_32x32x16_bf16 v[32:47], v[216:219], v[188:191], v[32:47]
v_mfma_f32_32x32x16_bf16 v[48:63], v[220:223], v[184:187], v[48:63]
v_mfma_f32_32x32x16_bf16 v[64:79], v[220:223], v[188:191], v[64:79]
s_waitcnt vmcnt(4)
ds_read_b64_tr_b16 v[216:217], v4 offset:30720
ds_read_b64_tr_b16 v[218:219], v4 offset:31744
ds_read_b64_tr_b16 v[220:221], v5 offset:30720
ds_read_b64_tr_b16 v[222:223], v5 offset:31744
s_waitcnt lgkmcnt(4)
v_mfma_f32_32x32x16_bf16 v[16:31], v[208:211], v[192:195], v[16:31]
v_mfma_f32_32x32x16_bf16 v[32:47], v[208:211], v[196:199], v[32:47]
v_mfma_f32_32x32x16_bf16 v[48:63], v[212:215], v[192:195], v[48:63]
v_mfma_f32_32x32x16_bf16 v[64:79], v[212:215], v[196:199], v[64:79]
s_waitcnt lgkmcnt(0)
v_mfma_f32_32x32x16_bf16 v[16:31], v[216:219], v[200:203], v[16:31]
v_mfma_f32_32x32x16_bf16 v[32:47], v[216:219], v[204:207], v[32:47]
v_mfma_f32_32x32x16_bf16 v[48:63], v[220:223], v[200:203], v[48:63]
v_mfma_f32_32x32x16_bf16 v[64:79], v[220:223], v[204:207], v[64:79]
s_nop 7
s_nop 3
s_barrier
s_xor_b32 s27, s24, 1
s_lshl_b32 s27, s27, 15
v_add_u32 v8, s27, v1
ds_write_b128 v8, v[32:35] offset:0
ds_write_b128 v8, v[36:39] offset:1024
ds_write_b128 v8, v[40:43] offset:2048
ds_write_b128 v8, v[44:47] offset:3072
s_xor_b32 s27, s24, 2
s_lshl_b32 s27, s27, 15
v_add_u32 v8, s27, v1
ds_write_b128 v8, v[48:51] offset:4096
ds_write_b128 v8, v[52:55] offset:5120
ds_write_b128 v8, v[56:59] offset:6144
ds_write_b128 v8, v[60:63] offset:7168
s_xor_b32 s27, s24, 3
s_lshl_b32 s27, s27, 15
v_add_u32 v8, s27, v1
ds_write_b128 v8, v[64:67] offset:8192
ds_write_b128 v8, v[68:71] offset:9216
ds_write_b128 v8, v[72:75] offset:10240
ds_write_b128 v8, v[76:79] offset:11264
v_add_u32 v8, s32, v1
s_waitcnt lgkmcnt(0)
s_barrier
ds_read_b128 v[80:83], v8 offset:0
ds_read_b128 v[84:87], v8 offset:1024
ds_read_b128 v[88:91], v8 offset:2048
ds_read_b128 v[92:95], v8 offset:3072
ds_read_b128 v[96:99], v8 offset:4096
ds_read_b128 v[100:103], v8 offset:5120
ds_read_b128 v[104:107], v8 offset:6144
ds_read_b128 v[108:111], v8 offset:7168
ds_read_b128 v[112:115], v8 offset:8192
ds_read_b128 v[116:119], v8 offset:9216
ds_read_b128 v[120:123], v8 offset:10240
ds_read_b128 v[124:127], v8 offset:11264
s_waitcnt lgkmcnt(8)
v_add_f32 v16, v16, v80
v_add_f32 v17, v17, v81
v_add_f32 v18, v18, v82
v_add_f32 v19, v19, v83
v_add_f32 v20, v20, v84
v_add_f32 v21, v21, v85
v_add_f32 v22, v22, v86
v_add_f32 v23, v23, v87
v_add_f32 v24, v24, v88
v_add_f32 v25, v25, v89
v_add_f32 v26, v26, v90
v_add_f32 v27, v27, v91
v_add_f32 v28, v28, v92
v_add_f32 v29, v29, v93
v_add_f32 v30, v30, v94
v_add_f32 v31, v31, v95
s_waitcnt lgkmcnt(0)
v_add_f32 v96, v96, v112
v_add_f32 v97, v97, v113
v_add_f32 v98, v98, v114
v_add_f32 v99, v99, v115
v_add_f32 v100, v100, v116
v_add_f32 v101, v101, v117
v_add_f32 v102, v102, v118
v_add_f32 v103, v103, v119
v_add_f32 v104, v104, v120
v_add_f32 v105, v105, v121
v_add_f32 v106, v106, v122
v_add_f32 v107, v107, v123
v_add_f32 v108, v108, v124
v_add_f32 v109, v109, v125
v_add_f32 v110, v110, v126
v_add_f32 v111, v111, v127
v_add_f32 v80, v16, v96
v_add_f32 v81, v17, v97
v_add_f32 v82, v18, v98
v_add_f32 v83, v19, v99
v_add_f32 v84, v20, v100
v_add_f32 v85, v21, v101
v_add_f32 v86, v22, v102
v_add_f32 v87, v23, v103
v_add_f32 v88, v24, v104
v_add_f32 v89, v25, v105
v_add_f32 v90, v26, v106
v_add_f32 v91, v27, v107
v_add_f32 v92, v28, v108
v_add_f32 v93, v29, v109
v_add_f32 v94, v30, v110
v_add_f32 v95, v31, v111
s_waitcnt vmcnt(0)
v_cvt_pk_bf16_f32 v16, v80, v81
v_cvt_pk_bf16_f32 v17, v82, v83
v_cvt_pk_bf16_f32 v18, v84, v85
v_cvt_pk_bf16_f32 v19, v86, v87
v_cvt_pk_bf16_f32 v20, v88, v89
v_cvt_pk_bf16_f32 v21, v90, v91
v_cvt_pk_bf16_f32 v22, v92, v93
v_cvt_pk_bf16_f32 v23, v94, v95
v_lshlrev_b32 v80, 16, v16
v_and_b32 v81, 0xffff0000, v16
v_lshlrev_b32 v96, 16, v224
v_and_b32 v97, 0xffff0000, v224
v_lshlrev_b32 v82, 16, v17
v_and_b32 v83, 0xffff0000, v17
v_lshlrev_b32 v98, 16, v225
v_and_b32 v99, 0xffff0000, v225
v_lshlrev_b32 v84, 16, v18
v_and_b32 v85, 0xffff0000, v18
v_lshlrev_b32 v100, 16, v226
v_and_b32 v101, 0xffff0000, v226
v_lshlrev_b32 v86, 16, v19
v_and_b32 v87, 0xffff0000, v19
v_lshlrev_b32 v102, 16, v227
v_and_b32 v103, 0xffff0000, v227
v_lshlrev_b32 v88, 16, v20
v_and_b32 v89, 0xffff0000, v20
v_lshlrev_b32 v104, 16, v228
v_and_b32 v105, 0xffff0000, v228
v_lshlrev_b32 v90, 16, v21
v_and_b32 v91, 0xffff0000, v21
v_lshlrev_b32 v106, 16, v229
v_and_b32 v107, 0xffff0000, v229
v_lshlrev_b32 v92, 16, v22
v_and_b32 v93, 0xffff0000, v22
v_lshlrev_b32 v108, 16, v230
v_and_b32 v109, 0xffff0000, v230
v_lshlrev_b32 v94, 16, v23
v_and_b32 v95, 0xffff0000, v23
v_lshlrev_b32 v110, 16, v231
v_and_b32 v111, 0xffff0000, v231
v_add_f32 v80, v80, v96
v_add_f32 v81, v81, v97
v_add_f32 v82, v82, v98
v_add_f32 v83, v83, v99
v_add_f32 v84, v84, v100
v_add_f32 v85, v85, v101
v_add_f32 v86, v86, v102
v_add_f32 v87, v87, v103
v_add_f32 v88, v88, v104
v_add_f32 v89, v89, v105
v_add_f32 v90, v90, v106
v_add_f32 v91, v91, v107
v_add_f32 v92, v92, v108
v_add_f32 v93, v93, v109
v_add_f32 v94, v94, v110
v_add_f32 v95, v95, v111
v_cvt_pk_bf16_f32 v16, v80, v81
v_cvt_pk_bf16_f32 v17, v82, v83
v_cvt_pk_bf16_f32 v18, v84, v85
v_cvt_pk_bf16_f32 v19, v86, v87
v_cvt_pk_bf16_f32 v20, v88, v89
v_cvt_pk_bf16_f32 v21, v90, v91
v_cvt_pk_bf16_f32 v22, v92, v93
v_cvt_pk_bf16_f32 v23, v94, v95
s_lshl_b32 s36, s34, 5
s_lshl_b32 s37, s35, 1
s_add_u32 s36, s36, s37
s_lshl_b32 s36, s36, 10
s_add_u32 s36, s36, 0x3600000
buffer_store_dwordx4 v[16:19], v1, s[4:7], s36 offen offset:0 sc1
buffer_store_dwordx4 v[20:23], v1, s[4:7], s36 offen offset:1024 sc1
v_lshlrev_b32 v80, 16, v16
v_and_b32 v81, 0xffff0000, v16
v_lshlrev_b32 v82, 16, v17
v_and_b32 v83, 0xffff0000, v17
v_lshlrev_b32 v84, 16, v18
v_and_b32 v85, 0xffff0000, v18
v_lshlrev_b32 v86, 16, v19
v_and_b32 v87, 0xffff0000, v19
v_lshlrev_b32 v88, 16, v20
v_and_b32 v89, 0xffff0000, v20
v_lshlrev_b32 v90, 16, v21
v_and_b32 v91, 0xffff0000, v21
v_lshlrev_b32 v92, 16, v22
v_and_b32 v93, 0xffff0000, v22
v_lshlrev_b32 v94, 16, v23
v_and_b32 v95, 0xffff0000, v23
v_add_f32 v232, v80, v81
v_mul_f32 v233, v80, v80
v_fmac_f32 v233, v81, v81
v_add_f32 v232, v232, v82
v_fmac_f32 v233, v82, v82
v_add_f32 v232, v232, v83
v_fmac_f32 v233, v83, v83
v_add_f32 v232, v232, v84
v_fmac_f32 v233, v84, v84
v_add_f32 v232, v232, v85
v_fmac_f32 v233, v85, v85
v_add_f32 v232, v232, v86
v_fmac_f32 v233, v86, v86
v_add_f32 v232, v232, v87
v_fmac_f32 v233, v87, v87
v_add_f32 v232, v232, v88
v_fmac_f32 v233, v88, v88
v_add_f32 v232, v232, v89
v_fmac_f32 v233, v89, v89
v_add_f32 v232, v232, v90
v_fmac_f32 v233, v90, v90
v_add_f32 v232, v232, v91
v_fmac_f32 v233, v91, v91
v_add_f32 v232, v232, v92
v_fmac_f32 v233, v92, v92
v_add_f32 v232, v232, v93
v_fmac_f32 v233, v93, v93
v_add_f32 v232, v232, v94
v_fmac_f32 v233, v94, v94
v_add_f32 v232, v232, v95
v_fmac_f32 v233, v95, v95
v_mov_b32 v234, v232
v_mov_b32 v235, v233
s_nop 1
v_permlane32_swap_b32 v232, v234
v_permlane32_swap_b32 v233, v235
s_nop 1
v_add_f32 v232, v232, v234
v_add_f32 v233, v233, v235
v_lshlrev_b32 v8, 7, v12
s_lshl_b32 s36, s34, 12
s_lshl_b32 s37, s35, 3
s_add_u32 s36, s36, s37
s_add_u32 s36, s36, 0x3800000
buffer_store_dwordx2 v[232:233], v8, s[4:7], s36 offen sc1
s_lshr_b32 s28, s2, 3
s_and_b32 s27, s2, 7
s_lshl_b32 s26, s27, 1
s_and_b32 s27, s28, 1
s_add_u32 s26, s26, s27
s_lshr_b32 s25, s28, 1
s_lshl_b32 s29, s25, 2
s_add_u32 s29, s29, s24
s_cmp_ge_u32 s26, 15
s_cbranch_scc1 L_B_skip
v_lshrrev_b32 v12, 4, v10
v_add_u32 v13, s26, v12
v_and_b32 v13, 1, v13
v_bfe_u32 v14, v10, 2, 2
v_sub_u32 v14, v14, v12
v_add_u32 v14, v14, v13
v_and_b32 v14, 3, v14
v_sub_u32 v14, v14, v13
v_lshlrev_b32 v14, 6, v14
v_and_b32 v15, 3, v10
v_lshl_add_u32 v14, v15, 4, v14
v_mul_u32_u24 v12, 2752, v12
v_add_u32 v5, v12, v14
v_add_u32 v5, 64, v5
s_mul_i32 s30, s26, 192
s_mul_i32 s31, s24, 44032
s_add_u32 s30, s30, s31
s_lshl_b32 s31, s24, 12
s_sub_u32 s8, s44, 64
s_subb_u32 s9, s45, 0
s_mov_b32 s10, 0x158040
s_mov_b32 s11, 0x00020000
s_sub_u32 s12, s46, 64
s_subb_u32 s13, s47, 0
s_mov_b32 s14, 0x158040
s_mov_b32 s15, 0x00020000
s_barrier
s_add_u32 m0, s31, 0
s_add_u32 s27, s30, 0
buffer_load_dwordx4 v5, s[8:11], s27 offen lds
s_add_u32 m0, s31, 1024
s_add_u32 s27, s30, 11008
buffer_load_dwordx4 v5, s[8:11], s27 offen lds
s_add_u32 m0, s31, 2048
s_add_u32 s27, s30, 22016
buffer_load_dwordx4 v5, s[8:11], s27 offen lds
s_add_u32 m0, s31, 3072
s_add_u32 s27, s30, 33024
buffer_load_dwordx4 v5, s[8:11], s27 offen lds
s_add_u32 m0, s31, 16384
s_add_u32 s27, s30, 0
buffer_load_dwordx4 v5, s[12:15], s27 offen lds
s_add_u32 m0, s31, 17408
s_add_u32 s27, s30, 11008
buffer_load_dwordx4 v5, s[12:15], s27 offen lds
s_add_u32 m0, s31, 18432
s_add_u32 s27, s30, 22016
buffer_load_dwordx4 v5, s[12:15], s27 offen lds
s_add_u32 m0, s31, 19456
s_add_u32 s27, s30, 33024
buffer_load_dwordx4 v5, s[12:15], s27 offen lds
s_add_u32 m0, s31, 32768
s_add_u32 s27, s30, 176128
buffer_load_dwordx4 v5, s[8:11], s27 offen lds
s_add_u32 m0, s31, 33792
s_add_u32 s27, s30, 187136
buffer_load_dwordx4 v5, s[8:11], s27 offen lds
s_add_u32 m0, s31, 34816
s_add_u32 s27, s30, 198144
buffer_load_dwordx4 v5, s[8:11], s27 offen lds
s_add_u32 m0, s31, 35840
s_add_u32 s27, s30, 209152
buffer_load_dwordx4 v5, s[8:11], s27 offen lds
s_add_u32 m0, s31, 49152
s_add_u32 s27, s30, 176128
buffer_load_dwordx4 v5, s[12:15], s27 offen lds
s_add_u32 m0, s31, 50176
s_add_u32 s27, s30, 187136
buffer_load_dwordx4 v5, s[12:15], s27 offen lds
s_add_u32 m0, s31, 51200
s_add_u32 s27, s30, 198144
buffer_load_dwordx4 v5, s[12:15], s27 offen lds
s_add_u32 m0, s31, 52224
s_add_u32 s27, s30, 209152
buffer_load_dwordx4 v5, s[12:15], s27 offen lds
s_waitcnt vmcnt(16)
s_barrier
s_cmp_lg_u32 s24, 0
s_cbranch_scc1 L_sig_0
v_mov_b32 v234, 0
v_mov_b32 v235, 1
s_mov_b64 s[60:61], exec
s_mov_b64 exec, 1
buffer_store_dword v235, v234, s[4:7], s38 offen sc1
s_mov_b64 exec, s[60:61]
L_sig_0:
s_add_u32 m0, s31, 65536
s_add_u32 s27, s30, 352256
buffer_load_dwordx4 v5, s[8:11], s27 offen lds
s_add_u32 m0, s31, 66560
s_add_u32 s27, s30, 363264
buffer_load_dwordx4 v5, s[8:11], s27 offen lds
s_add_u32 m0, s31, 67584
s_add_u32 s27, s30, 374272
buffer_load_dwordx4 v5, s[8:11], s27 offen lds
s_add_u32 m0, s31, 68608
s_add_u32 s27, s30, 385280
buffer_load_dwordx4 v5, s[8:11], s27 offen lds
s_add_u32 m0, s31, 81920
s_add_u32 s27, s30, 352256
buffer_load_dwordx4 v5, s[12:15], s27 offen lds
s_add_u32 m0, s31, 82944
s_add_u32 s27, s30, 363264
buffer_load_dwordx4 v5, s[12:15], s27 offen lds
s_add_u32 m0, s31, 83968
s_add_u32 s27, s30, 374272
buffer_load_dwordx4 v5, s[12:15], s27 offen lds
s_add_u32 m0, s31, 84992
s_add_u32 s27, s30, 385280
buffer_load_dwordx4 v5, s[12:15], s27 offen lds
v_and_b32 v12, 31, v10
v_lshrrev_b32 v13, 5, v10
v_lshlrev_b32 v6, 7, v12
v_lshl_add_u32 v6, v13, 6, v6
s_lshl_b32 s28, s29, 12
s_add_u32 s28, s28, 0x3800000
s_lshl_b32 s39, s29, 15
s_add_u32 s39, s39, 0x3600000
v_and_b32 v14, 15, v10
v_lshrrev_b32 v15, 2, v14
v_lshl_add_u32 v2, v13, 2, v15
v_lshlrev_b32 v2, 8, v2
v_bfe_u32 v3, v10, 4, 1
v_lshl_add_u32 v2, v3, 5, v2
v_and_b32 v3, 3, v14
v_lshl_add_u32 v2, v3, 3, v2
v_add_u32 v3, 0, v15
v_and_b32 v3, 3, v3
v_lshl_add_u32 v7, v3, 6, v2
v_add_u32 v3, 1, v15
v_and_b32 v3, 3, v3
v_lshl_add_u32 v8, v3, 6, v2
v_add_u32 v3, 2, v15
v_and_b32 v3, 3, v3
v_lshl_add_u32 v9, v3, 6, v2
s_lshl_b32 s37, s25, 7
s_add_u32 s37, s37, 0x3f00000
s_cmp_lg_u32 s24, 0
s_cbranch_scc1 L_poll_done_A
v_and_b32 v232, 15, v10
v_min_u32 v232, 15, v232
v_lshlrev_b32 v232, 2, v232
s_mov_b32 s33, 65536
L_poll_A:
buffer_load_dword v233, v232, s[4:7], s37 offen sc1
s_waitcnt vmcnt(0)
v_cmp_ne_u32 vcc, 1, v233
s_nop 3
s_cmp_eq_u64 vcc, 0
s_cbranch_scc1 L_poll_done_A
s_sleep 1
s_sub_u32 s33, s33, 1
s_cbranch_scc0 L_poll_A
L_poll_done_A:
s_barrier
buffer_load_dwordx4 v[16:19], v6, s[4:7], s28 offen offset:0 sc1
buffer_load_dwordx4 v[20:23], v6, s[4:7], s28 offen offset:16 sc1
buffer_load_dwordx4 v[24:27], v6, s[4:7], s28 offen offset:32 sc1
buffer_load_dwordx4 v[28:31], v6, s[4:7], s28 offen offset:48 sc1
buffer_load_dwordx4 v[128:131], v1, s[4:7], s39 offen sc1
buffer_load_dwordx4 v[132:135], v1, s[4:7], s39 offen offset:1024 sc1
buffer_load_dwordx4 v[136:139], v1, s[4:7], s39 offen offset:2048 sc1
buffer_load_dwordx4 v[140:143], v1, s[4:7], s39 offen offset:3072 sc1
s_add_u32 s39, s39, 4096
buffer_load_dwordx4 v[144:147], v1, s[4:7], s39 offen sc1
buffer_load_dwordx4 v[148:151], v1, s[4:7], s39 offen offset:1024 sc1
buffer_load_dwordx4 v[152:155], v1, s[4:7], s39 offen offset:2048 sc1
buffer_load_dwordx4 v[156:159], v1, s[4:7], s39 offen offset:3072 sc1
s_waitcnt vmcnt(8)
v_add_f32 v2, v16, v18
v_add_f32 v3, v17, v19
v_add_f32 v2, v2, v20
v_add_f32 v3, v3, v21
v_add_f32 v2, v2, v22
v_add_f32 v3, v3, v23
v_add_f32 v2, v2, v24
v_add_f32 v3, v3, v25
v_add_f32 v2, v2, v26
v_add_f32 v3, v3, v27
v_add_f32 v2, v2, v28
v_add_f32 v3, v3, v29
v_add_f32 v2, v2, v30
v_add_f32 v3, v3, v31
v_mov_b32 v4, v2
v_mov_b32 v11, v3
s_nop 1
v_permlane32_swap_b32 v2, v4
v_permlane32_swap_b32 v3, v11
s_nop 1
v_add_f32 v2, v2, v4
v_add_f32 v3, v3, v11
v_mul_f32 v2, 0x3b000000, v2
v_mul_f32 v3, 0x3b000000, v3
v_fma_f32 v3, -v2, v2, v3
v_max_f32 v3, 0, v3
v_cvt_pk_bf16_f32 v2, v2, v2
v_cvt_pk_bf16_f32 v3, v3, v3
v_lshlrev_b32 v2, 16, v2
v_lshlrev_b32 v3, 16, v3
v_add_f32 v3, 0x3727c5ac, v3
v_cvt_pk_bf16_f32 v3, v3, v3
v_lshlrev_b32 v3, 16, v3
v_sqrt_f32 v3, v3
s_nop 0
v_cvt_pk_bf16_f32 v3, v3, v3
v_lshlrev_b32 v3, 16, v3
v_rcp_f32 v3, v3
s_nop 0
v_mul_f32 v4, v2, v3
v_sub_f32 v4, 0, v4
s_mov_b32 s36, 0xffff0000
s_waitcnt vmcnt(6)
v_lshlrev_b32 v12, 16, v128
v_and_b32 v13, s36, v128
v_lshlrev_b32 v14, 16, v129
v_and_b32 v15, s36, v129
v_lshlrev_b32 v112, 16, v130
v_and_b32 v113, s36, v130
v_lshlrev_b32 v114, 16, v131
v_and_b32 v115, s36, v131
v_fma_f32 v12, v12, v3, v4
v_fma_f32 v13, v13, v3, v4
v_fma_f32 v14, v14, v3, v4
v_fma_f32 v15, v15, v3, v4
v_fma_f32 v112, v112, v3, v4
v_fma_f32 v113, v113, v3, v4
v_fma_f32 v114, v114, v3, v4
v_fma_f32 v115, v115, v3, v4
v_cvt_pk_bf16_f32 v128, v12, v13
v_cvt_pk_bf16_f32 v129, v14, v15
v_cvt_pk_bf16_f32 v130, v112, v113
v_cvt_pk_bf16_f32 v131, v114, v115
v_lshlrev_b32 v12, 16, v132
v_and_b32 v13, s36, v132
v_lshlrev_b32 v14, 16, v133
v_and_b32 v15, s36, v133
v_lshlrev_b32 v112, 16, v134
v_and_b32 v113, s36, v134
v_lshlrev_b32 v114, 16, v135
v_and_b32 v115, s36, v135
v_fma_f32 v12, v12, v3, v4
v_fma_f32 v13, v13, v3, v4
v_fma_f32 v14, v14, v3, v4
v_fma_f32 v15, v15, v3, v4
v_fma_f32 v112, v112, v3, v4
v_fma_f32 v113, v113, v3, v4
v_fma_f32 v114, v114, v3, v4
v_fma_f32 v115, v115, v3, v4
v_cvt_pk_bf16_f32 v132, v12, v13
v_cvt_pk_bf16_f32 v133, v14, v15
v_cvt_pk_bf16_f32 v134, v112, v113
v_cvt_pk_bf16_f32 v135, v114, v115
s_waitcnt vmcnt(28)
s_barrier
ds_read_b64_tr_b16 a[0:1], v7 offset:0
ds_read_b64_tr_b16 a[2:3], v7 offset:2048
ds_read_b64_tr_b16 a[4:5], v7 offset:16384
ds_read_b64_tr_b16 a[6:7], v7 offset:18432
ds_read_b64_tr_b16 a[8:9], v8 offset:0
ds_read_b64_tr_b16 a[10:11], v8 offset:2048
ds_read_b64_tr_b16 a[12:13], v8 offset:16384
ds_read_b64_tr_b16 a[14:15], v8 offset:18432
ds_read_b64_tr_b16 a[16:17], v9 offset:0
ds_read_b64_tr_b16 a[18:19], v9 offset:2048
ds_read_b64_tr_b16 a[20:21], v9 offset:16384
ds_read_b64_tr_b16 a[22:23], v9 offset:18432
s_waitcnt vmcnt(4)
s_waitcnt lgkmcnt(6)
v_mfma_f32_32x32x16_bf16 v[16:31], a[0:3], v[128:131], 0
ds_read_b64_tr_b16 a[24:25], v7 offset:4096
ds_read_b64_tr_b16 a[26:27], v7 offset:6144
v_lshlrev_b32 v12, 16, v136
v_and_b32 v13, s36, v136
v_lshlrev_b32 v14, 16, v137
s_add_u32 s39, s39, 4096
buffer_load_dwordx4 v[160:163], v1, s[4:7], s39 offen sc1
v_mfma_f32_32x32x16_bf16 v[64:79], a[4:7], v[128:131], 0
ds_read_b64_tr_b16 a[28:29], v7 offset:20480
ds_read_b64_tr_b16 a[30:31], v7 offset:22528
v_and_b32 v15, s36, v137
v_lshlrev_b32 v112, 16, v138
v_and_b32 v113, s36, v138
v_mfma_f32_32x32x16_bf16 v[32:47], a[8:11], v[128:131], 0
ds_read_b64_tr_b16 a[32:33], v8 offset:4096
ds_read_b64_tr_b16 a[34:35], v8 offset:6144
v_lshlrev_b32 v114, 16, v139
v_and_b32 v115, s36, v139
v_fma_f32 v12, v12, v3, v4
v_fma_f32 v13, v13, v3, v4
buffer_load_dwordx4 v[164:167], v1, s[4:7], s39 offen offset:1024 sc1
s_waitcnt lgkmcnt(6)
v_mfma_f32_32x32x16_bf16 v[80:95], a[12:15], v[128:131], 0
ds_read_b64_tr_b16 a[36:37], v8 offset:20480
ds_read_b64_tr_b16 a[38:39], v8 offset:22528
v_fma_f32 v14, v14, v3, v4
v_fma_f32 v15, v15, v3, v4
v_fma_f32 v112, v112, v3, v4
v_mfma_f32_32x32x16_bf16 v[48:63], a[16:19], v[128:131], 0
ds_read_b64_tr_b16 a[40:41], v9 offset:4096
ds_read_b64_tr_b16 a[42:43], v9 offset:6144
v_fma_f32 v113, v113, v3, v4
v_fma_f32 v114, v114, v3, v4
v_fma_f32 v115, v115, v3, v4
buffer_load_dwordx4 v[168:171], v1, s[4:7], s39 offen offset:2048 sc1
v_mfma_f32_32x32x16_bf16 v[96:111], a[20:23], v[128:131], 0
ds_read_b64_tr_b16 a[44:45], v9 offset:20480
ds_read_b64_tr_b16 a[46:47], v9 offset:22528
v_cvt_pk_bf16_f32 v136, v12, v13
v_cvt_pk_bf16_f32 v137, v14, v15
v_cvt_pk_bf16_f32 v138, v112, v113
v_cvt_pk_bf16_f32 v139, v114, v115
s_waitcnt lgkmcnt(6)
v_mfma_f32_32x32x16_bf16 v[16:31], a[24:27], v[132:135], v[16:31]
ds_read_b64_tr_b16 a[0:1], v7 offset:8192
ds_read_b64_tr_b16 a[2:3], v7 offset:10240
v_lshlrev_b32 v12, 16, v140
v_and_b32 v13, s36, v140
v_lshlrev_b32 v14, 16, v141
buffer_load_dwordx4 v[172:175], v1, s[4:7], s39 offen offset:3072 sc1
v_mfma_f32_32x32x16_bf16 v[64:79], a[28:31], v[132:135], v[64:79]
ds_read_b64_tr_b16 a[4:5], v7 offset:24576
ds_read_b64_tr_b16 a[6:7], v7 offset:26624
v_and_b32 v15, s36, v141
v_lshlrev_b32 v112, 16, v142
v_and_b32 v113, s36, v142
v_mfma_f32_32x32x16_bf16 v[32:47], a[32:35], v[132:135], v[32:47]
ds_read_b64_tr_b16 a[8:9], v8 offset:8192
ds_read_b64_tr_b16 a[10:11], v8 offset:10240
v_lshlrev_b32 v114, 16, v143
v_and_b32 v115, s36, v143
v_fma_f32 v12, v12, v3, v4
v_fma_f32 v13, v13, v3, v4
s_add_u32 m0, s31, 98304
s_add_u32 s27, s30, 528384
buffer_load_dwordx4 v5, s[8:11], s27 offen lds
s_waitcnt lgkmcnt(6)
v_mfma_f32_32x32x16_bf16 v[80:95], a[36:39], v[132:135], v[80:95]
ds_read_b64_tr_b16 a[12:13], v8 offset:24576
ds_read_b64_tr_b16 a[14:15], v8 offset:26624
v_fma_f32 v14, v14, v3, v4
v_fma_f32 v15, v15, v3, v4
v_fma_f32 v112, v112, v3, v4
v_mfma_f32_32x32x16_bf16 v[48:63], a[40:43], v[132:135], v[48:63]
ds_read_b64_tr_b16 a[16:17], v9 offset:8192
ds_read_b64_tr_b16 a[18:19], v9 offset:10240
v_fma_f32 v113, v113, v3, v4
v_fma_f32 v114, v114, v3, v4
v_fma_f32 v115, v115, v3, v4
s_add_u32 m0, s31, 99328
s_add_u32 s27, s30, 539392
buffer_load_dwordx4 v5, s[8:11], s27 offen lds
v_mfma_f32_32x32x16_bf16 v[96:111], a[44:47], v[132:135], v[96:111]
ds_read_b64_tr_b16 a[20:21], v9 offset:24576
ds_read_b64_tr_b16 a[22:23], v9 offset:26624
v_cvt_pk_bf16_f32 v140, v12, v13
v_cvt_pk_bf16_f32 v141, v14, v15
v_cvt_pk_bf16_f32 v142, v112, v113
v_cvt_pk_bf16_f32 v143, v114, v115
s_waitcnt vmcnt(8)
s_waitcnt lgkmcnt(6)
v_mfma_f32_32x32x16_bf16 v[16:31], a[0:3], v[136:139], v[16:31]
ds_read_b64_tr_b16 a[24:25], v7 offset:12288
ds_read_b64_tr_b16 a[26:27], v7 offset:14336
v_lshlrev_b32 v12, 16, v144
v_and_b32 v13, s36, v144
v_lshlrev_b32 v14, 16, v145
s_add_u32 m0, s31, 100352
s_add_u32 s27, s30, 550400
buffer_load_dwordx4 v5, s[8:11], s27 offen lds
v_mfma_f32_32x32x16_bf16 v[64:79], a[4:7], v[136:139], v[64:79]
ds_read_b64_tr_b16 a[28:29], v7 offset:28672
ds_read_b64_tr_b16 a[30:31], v7 offset:30720
v_and_b32 v15, s36, v145
v_lshlrev_b32 v112, 16, v146
v_and_b32 v113, s36, v146
v_mfma_f32_32x32x16_bf16 v[32:47], a[8:11], v[136:139], v[32:47]
ds_read_b64_tr_b16 a[32:33], v8 offset:12288
ds_read_b64_tr_b16 a[34:35], v8 offset:14336
v_lshlrev_b32 v114, 16, v147
v_and_b32 v115, s36, v147
v_fma_f32 v12, v12, v3, v4
v_fma_f32 v13, v13, v3, v4
s_add_u32 m0, s31, 101376
s_add_u32 s27, s30, 561408
buffer_load_dwordx4 v5, s[8:11], s27 offen lds
s_waitcnt lgkmcnt(6)
v_mfma_f32_32x32x16_bf16 v[80:95], a[12:15], v[136:139], v[80:95]
ds_read_b64_tr_b16 a[36:37], v8 offset:28672
ds_read_b64_tr_b16 a[38:39], v8 offset:30720
v_fma_f32 v14, v14, v3, v4
v_fma_f32 v15, v15, v3, v4
v_fma_f32 v112, v112, v3, v4
v_mfma_f32_32x32x16_bf16 v[48:63], a[16:19], v[136:139], v[48:63]
ds_read_b64_tr_b16 a[40:41], v9 offset:12288
ds_read_b64_tr_b16 a[42:43], v9 offset:14336
v_fma_f32 v113, v113, v3, v4
v_fma_f32 v114, v114, v3, v4
v_fma_f32 v115, v115, v3, v4
s_add_u32 m0, s31, 114688
s_add_u32 s27, s30, 528384
buffer_load_dwordx4 v5, s[12:15], s27 offen lds
v_mfma_f32_32x32x16_bf16 v[96:111], a[20:23], v[136:139], v[96:111]
ds_read_b64_tr_b16 a[44:45], v9 offset:28672
ds_read_b64_tr_b16 a[46:47], v9 offset:30720
v_cvt_pk_bf16_f32 v144, v12, v13
v_cvt_pk_bf16_f32 v145, v14, v15
v_cvt_pk_bf16_f32 v146, v112, v113
v_cvt_pk_bf16_f32 v147, v114, v115
s_waitcnt vmcnt(29)
s_waitcnt lgkmcnt(0)
s_barrier
v_add_u32 v7, 0x8000, v7
v_add_u32 v8, 0x8000, v8
v_add_u32 v9, 0x8000, v9
s_waitcnt lgkmcnt(6)
v_mfma_f32_32x32x16_bf16 v[16:31], a[24:27], v[140:143], v[16:31]
ds_read_b64_tr_b16 a[0:1], v7 offset:0
ds_read_b64_tr_b16 a[2:3], v7 offset:2048
v_lshlrev_b32 v12, 16, v148
v_and_b32 v13, s36, v148
v_lshlrev_b32 v14, 16, v149
s_add_u32 m0, s31, 115712
s_add_u32 s27, s30, 539392
buffer_load_dwordx4 v5, s[12:15], s27 offen lds
v_mfma_f32_32x32x16_bf16 v[64:79], a[28:31], v[140:143], v[64:79]
ds_read_b64_tr_b16 a[4:5], v7 offset:16384
ds_read_b64_tr_b16 a[6:7], v7 offset:18432
v_and_b32 v15, s36, v149
v_lshlrev_b32 v112, 16, v150
v_and_b32 v113, s36, v150
v_mfma_f32_32x32x16_bf16 v[32:47], a[32:35], v[140:143], v[32:47]
ds_read_b64_tr_b16 a[8:9], v8 offset:0
ds_read_b64_tr_b16 a[10:11], v8 offset:2048
v_lshlrev_b32 v114, 16, v151
v_and_b32 v115, s36, v151
v_fma_f32 v12, v12, v3, v4
v_fma_f32 v13, v13, v3, v4
s_add_u32 m0, s31, 116736
s_add_u32 s27, s30, 550400
buffer_load_dwordx4 v5, s[12:15], s27 offen lds
s_waitcnt lgkmcnt(6)
v_mfma_f32_32x32x16_bf16 v[80:95], a[36:39], v[140:143], v[80:95]
ds_read_b64_tr_b16 a[12:13], v8 offset:16384
ds_read_b64_tr_b16 a[14:15], v8 offset:18432
v_fma_f32 v14, v14, v3, v4
v_fma_f32 v15, v15, v3, v4
v_fma_f32 v112, v112, v3, v4
v_mfma_f32_32x32x16_bf16 v[48:63], a[40:43], v[140:143], v[48:63]
ds_read_b64_tr_b16 a[16:17], v9 offset:0
ds_read_b64_tr_b16 a[18:19], v9 offset:2048
v_fma_f32 v113, v113, v3, v4
v_fma_f32 v114, v114, v3, v4
v_fma_f32 v115, v115, v3, v4
s_add_u32 m0, s31, 117760
s_add_u32 s27, s30, 561408
buffer_load_dwordx4 v5, s[12:15], s27 offen lds
v_mfma_f32_32x32x16_bf16 v[96:111], a[44:47], v[140:143], v[96:111]
ds_read_b64_tr_b16 a[20:21], v9 offset:16384
ds_read_b64_tr_b16 a[22:23], v9 offset:18432
v_cvt_pk_bf16_f32 v148, v12, v13
v_cvt_pk_bf16_f32 v149, v14, v15
v_cvt_pk_bf16_f32 v150, v112, v113
v_cvt_pk_bf16_f32 v151, v114, v115
s_waitcnt vmcnt(12)
s_waitcnt lgkmcnt(6)
v_mfma_f32_32x32x16_bf16 v[16:31], a[0:3], v[144:147], v[16:31]
ds_read_b64_tr_b16 a[24:25], v7 offset:4096
ds_read_b64_tr_b16 a[26:27], v7 offset:6144
v_lshlrev_b32 v12, 16, v152
v_and_b32 v13, s36, v152
v_lshlrev_b32 v14, 16, v153
s_add_u32 s39, s39, 4096
buffer_load_dwordx4 v[176:179], v1, s[4:7], s39 offen sc1
v_mfma_f32_32x32x16_bf16 v[64:79], a[4:7], v[144:147], v[64:79]
ds_read_b64_tr_b16 a[28:29], v7 offset:20480
ds_read_b64_tr_b16 a[30:31], v7 offset:22528
v_and_b32 v15, s36, v153
v_lshlrev_b32 v112, 16, v154
v_and_b32 v113, s36, v154
v_mfma_f32_32x32x16_bf16 v[32:47], a[8:11], v[144:147], v[32:47]
ds_read_b64_tr_b16 a[32:33], v8 offset:4096
ds_read_b64_tr_b16 a[34:35], v8 offset:6144
v_lshlrev_b32 v114, 16, v155
v_and_b32 v115, s36, v155
v_fma_f32 v12, v12, v3, v4
v_fma_f32 v13, v13, v3, v4
buffer_load_dwordx4 v[180:183], v1, s[4:7], s39 offen offset:1024 sc1
s_waitcnt lgkmcnt(6)
v_mfma_f32_32x32x16_bf16 v[80:95], a[12:15], v[144:147], v[80:95]
ds_read_b64_tr_b16 a[36:37], v8 offset:20480
ds_read_b64_tr_b16 a[38:39], v8 offset:22528
v_fma_f32 v14, v14, v3, v4
v_fma_f32 v15, v15, v3, v4
v_fma_f32 v112, v112, v3, v4
v_mfma_f32_32x32x16_bf16 v[48:63], a[16:19], v[144:147], v[48:63]
ds_read_b64_tr_b16 a[40:41], v9 offset:4096
ds_read_b64_tr_b16 a[42:43], v9 offset:6144
v_fma_f32 v113, v113, v3, v4
v_fma_f32 v114, v114, v3, v4
v_fma_f32 v115, v115, v3, v4
buffer_load_dwordx4 v[184:187], v1, s[4:7], s39 offen offset:2048 sc1
v_mfma_f32_32x32x16_bf16 v[96:111], a[20:23], v[144:147], v[96:111]
ds_read_b64_tr_b16 a[44:45], v9 offset:20480
ds_read_b64_tr_b16 a[46:47], v9 offset:22528
v_cvt_pk_bf16_f32 v152, v12, v13
v_cvt_pk_bf16_f32 v153, v14, v15
v_cvt_pk_bf16_f32 v154, v112, v113
v_cvt_pk_bf16_f32 v155, v114, v115
s_waitcnt lgkmcnt(6)
v_mfma_f32_32x32x16_bf16 v[16:31], a[24:27], v[148:151], v[16:31]
ds_read_b64_tr_b16 a[0:1], v7 offset:8192
ds_read_b64_tr_b16 a[2:3], v7 offset:10240
v_lshlrev_b32 v12, 16, v156
v_and_b32 v13, s36, v156
v_lshlrev_b32 v14, 16, v157
buffer_load_dwordx4 v[188:191], v1, s[4:7], s39 offen offset:3072 sc1
v_mfma_f32_32x32x16_bf16 v[64:79], a[28:31], v[148:151], v[64:79]
ds_read_b64_tr_b16 a[4:5], v7 offset:24576
ds_read_b64_tr_b16 a[6:7], v7 offset:26624
v_and_b32 v15, s36, v157
v_lshlrev_b32 v112, 16, v158
v_and_b32 v113, s36, v158
v_mfma_f32_32x32x16_bf16 v[32:47], a[32:35], v[148:151], v[32:47]
ds_read_b64_tr_b16 a[8:9], v8 offset:8192
ds_read_b64_tr_b16 a[10:11], v8 offset:10240
v_lshlrev_b32 v114, 16, v159
v_and_b32 v115, s36, v159
v_fma_f32 v12, v12, v3, v4
v_fma_f32 v13, v13, v3, v4
s_add_u32 m0, s31, 131072
s_add_u32 s27, s30, 704512
buffer_load_dwordx4 v5, s[8:11], s27 offen lds
s_waitcnt lgkmcnt(6)
v_mfma_f32_32x32x16_bf16 v[80:95], a[36:39], v[148:151], v[80:95]
ds_read_b64_tr_b16 a[12:13], v8 offset:24576
ds_read_b64_tr_b16 a[14:15], v8 offset:26624
v_fma_f32 v14, v14, v3, v4
v_fma_f32 v15, v15, v3, v4
v_fma_f32 v112, v112, v3, v4
v_mfma_f32_32x32x16_bf16 v[48:63], a[40:43], v[148:151], v[48:63]
ds_read_b64_tr_b16 a[16:17], v9 offset:8192
ds_read_b64_tr_b16 a[18:19], v9 offset:10240
v_fma_f32 v113, v113, v3, v4
v_fma_f32 v114, v114, v3, v4
v_fma_f32 v115, v115, v3, v4
s_add_u32 m0, s31, 132096
s_add_u32 s27, s30, 715520
buffer_load_dwordx4 v5, s[8:11], s27 offen lds
v_mfma_f32_32x32x16_bf16 v[96:111], a[44:47], v[148:151], v[96:111]
ds_read_b64_tr_b16 a[20:21], v9 offset:24576
ds_read_b64_tr_b16 a[22:23], v9 offset:26624
v_cvt_pk_bf16_f32 v156, v12, v13
v_cvt_pk_bf16_f32 v157, v14, v15
v_cvt_pk_bf16_f32 v158, v112, v113
v_cvt_pk_bf16_f32 v159, v114, v115
s_waitcnt vmcnt(16)
s_waitcnt lgkmcnt(6)
v_mfma_f32_32x32x16_bf16 v[16:31], a[0:3], v[152:155], v[16:31]
ds_read_b64_tr_b16 a[24:25], v7 offset:12288
ds_read_b64_tr_b16 a[26:27], v7 offset:14336
v_lshlrev_b32 v12, 16, v160
v_and_b32 v13, s36, v160
v_lshlrev_b32 v14, 16, v161
s_add_u32 m0, s31, 133120
s_add_u32 s27, s30, 726528
buffer_load_dwordx4 v5, s[8:11], s27 offen lds
v_mfma_f32_32x32x16_bf16 v[64:79], a[4:7], v[152:155], v[64:79]
ds_read_b64_tr_b16 a[28:29], v7 offset:28672
ds_read_b64_tr_b16 a[30:31], v7 offset:30720
v_and_b32 v15, s36, v161
v_lshlrev_b32 v112, 16, v162
v_and_b32 v113, s36, v162
v_mfma_f32_32x32x16_bf16 v[32:47], a[8:11], v[152:155], v[32:47]
ds_read_b64_tr_b16 a[32:33], v8 offset:12288
ds_read_b64_tr_b16 a[34:35], v8 offset:14336
v_lshlrev_b32 v114, 16, v163
v_and_b32 v115, s36, v163
v_fma_f32 v12, v12, v3, v4
v_fma_f32 v13, v13, v3, v4
s_add_u32 m0, s31, 134144
s_add_u32 s27, s30, 737536
buffer_load_dwordx4 v5, s[8:11], s27 offen lds
s_waitcnt lgkmcnt(6)
v_mfma_f32_32x32x16_bf16 v[80:95], a[12:15], v[152:155], v[80:95]
ds_read_b64_tr_b16 a[36:37], v8 offset:28672
ds_read_b64_tr_b16 a[38:39], v8 offset:30720
v_fma_f32 v14, v14, v3, v4
v_fma_f32 v15, v15, v3, v4
v_fma_f32 v112, v112, v3, v4
v_mfma_f32_32x32x16_bf16 v[48:63], a[16:19], v[152:155], v[48:63]
ds_read_b64_tr_b16 a[40:41], v9 offset:12288
ds_read_b64_tr_b16 a[42:43], v9 offset:14336
v_fma_f32 v113, v113, v3, v4
v_fma_f32 v114, v114, v3, v4
v_fma_f32 v115, v115, v3, v4
s_add_u32 m0, s31, 147456
s_add_u32 s27, s30, 704512
buffer_load_dwordx4 v5, s[12:15], s27 offen lds
v_mfma_f32_32x32x16_bf16 v[96:111], a[20:23], v[152:155], v[96:111]
ds_read_b64_tr_b16 a[44:45], v9 offset:28672
ds_read_b64_tr_b16 a[46:47], v9 offset:30720
v_cvt_pk_bf16_f32 v160, v12, v13
v_cvt_pk_bf16_f32 v161, v14, v15
v_cvt_pk_bf16_f32 v162, v112, v113
v_cvt_pk_bf16_f32 v163, v114, v115
s_waitcnt vmcnt(33)
s_waitcnt lgkmcnt(0)
s_barrier
v_add_u32 v7, 0x8000, v7
v_add_u32 v8, 0x8000, v8
v_add_u32 v9, 0x8000, v9
s_waitcnt lgkmcnt(6)
v_mfma_f32_32x32x16_bf16 v[16:31], a[24:27], v[156:159], v[16:31]
ds_read_b64_tr_b16 a[0:1], v7 offset:0
ds_read_b64_tr_b16 a[2:3], v7 offset:2048
v_lshlrev_b32 v12, 16, v164
v_and_b32 v13, s36, v164
v_lshlrev_b32 v14, 16, v165
s_add_u32 m0, s31, 148480
s_add_u32 s27, s30, 715520
buffer_load_dwordx4 v5, s[12:15], s27 offen lds
v_mfma_f32_32x32x16_bf16 v[64:79], a[28:31], v[156:159], v[64:79]
ds_read_b64_tr_b16 a[4:5], v7 offset:16384
ds_read_b64_tr_b16 a[6:7], v7 offset:18432
v_and_b32 v15, s36, v165
v_lshlrev_b32 v112, 16, v166
v_and_b32 v113, s36, v166
v_mfma_f32_32x32x16_bf16 v[32:47], a[32:35], v[156:159], v[32:47]
ds_read_b64_tr_b16 a[8:9], v8 offset:0
ds_read_b64_tr_b16 a[10:11], v8 offset:2048
v_lshlrev_b32 v114, 16, v167
v_and_b32 v115, s36, v167
v_fma_f32 v12, v12, v3, v4
v_fma_f32 v13, v13, v3, v4
s_add_u32 m0, s31, 149504
s_add_u32 s27, s30, 726528
buffer_load_dwordx4 v5, s[12:15], s27 offen lds
s_waitcnt lgkmcnt(6)
v_mfma_f32_32x32x16_bf16 v[80:95], a[36:39], v[156:159], v[80:95]
ds_read_b64_tr_b16 a[12:13], v8 offset:16384
ds_read_b64_tr_b16 a[14:15], v8 offset:18432
v_fma_f32 v14, v14, v3, v4
v_fma_f32 v15, v15, v3, v4
v_fma_f32 v112, v112, v3, v4
v_mfma_f32_32x32x16_bf16 v[48:63], a[40:43], v[156:159], v[48:63]
ds_read_b64_tr_b16 a[16:17], v9 offset:0
ds_read_b64_tr_b16 a[18:19], v9 offset:2048
v_fma_f32 v113, v113, v3, v4
v_fma_f32 v114, v114, v3, v4
v_fma_f32 v115, v115, v3, v4
s_add_u32 m0, s31, 150528
s_add_u32 s27, s30, 737536
buffer_load_dwordx4 v5, s[12:15], s27 offen lds
v_mfma_f32_32x32x16_bf16 v[96:111], a[44:47], v[156:159], v[96:111]
ds_read_b64_tr_b16 a[20:21], v9 offset:16384
ds_read_b64_tr_b16 a[22:23], v9 offset:18432
v_cvt_pk_bf16_f32 v164, v12, v13
v_cvt_pk_bf16_f32 v165, v14, v15
v_cvt_pk_bf16_f32 v166, v112, v113
v_cvt_pk_bf16_f32 v167, v114, v115
s_waitcnt vmcnt(20)
s_waitcnt lgkmcnt(6)
v_mfma_f32_32x32x16_bf16 v[16:31], a[0:3], v[160:163], v[16:31]
ds_read_b64_tr_b16 a[24:25], v7 offset:4096
ds_read_b64_tr_b16 a[26:27], v7 offset:6144
v_lshlrev_b32 v12, 16, v168
v_and_b32 v13, s36, v168
v_lshlrev_b32 v14, 16, v169
s_add_u32 s39, s39, 4096
buffer_load_dwordx4 v[192:195], v1, s[4:7], s39 offen sc1
v_mfma_f32_32x32x16_bf16 v[64:79], a[4:7], v[160:163], v[64:79]
ds_read_b64_tr_b16 a[28:29], v7 offset:20480
ds_read_b64_tr_b16 a[30:31], v7 offset:22528
v_and_b32 v15, s36, v169
v_lshlrev_b32 v112, 16, v170
v_and_b32 v113, s36, v170
v_mfma_f32_32x32x16_bf16 v[32:47], a[8:11], v[160:163], v[32:47]
ds_read_b64_tr_b16 a[32:33], v8 offset:4096
ds_read_b64_tr_b16 a[34:35], v8 offset:6144
v_lshlrev_b32 v114, 16, v171
v_and_b32 v115, s36, v171
v_fma_f32 v12, v12, v3, v4
v_fma_f32 v13, v13, v3, v4
buffer_load_dwordx4 v[196:199], v1, s[4:7], s39 offen offset:1024 sc1
s_waitcnt lgkmcnt(6)
v_mfma_f32_32x32x16_bf16 v[80:95], a[12:15], v[160:163], v[80:95]
ds_read_b64_tr_b16 a[36:37], v8 offset:20480
ds_read_b64_tr_b16 a[38:39], v8 offset:22528
v_fma_f32 v14, v14, v3, v4
v_fma_f32 v15, v15, v3, v4
v_fma_f32 v112, v112, v3, v4
v_mfma_f32_32x32x16_bf16 v[48:63], a[16:19], v[160:163], v[48:63]
ds_read_b64_tr_b16 a[40:41], v9 offset:4096
ds_read_b64_tr_b16 a[42:43], v9 offset:6144
v_fma_f32 v113, v113, v3, v4
v_fma_f32 v114, v114, v3, v4
v_fma_f32 v115, v115, v3, v4
buffer_load_dwordx4 v[200:203], v1, s[4:7], s39 offen offset:2048 sc1
v_mfma_f32_32x32x16_bf16 v[96:111], a[20:23], v[160:163], v[96:111]
ds_read_b64_tr_b16 a[44:45], v9 offset:20480
ds_read_b64_tr_b16 a[46:47], v9 offset:22528
v_cvt_pk_bf16_f32 v168, v12, v13
v_cvt_pk_bf16_f32 v169, v14, v15
v_cvt_pk_bf16_f32 v170, v112, v113
v_cvt_pk_bf16_f32 v171, v114, v115
s_waitcnt lgkmcnt(6)
v_mfma_f32_32x32x16_bf16 v[16:31], a[24:27], v[164:167], v[16:31]
ds_read_b64_tr_b16 a[0:1], v7 offset:8192
ds_read_b64_tr_b16 a[2:3], v7 offset:10240
v_lshlrev_b32 v12, 16, v172
v_and_b32 v13, s36, v172
v_lshlrev_b32 v14, 16, v173
buffer_load_dwordx4 v[204:207], v1, s[4:7], s39 offen offset:3072 sc1
v_mfma_f32_32x32x16_bf16 v[64:79], a[28:31], v[164:167], v[64:79]
ds_read_b64_tr_b16 a[4:5], v7 offset:24576
ds_read_b64_tr_b16 a[6:7], v7 offset:26624
v_and_b32 v15, s36, v173
v_lshlrev_b32 v112, 16, v174
v_and_b32 v113, s36, v174
v_mfma_f32_32x32x16_bf16 v[32:47], a[32:35], v[164:167], v[32:47]
ds_read_b64_tr_b16 a[8:9], v8 offset:8192
ds_read_b64_tr_b16 a[10:11], v8 offset:10240
v_lshlrev_b32 v114, 16, v175
v_and_b32 v115, s36, v175
v_fma_f32 v12, v12, v3, v4
v_fma_f32 v13, v13, v3, v4
s_add_u32 s39, s39, 4096
buffer_load_dwordx4 v[208:211], v1, s[4:7], s39 offen sc1
s_waitcnt lgkmcnt(6)
v_mfma_f32_32x32x16_bf16 v[80:95], a[36:39], v[164:167], v[80:95]
ds_read_b64_tr_b16 a[12:13], v8 offset:24576
ds_read_b64_tr_b16 a[14:15], v8 offset:26624
v_fma_f32 v14, v14, v3, v4
v_fma_f32 v15, v15, v3, v4
v_fma_f32 v112, v112, v3, v4
v_mfma_f32_32x32x16_bf16 v[48:63], a[40:43], v[164:167], v[48:63]
ds_read_b64_tr_b16 a[16:17], v9 offset:8192
ds_read_b64_tr_b16 a[18:19], v9 offset:10240
v_fma_f32 v113, v113, v3, v4
v_fma_f32 v114, v114, v3, v4
v_fma_f32 v115, v115, v3, v4
buffer_load_dwordx4 v[212:215], v1, s[4:7], s39 offen offset:1024 sc1
v_mfma_f32_32x32x16_bf16 v[96:111], a[44:47], v[164:167], v[96:111]
ds_read_b64_tr_b16 a[20:21], v9 offset:24576
ds_read_b64_tr_b16 a[22:23], v9 offset:26624
v_cvt_pk_bf16_f32 v172, v12, v13
v_cvt_pk_bf16_f32 v173, v14, v15
v_cvt_pk_bf16_f32 v174, v112, v113
v_cvt_pk_bf16_f32 v175, v114, v115
s_waitcnt vmcnt(16)
s_waitcnt lgkmcnt(6)
v_mfma_f32_32x32x16_bf16 v[16:31], a[0:3], v[168:171], v[16:31]
ds_read_b64_tr_b16 a[24:25], v7 offset:12288
ds_read_b64_tr_b16 a[26:27], v7 offset:14336
v_lshlrev_b32 v12, 16, v176
v_and_b32 v13, s36, v176
v_lshlrev_b32 v14, 16, v177
buffer_load_dwordx4 v[216:219], v1, s[4:7], s39 offen offset:2048 sc1
v_mfma_f32_32x32x16_bf16 v[64:79], a[4:7], v[168:171], v[64:79]
ds_read_b64_tr_b16 a[28:29], v7 offset:28672
ds_read_b64_tr_b16 a[30:31], v7 offset:30720
v_and_b32 v15, s36, v177
v_lshlrev_b32 v112, 16, v178
v_and_b32 v113, s36, v178
v_mfma_f32_32x32x16_bf16 v[32:47], a[8:11], v[168:171], v[32:47]
ds_read_b64_tr_b16 a[32:33], v8 offset:12288
ds_read_b64_tr_b16 a[34:35], v8 offset:14336
v_lshlrev_b32 v114, 16, v179
v_and_b32 v115, s36, v179
v_fma_f32 v12, v12, v3, v4
v_fma_f32 v13, v13, v3, v4
buffer_load_dwordx4 v[220:223], v1, s[4:7], s39 offen offset:3072 sc1
s_waitcnt lgkmcnt(6)
v_mfma_f32_32x32x16_bf16 v[80:95], a[12:15], v[168:171], v[80:95]
ds_read_b64_tr_b16 a[36:37], v8 offset:28672
ds_read_b64_tr_b16 a[38:39], v8 offset:30720
v_fma_f32 v14, v14, v3, v4
v_fma_f32 v15, v15, v3, v4
v_fma_f32 v112, v112, v3, v4
v_mfma_f32_32x32x16_bf16 v[48:63], a[16:19], v[168:171], v[48:63]
ds_read_b64_tr_b16 a[40:41], v9 offset:12288
ds_read_b64_tr_b16 a[42:43], v9 offset:14336
v_fma_f32 v113, v113, v3, v4
v_fma_f32 v114, v114, v3, v4
v_fma_f32 v115, v115, v3, v4
s_add_u32 m0, s31, 0
s_add_u32 s27, s30, 880640
buffer_load_dwordx4 v5, s[8:11], s27 offen lds
v_mfma_f32_32x32x16_bf16 v[96:111], a[20:23], v[168:171], v[96:111]
ds_read_b64_tr_b16 a[44:45], v9 offset:28672
ds_read_b64_tr_b16 a[46:47], v9 offset:30720
v_cvt_pk_bf16_f32 v176, v12, v13
v_cvt_pk_bf16_f32 v177, v14, v15
v_cvt_pk_bf16_f32 v178, v112, v113
v_cvt_pk_bf16_f32 v179, v114, v115
s_waitcnt vmcnt(21)
s_waitcnt lgkmcnt(0)
s_barrier
v_add_u32 v7, 0x8000, v7
v_add_u32 v8, 0x8000, v8
v_add_u32 v9, 0x8000, v9
s_waitcnt lgkmcnt(6)
v_mfma_f32_32x32x16_bf16 v[16:31], a[24:27], v[172:175], v[16:31]
ds_read_b64_tr_b16 a[0:1], v7 offset:0
ds_read_b64_tr_b16 a[2:3], v7 offset:2048
v_lshlrev_b32 v12, 16, v180
v_and_b32 v13, s36, v180
v_lshlrev_b32 v14, 16, v181
s_add_u32 m0, s31, 1024
s_add_u32 s27, s30, 891648
buffer_load_dwordx4 v5, s[8:11], s27 offen lds
v_mfma_f32_32x32x16_bf16 v[64:79], a[28:31], v[172:175], v[64:79]
ds_read_b64_tr_b16 a[4:5], v7 offset:16384
ds_read_b64_tr_b16 a[6:7], v7 offset:18432
v_and_b32 v15, s36, v181
v_lshlrev_b32 v112, 16, v182
v_and_b32 v113, s36, v182
v_mfma_f32_32x32x16_bf16 v[32:47], a[32:35], v[172:175], v[32:47]
ds_read_b64_tr_b16 a[8:9], v8 offset:0
ds_read_b64_tr_b16 a[10:11], v8 offset:2048
v_lshlrev_b32 v114, 16, v183
v_and_b32 v115, s36, v183
v_fma_f32 v12, v12, v3, v4
v_fma_f32 v13, v13, v3, v4
s_add_u32 m0, s31, 2048
s_add_u32 s27, s30, 902656
buffer_load_dwordx4 v5, s[8:11], s27 offen lds
s_waitcnt lgkmcnt(6)
v_mfma_f32_32x32x16_bf16 v[80:95], a[36:39], v[172:175], v[80:95]
ds_read_b64_tr_b16 a[12:13], v8 offset:16384
ds_read_b64_tr_b16 a[14:15], v8 offset:18432
v_fma_f32 v14, v14, v3, v4
v_fma_f32 v15, v15, v3, v4
v_fma_f32 v112, v112, v3, v4
v_mfma_f32_32x32x16_bf16 v[48:63], a[40:43], v[172:175], v[48:63]
ds_read_b64_tr_b16 a[16:17], v9 offset:0
ds_read_b64_tr_b16 a[18:19], v9 offset:2048
v_fma_f32 v113, v113, v3, v4
v_fma_f32 v114, v114, v3, v4
v_fma_f32 v115, v115, v3, v4
s_add_u32 m0, s31, 3072
s_add_u32 s27, s30, 913664
buffer_load_dwordx4 v5, s[8:11], s27 offen lds
v_mfma_f32_32x32x16_bf16 v[96:111], a[44:47], v[172:175], v[96:111]
ds_read_b64_tr_b16 a[20:21], v9 offset:16384
ds_read_b64_tr_b16 a[22:23], v9 offset:18432
v_cvt_pk_bf16_f32 v180, v12, v13
v_cvt_pk_bf16_f32 v181, v14, v15
v_cvt_pk_bf16_f32 v182, v112, v113
v_cvt_pk_bf16_f32 v183, v114, v115
s_waitcnt vmcnt(20)
s_waitcnt lgkmcnt(6)
v_mfma_f32_32x32x16_bf16 v[16:31], a[0:3], v[176:179], v[16:31]
ds_read_b64_tr_b16 a[24:25], v7 offset:4096
ds_read_b64_tr_b16 a[26:27], v7 offset:6144
v_lshlrev_b32 v12, 16, v184
v_and_b32 v13, s36, v184
v_lshlrev_b32 v14, 16, v185
s_add_u32 m0, s31, 16384
s_add_u32 s27, s30, 880640
buffer_load_dwordx4 v5, s[12:15], s27 offen lds
v_mfma_f32_32x32x16_bf16 v[64:79], a[4:7], v[176:179], v[64:79]
ds_read_b64_tr_b16 a[28:29], v7 offset:20480
ds_read_b64_tr_b16 a[30:31], v7 offset:22528
v_and_b32 v15, s36, v185
v_lshlrev_b32 v112, 16, v186
v_and_b32 v113, s36, v186
v_mfma_f32_32x32x16_bf16 v[32:47], a[8:11], v[176:179], v[32:47]
ds_read_b64_tr_b16 a[32:33], v8 offset:4096
ds_read_b64_tr_b16 a[34:35], v8 offset:6144
v_lshlrev_b32 v114, 16, v187
v_and_b32 v115, s36, v187
v_fma_f32 v12, v12, v3, v4
v_fma_f32 v13, v13, v3, v4
s_add_u32 m0, s31, 17408
s_add_u32 s27, s30, 891648
buffer_load_dwordx4 v5, s[12:15], s27 offen lds
s_waitcnt lgkmcnt(6)
v_mfma_f32_32x32x16_bf16 v[80:95], a[12:15], v[176:179], v[80:95]
ds_read_b64_tr_b16 a[36:37], v8 offset:20480
ds_read_b64_tr_b16 a[38:39], v8 offset:22528
v_fma_f32 v14, v14, v3, v4
v_fma_f32 v15, v15, v3, v4
v_fma_f32 v112, v112, v3, v4
v_mfma_f32_32x32x16_bf16 v[48:63], a[16:19], v[176:179], v[48:63]
ds_read_b64_tr_b16 a[40:41], v9 offset:4096
ds_read_b64_tr_b16 a[42:43], v9 offset:6144
v_fma_f32 v113, v113, v3, v4
v_fma_f32 v114, v114, v3, v4
v_fma_f32 v115, v115, v3, v4
s_add_u32 m0, s31, 18432
s_add_u32 s27, s30, 902656
buffer_load_dwordx4 v5, s[12:15], s27 offen lds
v_mfma_f32_32x32x16_bf16 v[96:111], a[20:23], v[176:179], v[96:111]
ds_read_b64_tr_b16 a[44:45], v9 offset:20480
ds_read_b64_tr_b16 a[46:47], v9 offset:22528
v_cvt_pk_bf16_f32 v184, v12, v13
v_cvt_pk_bf16_f32 v185, v14, v15
v_cvt_pk_bf16_f32 v186, v112, v113
v_cvt_pk_bf16_f32 v187, v114, v115
s_waitcnt lgkmcnt(6)
v_mfma_f32_32x32x16_bf16 v[16:31], a[24:27], v[180:183], v[16:31]
ds_read_b64_tr_b16 a[0:1], v7 offset:8192
ds_read_b64_tr_b16 a[2:3], v7 offset:10240
v_lshlrev_b32 v12, 16, v188
v_and_b32 v13, s36, v188
v_lshlrev_b32 v14, 16, v189
s_add_u32 m0, s31, 19456
s_add_u32 s27, s30, 913664
buffer_load_dwordx4 v5, s[12:15], s27 offen lds
v_mfma_f32_32x32x16_bf16 v[64:79], a[28:31], v[180:183], v[64:79]
ds_read_b64_tr_b16 a[4:5], v7 offset:24576
ds_read_b64_tr_b16 a[6:7], v7 offset:26624
v_and_b32 v15, s36, v189
v_lshlrev_b32 v112, 16, v190
v_and_b32 v113, s36, v190
v_mfma_f32_32x32x16_bf16 v[32:47], a[32:35], v[180:183], v[32:47]
ds_read_b64_tr_b16 a[8:9], v8 offset:8192
ds_read_b64_tr_b16 a[10:11], v8 offset:10240
v_lshlrev_b32 v114, 16, v191
v_and_b32 v115, s36, v191
v_fma_f32 v12, v12, v3, v4
v_fma_f32 v13, v13, v3, v4
s_add_u32 s39, s39, 4096
buffer_load_dwordx4 v[224:227], v1, s[4:7], s39 offen sc1
s_waitcnt lgkmcnt(6)
v_mfma_f32_32x32x16_bf16 v[80:95], a[36:39], v[180:183], v[80:95]
ds_read_b64_tr_b16 a[12:13], v8 offset:24576
ds_read_b64_tr_b16 a[14:15], v8 offset:26624
v_fma_f32 v14, v14, v3, v4
v_fma_f32 v15, v15, v3, v4
v_fma_f32 v112, v112, v3, v4
v_mfma_f32_32x32x16_bf16 v[48:63], a[40:43], v[180:183], v[48:63]
ds_read_b64_tr_b16 a[16:17], v9 offset:8192
ds_read_b64_tr_b16 a[18:19], v9 offset:10240
v_fma_f32 v113, v113, v3, v4
v_fma_f32 v114, v114, v3, v4
v_fma_f32 v115, v115, v3, v4
buffer_load_dwordx4 v[228:231], v1, s[4:7], s39 offen offset:1024 sc1
v_mfma_f32_32x32x16_bf16 v[96:111], a[44:47], v[180:183], v[96:111]
ds_read_b64_tr_b16 a[20:21], v9 offset:24576
ds_read_b64_tr_b16 a[22:23], v9 offset:26624
v_cvt_pk_bf16_f32 v188, v12, v13
v_cvt_pk_bf16_f32 v189, v14, v15
v_cvt_pk_bf16_f32 v190, v112, v113
v_cvt_pk_bf16_f32 v191, v114, v115
s_waitcnt vmcnt(16)
s_waitcnt lgkmcnt(6)
v_mfma_f32_32x32x16_bf16 v[16:31], a[0:3], v[184:187], v[16:31]
ds_read_b64_tr_b16 a[24:25], v7 offset:12288
ds_read_b64_tr_b16 a[26:27], v7 offset:14336
v_lshlrev_b32 v12, 16, v192
v_and_b32 v13, s36, v192
v_lshlrev_b32 v14, 16, v193
buffer_load_dwordx4 v[232:235], v1, s[4:7], s39 offen offset:2048 sc1
v_mfma_f32_32x32x16_bf16 v[64:79], a[4:7], v[184:187], v[64:79]
ds_read_b64_tr_b16 a[28:29], v7 offset:28672
ds_read_b64_tr_b16 a[30:31], v7 offset:30720
v_and_b32 v15, s36, v193
v_lshlrev_b32 v112, 16, v194
v_and_b32 v113, s36, v194
v_mfma_f32_32x32x16_bf16 v[32:47], a[8:11], v[184:187], v[32:47]
ds_read_b64_tr_b16 a[32:33], v8 offset:12288
ds_read_b64_tr_b16 a[34:35], v8 offset:14336
v_lshlrev_b32 v114, 16, v195
v_and_b32 v115, s36, v195
v_fma_f32 v12, v12, v3, v4
v_fma_f32 v13, v13, v3, v4
buffer_load_dwordx4 v[236:239], v1, s[4:7], s39 offen offset:3072 sc1
s_waitcnt lgkmcnt(6)
v_mfma_f32_32x32x16_bf16 v[80:95], a[12:15], v[184:187], v[80:95]
ds_read_b64_tr_b16 a[36:37], v8 offset:28672
ds_read_b64_tr_b16 a[38:39], v8 offset:30720
v_fma_f32 v14, v14, v3, v4
v_fma_f32 v15, v15, v3, v4
v_fma_f32 v112, v112, v3, v4
v_mfma_f32_32x32x16_bf16 v[48:63], a[16:19], v[184:187], v[48:63]
ds_read_b64_tr_b16 a[40:41], v9 offset:12288
ds_read_b64_tr_b16 a[42:43], v9 offset:14336
v_fma_f32 v113, v113, v3, v4
v_fma_f32 v114, v114, v3, v4
v_fma_f32 v115, v115, v3, v4
s_add_u32 m0, s31, 32768
s_add_u32 s27, s30, 1056768
buffer_load_dwordx4 v5, s[8:11], s27 offen lds
v_mfma_f32_32x32x16_bf16 v[96:111], a[20:23], v[184:187], v[96:111]
ds_read_b64_tr_b16 a[44:45], v9 offset:28672
ds_read_b64_tr_b16 a[46:47], v9 offset:30720
v_cvt_pk_bf16_f32 v192, v12, v13
v_cvt_pk_bf16_f32 v193, v14, v15
v_cvt_pk_bf16_f32 v194, v112, v113
v_cvt_pk_bf16_f32 v195, v114, v115
s_waitcnt vmcnt(21)
s_barrier
v_add_u32 v7, 0x8000, v7
v_add_u32 v8, 0x8000, v8
v_add_u32 v9, 0x8000, v9
s_waitcnt lgkmcnt(6)
v_mfma_f32_32x32x16_bf16 v[16:31], a[24:27], v[188:191], v[16:31]
ds_read_b64_tr_b16 a[0:1], v7 offset:0
ds_read_b64_tr_b16 a[2:3], v7 offset:2048
v_lshlrev_b32 v12, 16, v196
v_and_b32 v13, s36, v196
v_lshlrev_b32 v14, 16, v197
s_add_u32 m0, s31, 33792
s_add_u32 s27, s30, 1067776
buffer_load_dwordx4 v5, s[8:11], s27 offen lds
v_mfma_f32_32x32x16_bf16 v[64:79], a[28:31], v[188:191], v[64:79]
ds_read_b64_tr_b16 a[4:5], v7 offset:16384
ds_read_b64_tr_b16 a[6:7], v7 offset:18432
v_and_b32 v15, s36, v197
v_lshlrev_b32 v112, 16, v198
v_and_b32 v113, s36, v198
v_mfma_f32_32x32x16_bf16 v[32:47], a[32:35], v[188:191], v[32:47]
ds_read_b64_tr_b16 a[8:9], v8 offset:0
ds_read_b64_tr_b16 a[10:11], v8 offset:2048
v_lshlrev_b32 v114, 16, v199
v_and_b32 v115, s36, v199
v_fma_f32 v12, v12, v3, v4
v_fma_f32 v13, v13, v3, v4
s_add_u32 m0, s31, 34816
s_add_u32 s27, s30, 1078784
buffer_load_dwordx4 v5, s[8:11], s27 offen lds
s_waitcnt lgkmcnt(6)
v_mfma_f32_32x32x16_bf16 v[80:95], a[36:39], v[188:191], v[80:95]
ds_read_b64_tr_b16 a[12:13], v8 offset:16384
ds_read_b64_tr_b16 a[14:15], v8 offset:18432
v_fma_f32 v14, v14, v3, v4
v_fma_f32 v15, v15, v3, v4
v_fma_f32 v112, v112, v3, v4
v_mfma_f32_32x32x16_bf16 v[48:63], a[40:43], v[188:191], v[48:63]
ds_read_b64_tr_b16 a[16:17], v9 offset:0
ds_read_b64_tr_b16 a[18:19], v9 offset:2048
v_fma_f32 v113, v113, v3, v4
v_fma_f32 v114, v114, v3, v4
v_fma_f32 v115, v115, v3, v4
s_add_u32 m0, s31, 35840
s_add_u32 s27, s30, 1089792
buffer_load_dwordx4 v5, s[8:11], s27 offen lds
v_mfma_f32_32x32x16_bf16 v[96:111], a[44:47], v[188:191], v[96:111]
ds_read_b64_tr_b16 a[20:21], v9 offset:16384
ds_read_b64_tr_b16 a[22:23], v9 offset:18432
v_cvt_pk_bf16_f32 v196, v12, v13
v_cvt_pk_bf16_f32 v197, v14, v15
v_cvt_pk_bf16_f32 v198, v112, v113
v_cvt_pk_bf16_f32 v199, v114, v115
s_waitcnt vmcnt(20)
s_waitcnt lgkmcnt(6)
v_mfma_f32_32x32x16_bf16 v[16:31], a[0:3], v[192:195], v[16:31]
ds_read_b64_tr_b16 a[24:25], v7 offset:4096
ds_read_b64_tr_b16 a[26:27], v7 offset:6144
v_lshlrev_b32 v12, 16, v200
v_and_b32 v13, s36, v200
v_lshlrev_b32 v14, 16, v201
s_add_u32 m0, s31, 49152
s_add_u32 s27, s30, 1056768
buffer_load_dwordx4 v5, s[12:15], s27 offen lds
v_mfma_f32_32x32x16_bf16 v[64:79], a[4:7], v[192:195], v[64:79]
ds_read_b64_tr_b16 a[28:29], v7 offset:20480
ds_read_b64_tr_b16 a[30:31], v7 offset:22528
v_and_b32 v15, s36, v201
v_lshlrev_b32 v112, 16, v202
v_and_b32 v113, s36, v202
v_mfma_f32_32x32x16_bf16 v[32:47], a[8:11], v[192:195], v[32:47]
ds_read_b64_tr_b16 a[32:33], v8 offset:4096
ds_read_b64_tr_b16 a[34:35], v8 offset:6144
v_lshlrev_b32 v114, 16, v203
v_and_b32 v115, s36, v203
v_fma_f32 v12, v12, v3, v4
v_fma_f32 v13, v13, v3, v4
s_add_u32 m0, s31, 50176
s_add_u32 s27, s30, 1067776
buffer_load_dwordx4 v5, s[12:15], s27 offen lds
s_waitcnt lgkmcnt(6)
v_mfma_f32_32x32x16_bf16 v[80:95], a[12:15], v[192:195], v[80:95]
ds_read_b64_tr_b16 a[36:37], v8 offset:20480
ds_read_b64_tr_b16 a[38:39], v8 offset:22528
v_fma_f32 v14, v14, v3, v4
v_fma_f32 v15, v15, v3, v4
v_fma_f32 v112, v112, v3, v4
v_mfma_f32_32x32x16_bf16 v[48:63], a[16:19], v[192:195], v[48:63]
ds_read_b64_tr_b16 a[40:41], v9 offset:4096
ds_read_b64_tr_b16 a[42:43], v9 offset:6144
v_fma_f32 v113, v113, v3, v4
v_fma_f32 v114, v114, v3, v4
v_fma_f32 v115, v115, v3, v4
s_add_u32 m0, s31, 51200
s_add_u32 s27, s30, 1078784
buffer_load_dwordx4 v5, s[12:15], s27 offen lds
v_mfma_f32_32x32x16_bf16 v[96:111], a[20:23], v[192:195], v[96:111]
ds_read_b64_tr_b16 a[44:45], v9 offset:20480
ds_read_b64_tr_b16 a[46:47], v9 offset:22528
v_cvt_pk_bf16_f32 v200, v12, v13
v_cvt_pk_bf16_f32 v201, v14, v15
v_cvt_pk_bf16_f32 v202, v112, v113
v_cvt_pk_bf16_f32 v203, v114, v115
s_waitcnt lgkmcnt(6)
v_mfma_f32_32x32x16_bf16 v[16:31], a[24:27], v[196:199], v[16:31]
ds_read_b64_tr_b16 a[0:1], v7 offset:8192
ds_read_b64_tr_b16 a[2:3], v7 offset:10240
v_lshlrev_b32 v12, 16, v204
v_and_b32 v13, s36, v204
v_lshlrev_b32 v14, 16, v205
s_add_u32 m0, s31, 52224
s_add_u32 s27, s30, 1089792
buffer_load_dwordx4 v5, s[12:15], s27 offen lds
v_mfma_f32_32x32x16_bf16 v[64:79], a[28:31], v[196:199], v[64:79]
ds_read_b64_tr_b16 a[4:5], v7 offset:24576
ds_read_b64_tr_b16 a[6:7], v7 offset:26624
v_and_b32 v15, s36, v205
v_lshlrev_b32 v112, 16, v206
v_and_b32 v113, s36, v206
v_mfma_f32_32x32x16_bf16 v[32:47], a[32:35], v[196:199], v[32:47]
ds_read_b64_tr_b16 a[8:9], v8 offset:8192
ds_read_b64_tr_b16 a[10:11], v8 offset:10240
v_lshlrev_b32 v114, 16, v207
v_and_b32 v115, s36, v207
v_fma_f32 v12, v12, v3, v4
v_fma_f32 v13, v13, v3, v4
s_add_u32 s39, s39, 4096
buffer_load_dwordx4 v[240:243], v1, s[4:7], s39 offen sc1
s_waitcnt lgkmcnt(6)
v_mfma_f32_32x32x16_bf16 v[80:95], a[36:39], v[196:199], v[80:95]
ds_read_b64_tr_b16 a[12:13], v8 offset:24576
ds_read_b64_tr_b16 a[14:15], v8 offset:26624
v_fma_f32 v14, v14, v3, v4
v_fma_f32 v15, v15, v3, v4
v_fma_f32 v112, v112, v3, v4
v_mfma_f32_32x32x16_bf16 v[48:63], a[40:43], v[196:199], v[48:63]
ds_read_b64_tr_b16 a[16:17], v9 offset:8192
ds_read_b64_tr_b16 a[18:19], v9 offset:10240
v_fma_f32 v113, v113, v3, v4
v_fma_f32 v114, v114, v3, v4
v_fma_f32 v115, v115, v3, v4
buffer_load_dwordx4 v[244:247], v1, s[4:7], s39 offen offset:1024 sc1
v_mfma_f32_32x32x16_bf16 v[96:111], a[44:47], v[196:199], v[96:111]
ds_read_b64_tr_b16 a[20:21], v9 offset:24576
ds_read_b64_tr_b16 a[22:23], v9 offset:26624
v_cvt_pk_bf16_f32 v204, v12, v13
v_cvt_pk_bf16_f32 v205, v14, v15
v_cvt_pk_bf16_f32 v206, v112, v113
v_cvt_pk_bf16_f32 v207, v114, v115
s_waitcnt vmcnt(24)
s_waitcnt lgkmcnt(6)
v_mfma_f32_32x32x16_bf16 v[16:31], a[0:3], v[200:203], v[16:31]
ds_read_b64_tr_b16 a[24:25], v7 offset:12288
ds_read_b64_tr_b16 a[26:27], v7 offset:14336
v_lshlrev_b32 v12, 16, v208
v_and_b32 v13, s36, v208
v_lshlrev_b32 v14, 16, v209
buffer_load_dwordx4 v[248:251], v1, s[4:7], s39 offen offset:2048 sc1
v_mfma_f32_32x32x16_bf16 v[64:79], a[4:7], v[200:203], v[64:79]
ds_read_b64_tr_b16 a[28:29], v7 offset:28672
ds_read_b64_tr_b16 a[30:31], v7 offset:30720
v_and_b32 v15, s36, v209
v_lshlrev_b32 v112, 16, v210
v_and_b32 v113, s36, v210
v_mfma_f32_32x32x16_bf16 v[32:47], a[8:11], v[200:203], v[32:47]
ds_read_b64_tr_b16 a[32:33], v8 offset:12288
ds_read_b64_tr_b16 a[34:35], v8 offset:14336
v_lshlrev_b32 v114, 16, v211
v_and_b32 v115, s36, v211
v_fma_f32 v12, v12, v3, v4
v_fma_f32 v13, v13, v3, v4
buffer_load_dwordx4 v[252:255], v1, s[4:7], s39 offen offset:3072 sc1
s_waitcnt lgkmcnt(6)
v_mfma_f32_32x32x16_bf16 v[80:95], a[12:15], v[200:203], v[80:95]
ds_read_b64_tr_b16 a[36:37], v8 offset:28672
ds_read_b64_tr_b16 a[38:39], v8 offset:30720
v_fma_f32 v14, v14, v3, v4
v_fma_f32 v15, v15, v3, v4
v_fma_f32 v112, v112, v3, v4
v_mfma_f32_32x32x16_bf16 v[48:63], a[16:19], v[200:203], v[48:63]
ds_read_b64_tr_b16 a[40:41], v9 offset:12288
ds_read_b64_tr_b16 a[42:43], v9 offset:14336
v_fma_f32 v113, v113, v3, v4
v_fma_f32 v114, v114, v3, v4
v_fma_f32 v115, v115, v3, v4
s_add_u32 m0, s31, 65536
s_add_u32 s27, s30, 1232896
buffer_load_dwordx4 v5, s[8:11], s27 offen lds
v_mfma_f32_32x32x16_bf16 v[96:111], a[20:23], v[200:203], v[96:111]
ds_read_b64_tr_b16 a[44:45], v9 offset:28672
ds_read_b64_tr_b16 a[46:47], v9 offset:30720
v_cvt_pk_bf16_f32 v208, v12, v13
v_cvt_pk_bf16_f32 v209, v14, v15
v_cvt_pk_bf16_f32 v210, v112, v113
v_cvt_pk_bf16_f32 v211, v114, v115
s_waitcnt vmcnt(17)
s_barrier
v_add_u32 v7, 0xfffe0000, v7
v_add_u32 v8, 0xfffe0000, v8
v_add_u32 v9, 0xfffe0000, v9
s_waitcnt lgkmcnt(6)
v_mfma_f32_32x32x16_bf16 v[16:31], a[24:27], v[204:207], v[16:31]
ds_read_b64_tr_b16 a[0:1], v7 offset:0
ds_read_b64_tr_b16 a[2:3], v7 offset:2048
v_lshlrev_b32 v12, 16, v212
v_and_b32 v13, s36, v212
v_lshlrev_b32 v14, 16, v213
s_add_u32 m0, s31, 66560
s_add_u32 s27, s30, 1243904
buffer_load_dwordx4 v5, s[8:11], s27 offen lds
v_mfma_f32_32x32x16_bf16 v[64:79], a[28:31], v[204:207], v[64:79]
ds_read_b64_tr_b16 a[4:5], v7 offset:16384
ds_read_b64_tr_b16 a[6:7], v7 offset:18432
v_and_b32 v15, s36, v213
v_lshlrev_b32 v112, 16, v214
v_and_b32 v113, s36, v214
v_mfma_f32_32x32x16_bf16 v[32:47], a[32:35], v[204:207], v[32:47]
ds_read_b64_tr_b16 a[8:9], v8 offset:0
ds_read_b64_tr_b16 a[10:11], v8 offset:2048
v_lshlrev_b32 v114, 16, v215
v_and_b32 v115, s36, v215
v_fma_f32 v12, v12, v3, v4
v_fma_f32 v13, v13, v3, v4
s_add_u32 m0, s31, 67584
s_add_u32 s27, s30, 1254912
buffer_load_dwordx4 v5, s[8:11], s27 offen lds
s_waitcnt lgkmcnt(6)
v_mfma_f32_32x32x16_bf16 v[80:95], a[36:39], v[204:207], v[80:95]
ds_read_b64_tr_b16 a[12:13], v8 offset:16384
ds_read_b64_tr_b16 a[14:15], v8 offset:18432
v_fma_f32 v14, v14, v3, v4
v_fma_f32 v15, v15, v3, v4
v_fma_f32 v112, v112, v3, v4
v_mfma_f32_32x32x16_bf16 v[48:63], a[40:43], v[204:207], v[48:63]
ds_read_b64_tr_b16 a[16:17], v9 offset:0
ds_read_b64_tr_b16 a[18:19], v9 offset:2048
v_fma_f32 v113, v113, v3, v4
v_fma_f32 v114, v114, v3, v4
v_fma_f32 v115, v115, v3, v4
s_add_u32 m0, s31, 68608
s_add_u32 s27, s30, 1265920
buffer_load_dwordx4 v5, s[8:11], s27 offen lds
v_mfma_f32_32x32x16_bf16 v[96:111], a[44:47], v[204:207], v[96:111]
ds_read_b64_tr_b16 a[20:21], v9 offset:16384
ds_read_b64_tr_b16 a[22:23], v9 offset:18432
v_cvt_pk_bf16_f32 v212, v12, v13
v_cvt_pk_bf16_f32 v213, v14, v15
v_cvt_pk_bf16_f32 v214, v112, v113
v_cvt_pk_bf16_f32 v215, v114, v115
s_waitcnt vmcnt(28)
s_waitcnt lgkmcnt(6)
v_mfma_f32_32x32x16_bf16 v[16:31], a[0:3], v[208:211], v[16:31]
ds_read_b64_tr_b16 a[24:25], v7 offset:4096
ds_read_b64_tr_b16 a[26:27], v7 offset:6144
v_lshlrev_b32 v12, 16, v216
v_and_b32 v13, s36, v216
v_lshlrev_b32 v14, 16, v217
s_add_u32 m0, s31, 81920
s_add_u32 s27, s30, 1232896
buffer_load_dwordx4 v5, s[12:15], s27 offen lds
v_mfma_f32_32x32x16_bf16 v[64:79], a[4:7], v[208:211], v[64:79]
ds_read_b64_tr_b16 a[28:29], v7 offset:20480
ds_read_b64_tr_b16 a[30:31], v7 offset:22528
v_and_b32 v15, s36, v217
v_lshlrev_b32 v112, 16, v218
v_and_b32 v113, s36, v218
v_mfma_f32_32x32x16_bf16 v[32:47], a[8:11], v[208:211], v[32:47]
ds_read_b64_tr_b16 a[32:33], v8 offset:4096
ds_read_b64_tr_b16 a[34:35], v8 offset:6144
v_lshlrev_b32 v114, 16, v219
v_and_b32 v115, s36, v219
v_fma_f32 v12, v12, v3, v4
v_fma_f32 v13, v13, v3, v4
s_add_u32 m0, s31, 82944
s_add_u32 s27, s30, 1243904
buffer_load_dwordx4 v5, s[12:15], s27 offen lds
s_waitcnt lgkmcnt(6)
v_mfma_f32_32x32x16_bf16 v[80:95], a[12:15], v[208:211], v[80:95]
ds_read_b64_tr_b16 a[36:37], v8 offset:20480
ds_read_b64_tr_b16 a[38:39], v8 offset:22528
v_fma_f32 v14, v14, v3, v4
v_fma_f32 v15, v15, v3, v4
v_fma_f32 v112, v112, v3, v4
v_mfma_f32_32x32x16_bf16 v[48:63], a[16:19], v[208:211], v[48:63]
ds_read_b64_tr_b16 a[40:41], v9 offset:4096
ds_read_b64_tr_b16 a[42:43], v9 offset:6144
v_fma_f32 v113, v113, v3, v4
v_fma_f32 v114, v114, v3, v4
v_fma_f32 v115, v115, v3, v4
s_add_u32 m0, s31, 83968
s_add_u32 s27, s30, 1254912
buffer_load_dwordx4 v5, s[12:15], s27 offen lds
v_mfma_f32_32x32x16_bf16 v[96:111], a[20:23], v[208:211], v[96:111]
ds_read_b64_tr_b16 a[44:45], v9 offset:20480
ds_read_b64_tr_b16 a[46:47], v9 offset:22528
v_cvt_pk_bf16_f32 v216, v12, v13
v_cvt_pk_bf16_f32 v217, v14, v15
v_cvt_pk_bf16_f32 v218, v112, v113
v_cvt_pk_bf16_f32 v219, v114, v115
s_waitcnt lgkmcnt(6)
v_mfma_f32_32x32x16_bf16 v[16:31], a[24:27], v[212:215], v[16:31]
ds_read_b64_tr_b16 a[0:1], v7 offset:8192
ds_read_b64_tr_b16 a[2:3], v7 offset:10240
v_lshlrev_b32 v12, 16, v220
v_and_b32 v13, s36, v220
v_lshlrev_b32 v14, 16, v221
s_add_u32 m0, s31, 84992
s_add_u32 s27, s30, 1265920
buffer_load_dwordx4 v5, s[12:15], s27 offen lds
v_mfma_f32_32x32x16_bf16 v[64:79], a[28:31], v[212:215], v[64:79]
ds_read_b64_tr_b16 a[4:5], v7 offset:24576
ds_read_b64_tr_b16 a[6:7], v7 offset:26624
v_and_b32 v15, s36, v221
v_lshlrev_b32 v112, 16, v222
v_and_b32 v113, s36, v222
v_mfma_f32_32x32x16_bf16 v[32:47], a[32:35], v[212:215], v[32:47]
ds_read_b64_tr_b16 a[8:9], v8 offset:8192
ds_read_b64_tr_b16 a[10:11], v8 offset:10240
v_lshlrev_b32 v114, 16, v223
v_and_b32 v115, s36, v223
v_fma_f32 v12, v12, v3, v4
v_fma_f32 v13, v13, v3, v4
s_waitcnt lgkmcnt(6)
v_mfma_f32_32x32x16_bf16 v[80:95], a[36:39], v[212:215], v[80:95]
ds_read_b64_tr_b16 a[12:13], v8 offset:24576
ds_read_b64_tr_b16 a[14:15], v8 offset:26624
v_fma_f32 v14, v14, v3, v4
v_fma_f32 v15, v15, v3, v4
v_fma_f32 v112, v112, v3, v4
v_mfma_f32_32x32x16_bf16 v[48:63], a[40:43], v[212:215], v[48:63]
ds_read_b64_tr_b16 a[16:17], v9 offset:8192
ds_read_b64_tr_b16 a[18:19], v9 offset:10240
v_fma_f32 v113, v113, v3, v4
v_fma_f32 v114, v114, v3, v4
v_fma_f32 v115, v115, v3, v4
v_mfma_f32_32x32x16_bf16 v[96:111], a[44:47], v[212:215], v[96:111]
ds_read_b64_tr_b16 a[20:21], v9 offset:24576
ds_read_b64_tr_b16 a[22:23], v9 offset:26624
v_cvt_pk_bf16_f32 v220, v12, v13
v_cvt_pk_bf16_f32 v221, v14, v15
v_cvt_pk_bf16_f32 v222, v112, v113
v_cvt_pk_bf16_f32 v223, v114, v115
s_waitcnt vmcnt(22)
s_waitcnt lgkmcnt(6)
v_mfma_f32_32x32x16_bf16 v[16:31], a[0:3], v[216:219], v[16:31]
ds_read_b64_tr_b16 a[24:25], v7 offset:12288
ds_read_b64_tr_b16 a[26:27], v7 offset:14336
v_lshlrev_b32 v12, 16, v224
v_and_b32 v13, s36, v224
v_lshlrev_b32 v14, 16, v225
v_mfma_f32_32x32x16_bf16 v[64:79], a[4:7], v[216:219], v[64:79]
ds_read_b64_tr_b16 a[28:29], v7 offset:28672
ds_read_b64_tr_b16 a[30:31], v7 offset:30720
v_and_b32 v15, s36, v225
v_lshlrev_b32 v112, 16, v226
v_and_b32 v113, s36, v226
v_mfma_f32_32x32x16_bf16 v[32:47], a[8:11], v[216:219], v[32:47]
ds_read_b64_tr_b16 a[32:33], v8 offset:12288
ds_read_b64_tr_b16 a[34:35], v8 offset:14336
v_lshlrev_b32 v114, 16, v227
v_and_b32 v115, s36, v227
v_fma_f32 v12, v12, v3, v4
v_fma_f32 v13, v13, v3, v4
s_waitcnt lgkmcnt(6)
v_mfma_f32_32x32x16_bf16 v[80:95], a[12:15], v[216:219], v[80:95]
ds_read_b64_tr_b16 a[36:37], v8 offset:28672
ds_read_b64_tr_b16 a[38:39], v8 offset:30720
v_fma_f32 v14, v14, v3, v4
v_fma_f32 v15, v15, v3, v4
v_fma_f32 v112, v112, v3, v4
v_mfma_f32_32x32x16_bf16 v[48:63], a[16:19], v[216:219], v[48:63]
ds_read_b64_tr_b16 a[40:41], v9 offset:12288
ds_read_b64_tr_b16 a[42:43], v9 offset:14336
v_fma_f32 v113, v113, v3, v4
v_fma_f32 v114, v114, v3, v4
v_fma_f32 v115, v115, v3, v4
v_mfma_f32_32x32x16_bf16 v[96:111], a[20:23], v[216:219], v[96:111]
ds_read_b64_tr_b16 a[44:45], v9 offset:28672
ds_read_b64_tr_b16 a[46:47], v9 offset:30720
v_cvt_pk_bf16_f32 v224, v12, v13
v_cvt_pk_bf16_f32 v225, v14, v15
v_cvt_pk_bf16_f32 v226, v112, v113
v_cvt_pk_bf16_f32 v227, v114, v115
s_waitcnt vmcnt(12)
s_barrier
v_add_u32 v7, 0x8000, v7
v_add_u32 v8, 0x8000, v8
v_add_u32 v9, 0x8000, v9
s_waitcnt lgkmcnt(6)
v_mfma_f32_32x32x16_bf16 v[16:31], a[24:27], v[220:223], v[16:31]
ds_read_b64_tr_b16 a[0:1], v7 offset:0
ds_read_b64_tr_b16 a[2:3], v7 offset:2048
v_lshlrev_b32 v12, 16, v228
v_and_b32 v13, s36, v228
v_lshlrev_b32 v14, 16, v229
v_mfma_f32_32x32x16_bf16 v[64:79], a[28:31], v[220:223], v[64:79]
ds_read_b64_tr_b16 a[4:5], v7 offset:16384
ds_read_b64_tr_b16 a[6:7], v7 offset:18432
v_and_b32 v15, s36, v229
v_lshlrev_b32 v112, 16, v230
v_and_b32 v113, s36, v230
v_mfma_f32_32x32x16_bf16 v[32:47], a[32:35], v[220:223], v[32:47]
ds_read_b64_tr_b16 a[8:9], v8 offset:0
ds_read_b64_tr_b16 a[10:11], v8 offset:2048
v_lshlrev_b32 v114, 16, v231
v_and_b32 v115, s36, v231
v_fma_f32 v12, v12, v3, v4
v_fma_f32 v13, v13, v3, v4
s_waitcnt lgkmcnt(6)
v_mfma_f32_32x32x16_bf16 v[80:95], a[36:39], v[220:223], v[80:95]
ds_read_b64_tr_b16 a[12:13], v8 offset:16384
ds_read_b64_tr_b16 a[14:15], v8 offset:18432
v_fma_f32 v14, v14, v3, v4
v_fma_f32 v15, v15, v3, v4
v_fma_f32 v112, v112, v3, v4
v_mfma_f32_32x32x16_bf16 v[48:63], a[40:43], v[220:223], v[48:63]
ds_read_b64_tr_b16 a[16:17], v9 offset:0
ds_read_b64_tr_b16 a[18:19], v9 offset:2048
v_fma_f32 v113, v113, v3, v4
v_fma_f32 v114, v114, v3, v4
v_fma_f32 v115, v115, v3, v4
v_mfma_f32_32x32x16_bf16 v[96:111], a[44:47], v[220:223], v[96:111]
ds_read_b64_tr_b16 a[20:21], v9 offset:16384
ds_read_b64_tr_b16 a[22:23], v9 offset:18432
v_cvt_pk_bf16_f32 v228, v12, v13
v_cvt_pk_bf16_f32 v229, v14, v15
v_cvt_pk_bf16_f32 v230, v112, v113
v_cvt_pk_bf16_f32 v231, v114, v115
s_waitcnt vmcnt(20)
s_waitcnt lgkmcnt(6)
v_mfma_f32_32x32x16_bf16 v[16:31], a[0:3], v[224:227], v[16:31]
ds_read_b64_tr_b16 a[24:25], v7 offset:4096
ds_read_b64_tr_b16 a[26:27], v7 offset:6144
v_lshlrev_b32 v12, 16, v232
v_and_b32 v13, s36, v232
v_lshlrev_b32 v14, 16, v233
v_mfma_f32_32x32x16_bf16 v[64:79], a[4:7], v[224:227], v[64:79]
ds_read_b64_tr_b16 a[28:29], v7 offset:20480
ds_read_b64_tr_b16 a[30:31], v7 offset:22528
v_and_b32 v15, s36, v233
v_lshlrev_b32 v112, 16, v234
v_and_b32 v113, s36, v234
v_mfma_f32_32x32x16_bf16 v[32:47], a[8:11], v[224:227], v[32:47]
ds_read_b64_tr_b16 a[32:33], v8 offset:4096
ds_read_b64_tr_b16 a[34:35], v8 offset:6144
v_lshlrev_b32 v114, 16, v235
v_and_b32 v115, s36, v235
v_fma_f32 v12, v12, v3, v4
v_fma_f32 v13, v13, v3, v4
s_waitcnt lgkmcnt(6)
v_mfma_f32_32x32x16_bf16 v[80:95], a[12:15], v[224:227], v[80:95]
ds_read_b64_tr_b16 a[36:37], v8 offset:20480
ds_read_b64_tr_b16 a[38:39], v8 offset:22528
v_fma_f32 v14, v14, v3, v4
v_fma_f32 v15, v15, v3, v4
v_fma_f32 v112, v112, v3, v4
v_mfma_f32_32x32x16_bf16 v[48:63], a[16:19], v[224:227], v[48:63]
ds_read_b64_tr_b16 a[40:41], v9 offset:4096
ds_read_b64_tr_b16 a[42:43], v9 offset:6144
v_fma_f32 v113, v113, v3, v4
v_fma_f32 v114, v114, v3, v4
v_fma_f32 v115, v115, v3, v4
v_mfma_f32_32x32x16_bf16 v[96:111], a[20:23], v[224:227], v[96:111]
ds_read_b64_tr_b16 a[44:45], v9 offset:20480
ds_read_b64_tr_b16 a[46:47], v9 offset:22528
v_cvt_pk_bf16_f32 v232, v12, v13
v_cvt_pk_bf16_f32 v233, v14, v15
v_cvt_pk_bf16_f32 v234, v112, v113
v_cvt_pk_bf16_f32 v235, v114, v115
s_waitcnt lgkmcnt(6)
v_mfma_f32_32x32x16_bf16 v[16:31], a[24:27], v[228:231], v[16:31]
ds_read_b64_tr_b16 a[0:1], v7 offset:8192
ds_read_b64_tr_b16 a[2:3], v7 offset:10240
v_lshlrev_b32 v12, 16, v236
v_and_b32 v13, s36, v236
v_lshlrev_b32 v14, 16, v237
v_mfma_f32_32x32x16_bf16 v[64:79], a[28:31], v[228:231], v[64:79]
ds_read_b64_tr_b16 a[4:5], v7 offset:24576
ds_read_b64_tr_b16 a[6:7], v7 offset:26624
v_and_b32 v15, s36, v237
v_lshlrev_b32 v112, 16, v238
v_and_b32 v113, s36, v238
v_mfma_f32_32x32x16_bf16 v[32:47], a[32:35], v[228:231], v[32:47]
ds_read_b64_tr_b16 a[8:9], v8 offset:8192
ds_read_b64_tr_b16 a[10:11], v8 offset:10240
v_lshlrev_b32 v114, 16, v239
v_and_b32 v115, s36, v239
v_fma_f32 v12, v12, v3, v4
v_fma_f32 v13, v13, v3, v4
s_waitcnt lgkmcnt(6)
v_mfma_f32_32x32x16_bf16 v[80:95], a[36:39], v[228:231], v[80:95]
ds_read_b64_tr_b16 a[12:13], v8 offset:24576
ds_read_b64_tr_b16 a[14:15], v8 offset:26624
v_fma_f32 v14, v14, v3, v4
v_fma_f32 v15, v15, v3, v4
v_fma_f32 v112, v112, v3, v4
v_mfma_f32_32x32x16_bf16 v[48:63], a[40:43], v[228:231], v[48:63]
ds_read_b64_tr_b16 a[16:17], v9 offset:8192
ds_read_b64_tr_b16 a[18:19], v9 offset:10240
v_fma_f32 v113, v113, v3, v4
v_fma_f32 v114, v114, v3, v4
v_fma_f32 v115, v115, v3, v4
v_mfma_f32_32x32x16_bf16 v[96:111], a[44:47], v[228:231], v[96:111]
ds_read_b64_tr_b16 a[20:21], v9 offset:24576
ds_read_b64_tr_b16 a[22:23], v9 offset:26624
v_cvt_pk_bf16_f32 v236, v12, v13
v_cvt_pk_bf16_f32 v237, v14, v15
v_cvt_pk_bf16_f32 v238, v112, v113
v_cvt_pk_bf16_f32 v239, v114, v115
s_waitcnt vmcnt(10)
s_waitcnt lgkmcnt(6)
v_mfma_f32_32x32x16_bf16 v[16:31], a[0:3], v[232:235], v[16:31]
ds_read_b64_tr_b16 a[24:25], v7 offset:12288
ds_read_b64_tr_b16 a[26:27], v7 offset:14336
v_lshlrev_b32 v12, 16, v240
v_and_b32 v13, s36, v240
v_lshlrev_b32 v14, 16, v241
v_mfma_f32_32x32x16_bf16 v[64:79], a[4:7], v[232:235], v[64:79]
ds_read_b64_tr_b16 a[28:29], v7 offset:28672
ds_read_b64_tr_b16 a[30:31], v7 offset:30720
v_and_b32 v15, s36, v241
v_lshlrev_b32 v112, 16, v242
v_and_b32 v113, s36, v242
v_mfma_f32_32x32x16_bf16 v[32:47], a[8:11], v[232:235], v[32:47]
ds_read_b64_tr_b16 a[32:33], v8 offset:12288
ds_read_b64_tr_b16 a[34:35], v8 offset:14336
v_lshlrev_b32 v114, 16, v243
v_and_b32 v115, s36, v243
v_fma_f32 v12, v12, v3, v4
v_fma_f32 v13, v13, v3, v4
s_waitcnt lgkmcnt(6)
v_mfma_f32_32x32x16_bf16 v[80:95], a[12:15], v[232:235], v[80:95]
ds_read_b64_tr_b16 a[36:37], v8 offset:28672
ds_read_b64_tr_b16 a[38:39], v8 offset:30720
v_fma_f32 v14, v14, v3, v4
v_fma_f32 v15, v15, v3, v4
v_fma_f32 v112, v112, v3, v4
v_mfma_f32_32x32x16_bf16 v[48:63], a[16:19], v[232:235], v[48:63]
ds_read_b64_tr_b16 a[40:41], v9 offset:12288
ds_read_b64_tr_b16 a[42:43], v9 offset:14336
v_fma_f32 v113, v113, v3, v4
v_fma_f32 v114, v114, v3, v4
v_fma_f32 v115, v115, v3, v4
v_mfma_f32_32x32x16_bf16 v[96:111], a[20:23], v[232:235], v[96:111]
ds_read_b64_tr_b16 a[44:45], v9 offset:28672
ds_read_b64_tr_b16 a[46:47], v9 offset:30720
v_cvt_pk_bf16_f32 v240, v12, v13
v_cvt_pk_bf16_f32 v241, v14, v15
v_cvt_pk_bf16_f32 v242, v112, v113
v_cvt_pk_bf16_f32 v243, v114, v115
s_waitcnt vmcnt(0)
s_barrier
v_add_u32 v7, 0x8000, v7
v_add_u32 v8, 0x8000, v8
v_add_u32 v9, 0x8000, v9
s_waitcnt lgkmcnt(6)
v_mfma_f32_32x32x16_bf16 v[16:31], a[24:27], v[236:239], v[16:31]
ds_read_b64_tr_b16 a[0:1], v7 offset:0
ds_read_b64_tr_b16 a[2:3], v7 offset:2048
v_lshlrev_b32 v12, 16, v244
v_and_b32 v13, s36, v244
v_lshlrev_b32 v14, 16, v245
v_mfma_f32_32x32x16_bf16 v[64:79], a[28:31], v[236:239], v[64:79]
ds_read_b64_tr_b16 a[4:5], v7 offset:16384
ds_read_b64_tr_b16 a[6:7], v7 offset:18432
v_and_b32 v15, s36, v245
v_lshlrev_b32 v112, 16, v246
v_and_b32 v113, s36, v246
v_mfma_f32_32x32x16_bf16 v[32:47], a[32:35], v[236:239], v[32:47]
ds_read_b64_tr_b16 a[8:9], v8 offset:0
ds_read_b64_tr_b16 a[10:11], v8 offset:2048
v_lshlrev_b32 v114, 16, v247
v_and_b32 v115, s36, v247
v_fma_f32 v12, v12, v3, v4
v_fma_f32 v13, v13, v3, v4
s_waitcnt lgkmcnt(6)
v_mfma_f32_32x32x16_bf16 v[80:95], a[36:39], v[236:239], v[80:95]
ds_read_b64_tr_b16 a[12:13], v8 offset:16384
ds_read_b64_tr_b16 a[14:15], v8 offset:18432
v_fma_f32 v14, v14, v3, v4
v_fma_f32 v15, v15, v3, v4
v_fma_f32 v112, v112, v3, v4
v_mfma_f32_32x32x16_bf16 v[48:63], a[40:43], v[236:239], v[48:63]
ds_read_b64_tr_b16 a[16:17], v9 offset:0
ds_read_b64_tr_b16 a[18:19], v9 offset:2048
v_fma_f32 v113, v113, v3, v4
v_fma_f32 v114, v114, v3, v4
v_fma_f32 v115, v115, v3, v4
v_mfma_f32_32x32x16_bf16 v[96:111], a[44:47], v[236:239], v[96:111]
ds_read_b64_tr_b16 a[20:21], v9 offset:16384
ds_read_b64_tr_b16 a[22:23], v9 offset:18432
v_cvt_pk_bf16_f32 v244, v12, v13
v_cvt_pk_bf16_f32 v245, v14, v15
v_cvt_pk_bf16_f32 v246, v112, v113
v_cvt_pk_bf16_f32 v247, v114, v115
s_waitcnt vmcnt(8)
s_waitcnt lgkmcnt(6)
v_mfma_f32_32x32x16_bf16 v[16:31], a[0:3], v[240:243], v[16:31]
ds_read_b64_tr_b16 a[24:25], v7 offset:4096
ds_read_b64_tr_b16 a[26:27], v7 offset:6144
v_lshlrev_b32 v12, 16, v248
v_and_b32 v13, s36, v248
v_lshlrev_b32 v14, 16, v249
v_mfma_f32_32x32x16_bf16 v[64:79], a[4:7], v[240:243], v[64:79]
ds_read_b64_tr_b16 a[28:29], v7 offset:20480
ds_read_b64_tr_b16 a[30:31], v7 offset:22528
v_and_b32 v15, s36, v249
v_lshlrev_b32 v112, 16, v250
v_and_b32 v113, s36, v250
v_mfma_f32_32x32x16_bf16 v[32:47], a[8:11], v[240:243], v[32:47]
ds_read_b64_tr_b16 a[32:33], v8 offset:4096
ds_read_b64_tr_b16 a[34:35], v8 offset:6144
v_lshlrev_b32 v114, 16, v251
v_and_b32 v115, s36, v251
v_fma_f32 v12, v12, v3, v4
v_fma_f32 v13, v13, v3, v4
s_waitcnt lgkmcnt(6)
v_mfma_f32_32x32x16_bf16 v[80:95], a[12:15], v[240:243], v[80:95]
ds_read_b64_tr_b16 a[36:37], v8 offset:20480
ds_read_b64_tr_b16 a[38:39], v8 offset:22528
v_fma_f32 v14, v14, v3, v4
v_fma_f32 v15, v15, v3, v4
v_fma_f32 v112, v112, v3, v4
v_mfma_f32_32x32x16_bf16 v[48:63], a[16:19], v[240:243], v[48:63]
ds_read_b64_tr_b16 a[40:41], v9 offset:4096
ds_read_b64_tr_b16 a[42:43], v9 offset:6144
v_fma_f32 v113, v113, v3, v4
v_fma_f32 v114, v114, v3, v4
v_fma_f32 v115, v115, v3, v4
v_mfma_f32_32x32x16_bf16 v[96:111], a[20:23], v[240:243], v[96:111]
ds_read_b64_tr_b16 a[44:45], v9 offset:20480
ds_read_b64_tr_b16 a[46:47], v9 offset:22528
v_cvt_pk_bf16_f32 v248, v12, v13
v_cvt_pk_bf16_f32 v249, v14, v15
v_cvt_pk_bf16_f32 v250, v112, v113
v_cvt_pk_bf16_f32 v251, v114, v115
s_waitcnt lgkmcnt(6)
v_mfma_f32_32x32x16_bf16 v[16:31], a[24:27], v[244:247], v[16:31]
ds_read_b64_tr_b16 a[0:1], v7 offset:8192
ds_read_b64_tr_b16 a[2:3], v7 offset:10240
v_lshlrev_b32 v12, 16, v252
v_and_b32 v13, s36, v252
v_lshlrev_b32 v14, 16, v253
v_mfma_f32_32x32x16_bf16 v[64:79], a[28:31], v[244:247], v[64:79]
ds_read_b64_tr_b16 a[4:5], v7 offset:24576
ds_read_b64_tr_b16 a[6:7], v7 offset:26624
v_and_b32 v15, s36, v253
v_lshlrev_b32 v112, 16, v254
v_and_b32 v113, s36, v254
v_mfma_f32_32x32x16_bf16 v[32:47], a[32:35], v[244:247], v[32:47]
ds_read_b64_tr_b16 a[8:9], v8 offset:8192
ds_read_b64_tr_b16 a[10:11], v8 offset:10240
v_lshlrev_b32 v114, 16, v255
v_and_b32 v115, s36, v255
v_fma_f32 v12, v12, v3, v4
v_fma_f32 v13, v13, v3, v4
s_waitcnt lgkmcnt(6)
v_mfma_f32_32x32x16_bf16 v[80:95], a[36:39], v[244:247], v[80:95]
ds_read_b64_tr_b16 a[12:13], v8 offset:24576
ds_read_b64_tr_b16 a[14:15], v8 offset:26624
v_fma_f32 v14, v14, v3, v4
v_fma_f32 v15, v15, v3, v4
v_fma_f32 v112, v112, v3, v4
v_mfma_f32_32x32x16_bf16 v[48:63], a[40:43], v[244:247], v[48:63]
ds_read_b64_tr_b16 a[16:17], v9 offset:8192
ds_read_b64_tr_b16 a[18:19], v9 offset:10240
v_fma_f32 v113, v113, v3, v4
v_fma_f32 v114, v114, v3, v4
v_fma_f32 v115, v115, v3, v4
v_mfma_f32_32x32x16_bf16 v[96:111], a[44:47], v[244:247], v[96:111]
ds_read_b64_tr_b16 a[20:21], v9 offset:24576
ds_read_b64_tr_b16 a[22:23], v9 offset:26624
v_cvt_pk_bf16_f32 v252, v12, v13
v_cvt_pk_bf16_f32 v253, v14, v15
v_cvt_pk_bf16_f32 v254, v112, v113
v_cvt_pk_bf16_f32 v255, v114, v115
s_waitcnt lgkmcnt(6)
v_mfma_f32_32x32x16_bf16 v[16:31], a[0:3], v[248:251], v[16:31]
ds_read_b64_tr_b16 a[24:25], v7 offset:12288
ds_read_b64_tr_b16 a[26:27], v7 offset:14336
v_mfma_f32_32x32x16_bf16 v[64:79], a[4:7], v[248:251], v[64:79]
ds_read_b64_tr_b16 a[28:29], v7 offset:28672
ds_read_b64_tr_b16 a[30:31], v7 offset:30720
v_mfma_f32_32x32x16_bf16 v[32:47], a[8:11], v[248:251], v[32:47]
ds_read_b64_tr_b16 a[32:33], v8 offset:12288
ds_read_b64_tr_b16 a[34:35], v8 offset:14336
s_waitcnt lgkmcnt(6)
v_mfma_f32_32x32x16_bf16 v[80:95], a[12:15], v[248:251], v[80:95]
ds_read_b64_tr_b16 a[36:37], v8 offset:28672
ds_read_b64_tr_b16 a[38:39], v8 offset:30720
v_mfma_f32_32x32x16_bf16 v[48:63], a[16:19], v[248:251], v[48:63]
ds_read_b64_tr_b16 a[40:41], v9 offset:12288
ds_read_b64_tr_b16 a[42:43], v9 offset:14336
v_mfma_f32_32x32x16_bf16 v[96:111], a[20:23], v[248:251], v[96:111]
ds_read_b64_tr_b16 a[44:45], v9 offset:28672
ds_read_b64_tr_b16 a[46:47], v9 offset:30720
s_waitcnt lgkmcnt(6)
v_mfma_f32_32x32x16_bf16 v[16:31], a[24:27], v[252:255], v[16:31]
v_mfma_f32_32x32x16_bf16 v[64:79], a[28:31], v[252:255], v[64:79]
v_mfma_f32_32x32x16_bf16 v[32:47], a[32:35], v[252:255], v[32:47]
s_waitcnt lgkmcnt(0)
v_mfma_f32_32x32x16_bf16 v[80:95], a[36:39], v[252:255], v[80:95]
v_mfma_f32_32x32x16_bf16 v[48:63], a[40:43], v[252:255], v[48:63]
v_mfma_f32_32x32x16_bf16 v[96:111], a[44:47], v[252:255], v[96:111]
s_nop 7
s_nop 3
s_mul_i32 s27, s29, 86
s_mul_i32 s28, s26, 6
s_add_u32 s27, s27, s28
s_lshl_b32 s27, s27, 10
s_add_u32 s27, s27, 0x3900000
v_max_f32 v16, 0, v16
v_mul_f32 v16, v16, v64
v_max_f32 v17, 0, v17
v_mul_f32 v17, v17, v65
v_max_f32 v18, 0, v18
v_mul_f32 v18, v18, v66
v_max_f32 v19, 0, v19
v_mul_f32 v19, v19, v67
v_max_f32 v20, 0, v20
v_mul_f32 v20, v20, v68
v_max_f32 v21, 0, v21
v_mul_f32 v21, v21, v69
v_max_f32 v22, 0, v22
v_mul_f32 v22, v22, v70
v_max_f32 v23, 0, v23
v_mul_f32 v23, v23, v71
v_max_f32 v24, 0, v24
v_mul_f32 v24, v24, v72
v_max_f32 v25, 0, v25
v_mul_f32 v25, v25, v73
v_max_f32 v26, 0, v26
v_mul_f32 v26, v26, v74
v_max_f32 v27, 0, v27
v_mul_f32 v27, v27, v75
v_max_f32 v28, 0, v28
v_mul_f32 v28, v28, v76
v_max_f32 v29, 0, v29
v_mul_f32 v29, v29, v77
v_max_f32 v30, 0, v30
v_mul_f32 v30, v30, v78
v_max_f32 v31, 0, v31
v_mul_f32 v31, v31, v79
v_cvt_pk_bf16_f32 v128, v16, v17
v_cvt_pk_bf16_f32 v129, v18, v19
v_cvt_pk_bf16_f32 v130, v20, v21
v_cvt_pk_bf16_f32 v131, v22, v23
buffer_store_dwordx4 v[128:131], v1, s[4:7], s27 offen sc1
v_cvt_pk_bf16_f32 v132, v24, v25
v_cvt_pk_bf16_f32 v133, v26, v27
v_cvt_pk_bf16_f32 v134, v28, v29
v_cvt_pk_bf16_f32 v135, v30, v31
buffer_store_dwordx4 v[132:135], v1, s[4:7], s27 offen offset:1024 sc1
s_cmp_eq_u32 s26, 14
s_cbranch_scc1 L_B_fin
v_max_f32 v32, 0, v32
v_mul_f32 v32, v32, v80
v_max_f32 v33, 0, v33
v_mul_f32 v33, v33, v81
v_max_f32 v34, 0, v34
v_mul_f32 v34, v34, v82
v_max_f32 v35, 0, v35
v_mul_f32 v35, v35, v83
v_max_f32 v36, 0, v36
v_mul_f32 v36, v36, v84
v_max_f32 v37, 0, v37
v_mul_f32 v37, v37, v85
v_max_f32 v38, 0, v38
v_mul_f32 v38, v38, v86
v_max_f32 v39, 0, v39
v_mul_f32 v39, v39, v87
v_max_f32 v40, 0, v40
v_mul_f32 v40, v40, v88
v_max_f32 v41, 0, v41
v_mul_f32 v41, v41, v89
v_max_f32 v42, 0, v42
v_mul_f32 v42, v42, v90
v_max_f32 v43, 0, v43
v_mul_f32 v43, v43, v91
v_max_f32 v44, 0, v44
v_mul_f32 v44, v44, v92
v_max_f32 v45, 0, v45
v_mul_f32 v45, v45, v93
v_max_f32 v46, 0, v46
v_mul_f32 v46, v46, v94
v_max_f32 v47, 0, v47
v_mul_f32 v47, v47, v95
v_cvt_pk_bf16_f32 v136, v32, v33
v_cvt_pk_bf16_f32 v137, v34, v35
v_cvt_pk_bf16_f32 v138, v36, v37
v_cvt_pk_bf16_f32 v139, v38, v39
buffer_store_dwordx4 v[136:139], v1, s[4:7], s27 offen offset:2048 sc1
v_cvt_pk_bf16_f32 v140, v40, v41
v_cvt_pk_bf16_f32 v141, v42, v43
v_cvt_pk_bf16_f32 v142, v44, v45
v_cvt_pk_bf16_f32 v143, v46, v47
buffer_store_dwordx4 v[140:143], v1, s[4:7], s27 offen offset:3072 sc1
v_max_f32 v48, 0, v48
v_mul_f32 v48, v48, v96
v_max_f32 v49, 0, v49
v_mul_f32 v49, v49, v97
v_max_f32 v50, 0, v50
v_mul_f32 v50, v50, v98
v_max_f32 v51, 0, v51
v_mul_f32 v51, v51, v99
v_max_f32 v52, 0, v52
v_mul_f32 v52, v52, v100
v_max_f32 v53, 0, v53
v_mul_f32 v53, v53, v101
v_max_f32 v54, 0, v54
v_mul_f32 v54, v54, v102
v_max_f32 v55, 0, v55
v_mul_f32 v55, v55, v103
v_max_f32 v56, 0, v56
v_mul_f32 v56, v56, v104
v_max_f32 v57, 0, v57
v_mul_f32 v57, v57, v105
v_max_f32 v58, 0, v58
v_mul_f32 v58, v58, v106
v_max_f32 v59, 0, v59
v_mul_f32 v59, v59, v107
v_max_f32 v60, 0, v60
v_mul_f32 v60, v60, v108
v_max_f32 v61, 0, v61
v_mul_f32 v61, v61, v109
v_max_f32 v62, 0, v62
v_mul_f32 v62, v62, v110
v_max_f32 v63, 0, v63
v_mul_f32 v63, v63, v111
v_cvt_pk_bf16_f32 v144, v48, v49
v_cvt_pk_bf16_f32 v145, v50, v51
v_cvt_pk_bf16_f32 v146, v52, v53
v_cvt_pk_bf16_f32 v147, v54, v55
s_add_u32 s27, s27, 4096
buffer_store_dwordx4 v[144:147], v1, s[4:7], s27 offen sc1
v_cvt_pk_bf16_f32 v148, v56, v57
v_cvt_pk_bf16_f32 v149, v58, v59
v_cvt_pk_bf16_f32 v150, v60, v61
v_cvt_pk_bf16_f32 v151, v62, v63
buffer_store_dwordx4 v[148:151], v1, s[4:7], s27 offen offset:1024 sc1
L_B_fin:
s_lshl_b32 s38, s25, 7
s_lshl_b32 s39, s26, 2
s_add_u32 s38, s38, s39
s_add_u32 s38, s38, 0x3f00800
s_mov_b32 s62, 1
s_branch L_C_start
L_B_skip:
s_barrier
s_waitcnt vmcnt(0)
s_barrier
s_cmp_lg_u32 s24, 0
s_cbranch_scc1 L_sig_1
v_mov_b32 v234, 0
v_mov_b32 v235, 1
s_mov_b64 s[60:61], exec
s_mov_b64 exec, 1
buffer_store_dword v235, v234, s[4:7], s38 offen sc1
s_mov_b64 exec, s[60:61]
L_sig_1:
s_mov_b32 s62, 0
L_C_start:
s_and_b32 s27, s2, 7
s_lshr_b32 s28, s2, 3
s_and_b32 s25, s28, 3
s_and_b32 s26, s27, 1
s_lshl_b32 s26, s26, 2
s_add_u32 s25, s25, s26
s_lshr_b32 s26, s27, 1
s_lshl_b32 s26, s26, 3
s_lshr_b32 s28, s28, 2
s_add_u32 s26, s26, s28
v_lshrrev_b32 v12, 3, v10
v_and_b32 v13, 7, v10
v_bfe_u32 v14, v10, 4, 1
v_lshlrev_b32 v14, 2, v14
v_xor_b32 v13, v13, v14
v_lshlrev_b32 v13, 4, v13
v_lshl_add_u32 v2, v12, 10, v13
v_add_u32 v3, 7168, v2
s_and_b32 s28, s24, 1
s_lshl_b32 s34, s26, 1
s_xor_b32 s35, s28, 1
s_add_u32 s35, s35, s34
s_add_u32 s34, s34, s28
s_mul_i32 s27, s24, 22528
s_mul_i32 s56, s34, 88064
s_mul_i32 s57, s35, 88064
s_mov_b32 s29, s27
s_mov_b32 s30, s27
s_mul_i32 s31, s24, 360448
s_lshl_b32 s27, s25, 7
s_add_u32 s31, s31, s27
s_lshl_b32 s32, s24, 15
s_lshr_b32 s27, s24, 1
s_lshl_b32 s35, s25, 1
s_add_u32 s35, s35, s27
s_mov_b32 s8, s48
s_mov_b32 s9, s49
s_mov_b32 s10, 0x158000
s_mov_b32 s11, 0x00020000
s_add_u32 s56, s56, 0x3900000
s_add_u32 s12, s52, s56
s_addc_u32 s13, s53, 0
s_mov_b32 s14, 88064
s_mov_b32 s15, 0x00020000
s_add_u32 s57, s57, 0x3900000
s_add_u32 s20, s52, s57
s_addc_u32 s21, s53, 0
s_mov_b32 s22, 88064
s_mov_b32 s23, 0x00020000
s_mov_b32 s16, s50
s_mov_b32 s17, s51
s_mov_b32 s18, 0x200000
s_mov_b32 s19, 0x00020000
s_barrier
s_add_u32 m0, s32, 0
s_nop 0
buffer_load_dwordx4 v2, s[8:11], s31 offen lds
buffer_load_dwordx4 v3, s[8:11], s31 offen offset:1024 lds
s_add_u32 s31, s31, 16384
s_add_u32 m0, s32, 2048
s_nop 0
buffer_load_dwordx4 v2, s[8:11], s31 offen lds
buffer_load_dwordx4 v3, s[8:11], s31 offen offset:1024 lds
s_add_u32 s31, s31, 16384
s_add_u32 m0, s32, 4096
s_nop 0
buffer_load_dwordx4 v2, s[8:11], s31 offen lds
buffer_load_dwordx4 v3, s[8:11], s31 offen offset:1024 lds
s_add_u32 s31, s31, 16384
s_add_u32 m0, s32, 6144
s_nop 0
buffer_load_dwordx4 v2, s[8:11], s31 offen lds
buffer_load_dwordx4 v3, s[8:11], s31 offen offset:1024 lds
s_add_u32 s31, s31, 16384
s_add_u32 m0, s32, 8192
s_nop 0
buffer_load_dwordx4 v2, s[8:11], s31 offen lds
buffer_load_dwordx4 v3, s[8:11], s31 offen offset:1024 lds
s_add_u32 s31, s31, 16384
s_add_u32 m0, s32, 10240
s_nop 0
buffer_load_dwordx4 v2, s[8:11], s31 offen lds
buffer_load_dwordx4 v3, s[8:11], s31 offen offset:1024 lds
s_add_u32 s31, s31, 16384
s_add_u32 m0, s32, 12288
s_nop 0
buffer_load_dwordx4 v2, s[8:11], s31 offen lds
buffer_load_dwordx4 v3, s[8:11], s31 offen offset:1024 lds
s_add_u32 s31, s31, 16384
s_add_u32 m0, s32, 14336
s_nop 0
buffer_load_dwordx4 v2, s[8:11], s31 offen lds
buffer_load_dwordx4 v3, s[8:11], s31 offen offset:1024 lds
s_add_u32 s31, s31, 16384
s_add_u32 m0, s32, 16384
s_nop 0
buffer_load_dwordx4 v2, s[8:11], s31 offen lds
buffer_load_dwordx4 v3, s[8:11], s31 offen offset:1024 lds
s_add_u32 s31, s31, 16384
s_add_u32 m0, s32, 18432
s_nop 0
buffer_load_dwordx4 v2, s[8:11], s31 offen lds
buffer_load_dwordx4 v3, s[8:11], s31 offen offset:1024 lds
s_add_u32 s31, s31, 16384
s_add_u32 m0, s32, 20480
s_nop 0
buffer_load_dwordx4 v2, s[8:11], s31 offen lds
buffer_load_dwordx4 v3, s[8:11], s31 offen offset:1024 lds
s_add_u32 s31, s31, 16384
s_add_u32 m0, s32, 22528
s_nop 0
buffer_load_dwordx4 v2, s[8:11], s31 offen lds
buffer_load_dwordx4 v3, s[8:11], s31 offen offset:1024 lds
s_add_u32 s31, s31, 16384
s_add_u32 m0, s32, 24576
s_nop 0
buffer_load_dwordx4 v2, s[8:11], s31 offen lds
buffer_load_dwordx4 v3, s[8:11], s31 offen offset:1024 lds
s_add_u32 s31, s31, 16384
s_add_u32 m0, s32, 26624
s_nop 0
buffer_load_dwordx4 v2, s[8:11], s31 offen lds
buffer_load_dwordx4 v3, s[8:11], s31 offen offset:1024 lds
s_add_u32 s31, s31, 16384
s_add_u32 m0, s32, 28672
s_nop 0
buffer_load_dwordx4 v2, s[8:11], s31 offen lds
buffer_load_dwordx4 v3, s[8:11], s31 offen offset:1024 lds
s_add_u32 s31, s31, 16384
s_cmp_eq_u32 s62, 0
s_cbranch_scc1 L_C_nosig
s_waitcnt vmcnt(30)
s_barrier
s_cmp_lg_u32 s24, 0
s_cbranch_scc1 L_sig_2
v_mov_b32 v234, 0
v_mov_b32 v235, 1
s_mov_b64 s[60:61], exec
s_mov_b64 exec, 1
buffer_store_dword v235, v234, s[4:7], s38 offen sc1
s_mov_b64 exec, s[60:61]
L_sig_2:
L_C_nosig:
v_and_b32 v12, 31, v10
v_lshrrev_b32 v13, 5, v10
v_and_b32 v14, 15, v10
v_lshrrev_b32 v15, 2, v14
v_lshl_add_u32 v15, v13, 2, v15
v_lshlrev_b32 v15, 7, v15
v_bfe_u32 v8, v10, 4, 1
v_lshlrev_b32 v8, 1, v8
v_bfe_u32 v9, v14, 1, 1
v_add_u32 v8, v8, v9
v_lshrrev_b32 v9, 3, v14
v_lshlrev_b32 v9, 2, v9
v_xor_b32 v8, v8, v9
v_lshl_add_u32 v15, v8, 4, v15
v_and_b32 v9, 1, v14
v_lshl_add_u32 v15, v9, 3, v15
v_add_u32 v15, s32, v15
s_lshr_b32 s27, s24, 1
s_lshl_b32 s27, s27, 6
v_xor_b32 v4, s27, v15
v_xor_b32 v5, 64, v4
v_mov_b32 v16, 0
v_mov_b32 v17, 0
v_mov_b32 v18, 0
v_mov_b32 v19, 0
v_mov_b32 v20, 0
v_mov_b32 v21, 0
v_mov_b32 v22, 0
v_mov_b32 v23, 0
v_mov_b32 v24, 0
v_mov_b32 v25, 0
v_mov_b32 v26, 0
v_mov_b32 v27, 0
v_mov_b32 v28, 0
v_mov_b32 v29, 0
v_mov_b32 v30, 0
v_mov_b32 v31, 0
v_mov_b32 v32, 0
v_mov_b32 v33, 0
v_mov_b32 v34, 0
v_mov_b32 v35, 0
v_mov_b32 v36, 0
v_mov_b32 v37, 0
v_mov_b32 v38, 0
v_mov_b32 v39, 0
v_mov_b32 v40, 0
v_mov_b32 v41, 0
v_mov_b32 v42, 0
v_mov_b32 v43, 0
v_mov_b32 v44, 0
v_mov_b32 v45, 0
v_mov_b32 v46, 0
v_mov_b32 v47, 0
v_mov_b32 v48, 0
v_mov_b32 v49, 0
v_mov_b32 v50, 0
v_mov_b32 v51, 0
v_mov_b32 v52, 0
v_mov_b32 v53, 0
v_mov_b32 v54, 0
v_mov_b32 v55, 0
v_mov_b32 v56, 0
v_mov_b32 v57, 0
v_mov_b32 v58, 0
v_mov_b32 v59, 0
v_mov_b32 v60, 0
v_mov_b32 v61, 0
v_mov_b32 v62, 0
v_mov_b32 v63, 0
v_mov_b32 v64, 0
v_mov_b32 v65, 0
v_mov_b32 v66, 0
v_mov_b32 v67, 0
v_mov_b32 v68, 0
v_mov_b32 v69, 0
v_mov_b32 v70, 0
v_mov_b32 v71, 0
v_mov_b32 v72, 0
v_mov_b32 v73, 0
v_mov_b32 v74, 0
v_mov_b32 v75, 0
v_mov_b32 v76, 0
v_mov_b32 v77, 0
v_mov_b32 v78, 0
v_mov_b32 v79, 0
s_lshr_b32 s37, s26, 1
s_lshl_b32 s37, s37, 7
s_add_u32 s37, s37, 0x3f00800
s_cmp_lg_u32 s24, 0
s_cbranch_scc1 L_poll_done_P
v_and_b32 v232, 15, v10
v_min_u32 v232, 14, v232
v_lshlrev_b32 v232, 2, v232
s_mov_b32 s33, 65536
L_poll_P:
buffer_load_dword v233, v232, s[4:7], s37 offen sc1
s_waitcnt vmcnt(0)
v_cmp_ne_u32 vcc, 1, v233
s_nop 3
s_cmp_eq_u64 vcc, 0
s_cbranch_scc1 L_poll_done_P
s_sleep 1
s_sub_u32 s33, s33, 1
s_cbranch_scc0 L_poll_P
L_poll_done_P:
s_barrier
buffer_load_dwordx4 v[80:83], v1, s[12:15], s29 offen sc1
buffer_load_dwordx4 v[84:87], v1, s[20:23], s30 offen sc1
s_add_u32 s29, s29, 1024
s_add_u32 s30, s30, 1024
buffer_load_dwordx4 v[88:91], v1, s[12:15], s29 offen sc1
buffer_load_dwordx4 v[92:95], v1, s[20:23], s30 offen sc1
s_add_u32 s29, s29, 1024
s_add_u32 s30, s30, 1024
buffer_load_dwordx4 v[96:99], v1, s[12:15], s29 offen sc1
buffer_load_dwordx4 v[100:103], v1, s[20:23], s30 offen sc1
s_add_u32 s29, s29, 1024
s_add_u32 s30, s30, 1024
buffer_load_dwordx4 v[104:107], v1, s[12:15], s29 offen sc1
buffer_load_dwordx4 v[108:111], v1, s[20:23], s30 offen sc1
s_add_u32 s29, s29, 1024
s_add_u32 s30, s30, 1024
buffer_load_dwordx4 v[112:115], v1, s[12:15], s29 offen sc1
buffer_load_dwordx4 v[116:119], v1, s[20:23], s30 offen sc1
s_add_u32 s29, s29, 1024
s_add_u32 s30, s30, 1024
buffer_load_dwordx4 v[120:123], v1, s[12:15], s29 offen sc1
buffer_load_dwordx4 v[124:127], v1, s[20:23], s30 offen sc1
s_add_u32 s29, s29, 1024
s_add_u32 s30, s30, 1024
buffer_load_dwordx4 v[128:131], v1, s[12:15], s29 offen sc1
buffer_load_dwordx4 v[132:135], v1, s[20:23], s30 offen sc1
s_add_u32 s29, s29, 1024
s_add_u32 s30, s30, 1024
buffer_load_dwordx4 v[136:139], v1, s[12:15], s29 offen sc1
buffer_load_dwordx4 v[140:143], v1, s[20:23], s30 offen sc1
s_add_u32 s29, s29, 1024
s_add_u32 s30, s30, 1024
buffer_load_dwordx4 v[144:147], v1, s[12:15], s29 offen sc1
buffer_load_dwordx4 v[148:151], v1, s[20:23], s30 offen sc1
s_add_u32 s29, s29, 1024
s_add_u32 s30, s30, 1024
buffer_load_dwordx4 v[152:155], v1, s[12:15], s29 offen sc1
buffer_load_dwordx4 v[156:159], v1, s[20:23], s30 offen sc1
s_add_u32 s29, s29, 1024
s_add_u32 s30, s30, 1024
buffer_load_dwordx4 v[160:163], v1, s[12:15], s29 offen sc1
buffer_load_dwordx4 v[164:167], v1, s[20:23], s30 offen sc1
s_add_u32 s29, s29, 1024
s_add_u32 s30, s30, 1024
buffer_load_dwordx4 v[168:171], v1, s[12:15], s29 offen sc1
buffer_load_dwordx4 v[172:175], v1, s[20:23], s30 offen sc1
s_add_u32 s29, s29, 1024
s_add_u32 s30, s30, 1024
buffer_load_dwordx4 v[176:179], v1, s[12:15], s29 offen sc1
buffer_load_dwordx4 v[180:183], v1, s[20:23], s30 offen sc1
s_add_u32 s29, s29, 1024
s_add_u32 s30, s30, 1024
buffer_load_dwordx4 v[184:187], v1, s[12:15], s29 offen sc1
buffer_load_dwordx4 v[188:191], v1, s[20:23], s30 offen sc1
s_add_u32 s29, s29, 1024
s_add_u32 s30, s30, 1024
buffer_load_dwordx4 v[192:195], v1, s[12:15], s29 offen sc1
buffer_load_dwordx4 v[196:199], v1, s[20:23], s30 offen sc1
s_add_u32 s29, s29, 1024
s_add_u32 s30, s30, 1024
s_waitcnt vmcnt(58)
ds_read_b64_tr_b16 v[208:209], v4 offset:0
ds_read_b64_tr_b16 v[210:211], v4 offset:1024
ds_read_b64_tr_b16 v[212:213], v5 offset:0
ds_read_b64_tr_b16 v[214:215], v5 offset:1024
s_waitcnt vmcnt(28)
ds_read_b64_tr_b16 v[216:217], v4 offset:2048
ds_read_b64_tr_b16 v[218:219], v4 offset:3072
ds_read_b64_tr_b16 v[220:221], v5 offset:2048
ds_read_b64_tr_b16 v[222:223], v5 offset:3072
s_waitcnt lgkmcnt(4)
v_mfma_f32_32x32x16_bf16 v[16:31], v[208:211], v[80:83], v[16:31]
s_add_u32 m0, s32, 30720
buffer_load_dwordx4 v[200:203], v1, s[12:15], s29 offen sc1
v_mfma_f32_32x32x16_bf16 v[32:47], v[208:211], v[84:87], v[32:47]
buffer_load_dwordx4 v2, s[8:11], s31 offen lds
v_mfma_f32_32x32x16_bf16 v[48:63], v[212:215], v[80:83], v[48:63]
buffer_load_dwordx4 v[204:207], v1, s[20:23], s30 offen sc1
v_mfma_f32_32x32x16_bf16 v[64:79], v[212:215], v[84:87], v[64:79]
buffer_load_dwordx4 v3, s[8:11], s31 offen offset:1024 lds
s_add_u32 s29, s29, 1024
s_add_u32 s30, s30, 1024
s_add_u32 s31, s31, 16384
s_waitcnt vmcnt(30)
ds_read_b64_tr_b16 v[208:209], v4 offset:4096
ds_read_b64_tr_b16 v[210:211], v4 offset:5120
ds_read_b64_tr_b16 v[212:213], v5 offset:4096
ds_read_b64_tr_b16 v[214:215], v5 offset:5120
s_waitcnt lgkmcnt(4)
v_mfma_f32_32x32x16_bf16 v[16:31], v[216:219], v[88:91], v[16:31]
s_add_u32 m0, s32, 0
buffer_load_dwordx4 v[80:83], v1, s[12:15], s29 offen sc1
v_mfma_f32_32x32x16_bf16 v[32:47], v[216:219], v[92:95], v[32:47]
buffer_load_dwordx4 v2, s[8:11], s31 offen lds
v_mfma_f32_32x32x16_bf16 v[48:63], v[220:223], v[88:91], v[48:63]
buffer_load_dwordx4 v[84:87], v1, s[20:23], s30 offen sc1
v_mfma_f32_32x32x16_bf16 v[64:79], v[220:223], v[92:95], v[64:79]
buffer_load_dwordx4 v3, s[8:11], s31 offen offset:1024 lds
s_add_u32 s29, s29, 1024
s_add_u32 s30, s30, 1024
s_add_u32 s31, s31, 16384
s_waitcnt vmcnt(32)
ds_read_b64_tr_b16 v[216:217], v4 offset:6144
ds_read_b64_tr_b16 v[218:219], v4 offset:7168
ds_read_b64_tr_b16 v[220:221], v5 offset:6144
ds_read_b64_tr_b16 v[222:223], v5 offset:7168
s_waitcnt lgkmcnt(4)
v_mfma_f32_32x32x16_bf16 v[16:31], v[208:211], v[96:99], v[16:31]
s_add_u32 m0, s32, 2048
buffer_load_dwordx4 v[88:91], v1, s[12:15], s29 offen sc1
v_mfma_f32_32x32x16_bf16 v[32:47], v[208:211], v[100:103], v[32:47]
buffer_load_dwordx4 v2, s[8:11], s31 offen lds
v_mfma_f32_32x32x16_bf16 v[48:63], v[212:215], v[96:99], v[48:63]
buffer_load_dwordx4 v[92:95], v1, s[20:23], s30 offen sc1
v_mfma_f32_32x32x16_bf16 v[64:79], v[212:215], v[100:103], v[64:79]
buffer_load_dwordx4 v3, s[8:11], s31 offen offset:1024 lds
s_add_u32 s29, s29, 1024
s_add_u32 s30, s30, 1024
s_add_u32 s31, s31, 16384
s_waitcnt vmcnt(34)
ds_read_b64_tr_b16 v[208:209], v4 offset:8192
ds_read_b64_tr_b16 v[210:211], v4 offset:9216
ds_read_b64_tr_b16 v[212:213], v5 offset:8192
ds_read_b64_tr_b16 v[214:215], v5 offset:9216
s_waitcnt lgkmcnt(4)
v_mfma_f32_32x32x16_bf16 v[16:31], v[216:219], v[104:107], v[16:31]
s_add_u32 m0, s32, 4096
buffer_load_dwordx4 v[96:99], v1, s[12:15], s29 offen sc1
v_mfma_f32_32x32x16_bf16 v[32:47], v[216:219], v[108:111], v[32:47]
buffer_load_dwordx4 v2, s[8:11], s31 offen lds
v_mfma_f32_32x32x16_bf16 v[48:63], v[220:223], v[104:107], v[48:63]
buffer_load_dwordx4 v[100:103], v1, s[20:23], s30 offen sc1
v_mfma_f32_32x32x16_bf16 v[64:79], v[220:223], v[108:111], v[64:79]
buffer_load_dwordx4 v3, s[8:11], s31 offen offset:1024 lds
s_add_u32 s29, s29, 1024
s_add_u32 s30, s30, 1024
s_add_u32 s31, s31, 16384
s_waitcnt vmcnt(36)
ds_read_b64_tr_b16 v[216:217], v4 offset:10240
ds_read_b64_tr_b16 v[218:219], v4 offset:11264
ds_read_b64_tr_b16 v[220:221], v5 offset:10240
ds_read_b64_tr_b16 v[222:223], v5 offset:11264
s_waitcnt lgkmcnt(4)
v_mfma_f32_32x32x16_bf16 v[16:31], v[208:211], v[112:115], v[16:31]
s_add_u32 m0, s32, 6144
buffer_load_dwordx4 v[104:107], v1, s[12:15], s29 offen sc1
v_mfma_f32_32x32x16_bf16 v[32:47], v[208:211], v[116:119], v[32:47]
buffer_load_dwordx4 v2, s[8:11], s31 offen lds
v_mfma_f32_32x32x16_bf16 v[48:63], v[212:215], v[112:115], v[48:63]
buffer_load_dwordx4 v[108:111], v1, s[20:23], s30 offen sc1
v_mfma_f32_32x32x16_bf16 v[64:79], v[212:215], v[116:119], v[64:79]
buffer_load_dwordx4 v3, s[8:11], s31 offen offset:1024 lds
s_add_u32 s29, s29, 1024
s_add_u32 s30, s30, 1024
s_add_u32 s31, s31, 16384
s_waitcnt vmcnt(38)
ds_read_b64_tr_b16 v[208:209], v4 offset:12288
ds_read_b64_tr_b16 v[210:211], v4 offset:13312
ds_read_b64_tr_b16 v[212:213], v5 offset:12288
ds_read_b64_tr_b16 v[214:215], v5 offset:13312
s_waitcnt lgkmcnt(4)
v_mfma_f32_32x32x16_bf16 v[16:31], v[216:219], v[120:123], v[16:31]
s_add_u32 m0, s32, 8192
buffer_load_dwordx4 v[112:115], v1, s[12:15], s29 offen sc1
v_mfma_f32_32x32x16_bf16 v[32:47], v[216:219], v[124:127], v[32:47]
buffer_load_dwordx4 v2, s[8:11], s31 offen lds
v_mfma_f32_32x32x16_bf16 v[48:63], v[220:223], v[120:123], v[48:63]
buffer_load_dwordx4 v[116:119], v1, s[20:23], s30 offen sc1
v_mfma_f32_32x32x16_bf16 v[64:79], v[220:223], v[124:127], v[64:79]
buffer_load_dwordx4 v3, s[8:11], s31 offen offset:1024 lds
s_add_u32 s29, s29, 1024
s_add_u32 s30, s30, 1024
s_add_u32 s31, s31, 16384
s_waitcnt vmcnt(40)
ds_read_b64_tr_b16 v[216:217], v4 offset:14336
ds_read_b64_tr_b16 v[218:219], v4 offset:15360
ds_read_b64_tr_b16 v[220:221], v5 offset:14336
ds_read_b64_tr_b16 v[222:223], v5 offset:15360
s_waitcnt lgkmcnt(4)
v_mfma_f32_32x32x16_bf16 v[16:31], v[208:211], v[128:131], v[16:31]
s_add_u32 m0, s32, 10240
buffer_load_dwordx4 v[120:123], v1, s[12:15], s29 offen sc1
v_mfma_f32_32x32x16_bf16 v[32:47], v[208:211], v[132:135], v[32:47]
buffer_load_dwordx4 v2, s[8:11], s31 offen lds
v_mfma_f32_32x32x16_bf16 v[48:63], v[212:215], v[128:131], v[48:63]
buffer_load_dwordx4 v[124:127], v1, s[20:23], s30 offen sc1
v_mfma_f32_32x32x16_bf16 v[64:79], v[212:215], v[132:135], v[64:79]
buffer_load_dwordx4 v3, s[8:11], s31 offen offset:1024 lds
s_add_u32 s29, s29, 1024
s_add_u32 s30, s30, 1024
s_add_u32 s31, s31, 16384
s_waitcnt vmcnt(42)
ds_read_b64_tr_b16 v[208:209], v4 offset:16384
ds_read_b64_tr_b16 v[210:211], v4 offset:17408
ds_read_b64_tr_b16 v[212:213], v5 offset:16384
ds_read_b64_tr_b16 v[214:215], v5 offset:17408
s_waitcnt lgkmcnt(4)
v_mfma_f32_32x32x16_bf16 v[16:31], v[216:219], v[136:139], v[16:31]
v_mfma_f32_32x32x16_bf16 v[32:47], v[216:219], v[140:143], v[32:47]
v_mfma_f32_32x32x16_bf16 v[48:63], v[220:223], v[136:139], v[48:63]
v_mfma_f32_32x32x16_bf16 v[64:79], v[220:223], v[140:143], v[64:79]
s_lshl_b32 s36, s34, 5
s_lshl_b32 s37, s35, 1
s_add_u32 s36, s36, s37
s_lshl_b32 s36, s36, 10
s_add_u32 s36, s36, 0x3600000
buffer_load_dwordx4 v[224:227], v1, s[4:7], s36 offen offset:0 sc1
buffer_load_dwordx4 v[228:231], v1, s[4:7], s36 offen offset:1024 sc1
v_lshlrev_b32 v14, 10, v12
v_lshl_add_u32 v6, v13, 4, v14
s_waitcnt vmcnt(42)
ds_read_b64_tr_b16 v[216:217], v4 offset:18432
ds_read_b64_tr_b16 v[218:219], v4 offset:19456
ds_read_b64_tr_b16 v[220:221], v5 offset:18432
ds_read_b64_tr_b16 v[222:223], v5 offset:19456
s_waitcnt lgkmcnt(4)
v_mfma_f32_32x32x16_bf16 v[16:31], v[208:211], v[144:147], v[16:31]
v_mfma_f32_32x32x16_bf16 v[32:47], v[208:211], v[148:151], v[32:47]
v_mfma_f32_32x32x16_bf16 v[48:63], v[212:215], v[144:147], v[48:63]
v_mfma_f32_32x32x16_bf16 v[64:79], v[212:215], v[148:151], v[64:79]
s_waitcnt vmcnt(40)
ds_read_b64_tr_b16 v[208:209], v4 offset:20480
ds_read_b64_tr_b16 v[210:211], v4 offset:21504
ds_read_b64_tr_b16 v[212:213], v5 offset:20480
ds_read_b64_tr_b16 v[214:215], v5 offset:21504
s_waitcnt lgkmcnt(4)
v_mfma_f32_32x32x16_bf16 v[16:31], v[216:219], v[152:155], v[16:31]
v_mfma_f32_32x32x16_bf16 v[32:47], v[216:219], v[156:159], v[32:47]
v_mfma_f32_32x32x16_bf16 v[48:63], v[220:223], v[152:155], v[48:63]
v_mfma_f32_32x32x16_bf16 v[64:79], v[220:223], v[156:159], v[64:79]
s_waitcnt vmcnt(38)
ds_read_b64_tr_b16 v[216:217], v4 offset:22528
ds_read_b64_tr_b16 v[218:219], v4 offset:23552
ds_read_b64_tr_b16 v[220:221], v5 offset:22528
ds_read_b64_tr_b16 v[222:223], v5 offset:23552
s_waitcnt lgkmcnt(4)
v_mfma_f32_32x32x16_bf16 v[16:31], v[208:211], v[160:163], v[16:31]
v_mfma_f32_32x32x16_bf16 v[32:47], v[208:211], v[164:167], v[32:47]
v_mfma_f32_32x32x16_bf16 v[48:63], v[212:215], v[160:163], v[48:63]
v_mfma_f32_32x32x16_bf16 v[64:79], v[212:215], v[164:167], v[64:79]
s_waitcnt vmcnt(36)
ds_read_b64_tr_b16 v[208:209], v4 offset:24576
ds_read_b64_tr_b16 v[210:211], v4 offset:25600
ds_read_b64_tr_b16 v[212:213], v5 offset:24576
ds_read_b64_tr_b16 v[214:215], v5 offset:25600
s_waitcnt lgkmcnt(4)
v_mfma_f32_32x32x16_bf16 v[16:31], v[216:219], v[168:171], v[16:31]
v_mfma_f32_32x32x16_bf16 v[32:47], v[216:219], v[172:175], v[32:47]
v_mfma_f32_32x32x16_bf16 v[48:63], v[220:223], v[168:171], v[48:63]
v_mfma_f32_32x32x16_bf16 v[64:79], v[220:223], v[172:175], v[64:79]
s_waitcnt vmcnt(34)
ds_read_b64_tr_b16 v[216:217], v4 offset:26624
ds_read_b64_tr_b16 v[218:219], v4 offset:27648
ds_read_b64_tr_b16 v[220:221], v5 offset:26624
ds_read_b64_tr_b16 v[222:223], v5 offset:27648
s_waitcnt lgkmcnt(4)
v_mfma_f32_32x32x16_bf16 v[16:31], v[208:211], v[176:179], v[16:31]
v_mfma_f32_32x32x16_bf16 v[32:47], v[208:211], v[180:183], v[32:47]
v_mfma_f32_32x32x16_bf16 v[48:63], v[212:215], v[176:179], v[48:63]
v_mfma_f32_32x32x16_bf16 v[64:79], v[212:215], v[180:183], v[64:79]
s_waitcnt vmcnt(32)
ds_read_b64_tr_b16 v[208:209], v4 offset:28672
ds_read_b64_tr_b16 v[210:211], v4 offset:29696
ds_read_b64_tr_b16 v[212:213], v5 offset:28672
ds_read_b64_tr_b16 v[214:215], v5 offset:29696
s_waitcnt lgkmcnt(4)
v_mfma_f32_32x32x16_bf16 v[16:31], v[216:219], v[184:187], v[16:31]
v_mfma_f32_32x32x16_bf16 v[32:47], v[216:219], v[188:191], v[32:47]
v_mfma_f32_32x32x16_bf16 v[48:63], v[220:223], v[184:187], v[48:63]
v_mfma_f32_32x32x16_bf16 v[64:79], v[220:223], v[188:191], v[64:79]
s_waitcnt vmcnt(26)
ds_read_b64_tr_b16 v[216:217], v4 offset:30720
ds_read_b64_tr_b16 v[218:219], v4 offset:31744
ds_read_b64_tr_b16 v[220:221], v5 offset:30720
ds_read_b64_tr_b16 v[222:223], v5 offset:31744
s_waitcnt lgkmcnt(4)
v_mfma_f32_32x32x16_bf16 v[16:31], v[208:211], v[192:195], v[16:31]
v_mfma_f32_32x32x16_bf16 v[32:47], v[208:211], v[196:199], v[32:47]
v_mfma_f32_32x32x16_bf16 v[48:63], v[212:215], v[192:195], v[48:63]
v_mfma_f32_32x32x16_bf16 v[64:79], v[212:215], v[196:199], v[64:79]
s_waitcnt vmcnt(22)
ds_read_b64_tr_b16 v[208:209], v4 offset:0
ds_read_b64_tr_b16 v[210:211], v4 offset:1024
ds_read_b64_tr_b16 v[212:213], v5 offset:0
ds_read_b64_tr_b16 v[214:215], v5 offset:1024
s_waitcnt lgkmcnt(4)
v_mfma_f32_32x32x16_bf16 v[16:31], v[216:219], v[200:203], v[16:31]
v_mfma_f32_32x32x16_bf16 v[32:47], v[216:219], v[204:207], v[32:47]
v_mfma_f32_32x32x16_bf16 v[48:63], v[220:223], v[200:203], v[48:63]
v_mfma_f32_32x32x16_bf16 v[64:79], v[220:223], v[204:207], v[64:79]
s_waitcnt vmcnt(18)
ds_read_b64_tr_b16 v[216:217], v4 offset:2048
ds_read_b64_tr_b16 v[218:219], v4 offset:3072
ds_read_b64_tr_b16 v[220:221], v5 offset:2048
ds_read_b64_tr_b16 v[222:223], v5 offset:3072
s_waitcnt lgkmcnt(4)
v_mfma_f32_32x32x16_bf16 v[16:31], v[208:211], v[80:83], v[16:31]
v_mfma_f32_32x32x16_bf16 v[32:47], v[208:211], v[84:87], v[32:47]
v_mfma_f32_32x32x16_bf16 v[48:63], v[212:215], v[80:83], v[48:63]
v_mfma_f32_32x32x16_bf16 v[64:79], v[212:215], v[84:87], v[64:79]
s_waitcnt vmcnt(14)
ds_read_b64_tr_b16 v[208:209], v4 offset:4096
ds_read_b64_tr_b16 v[210:211], v4 offset:5120
ds_read_b64_tr_b16 v[212:213], v5 offset:4096
ds_read_b64_tr_b16 v[214:215], v5 offset:5120
s_waitcnt lgkmcnt(4)
v_mfma_f32_32x32x16_bf16 v[16:31], v[216:219], v[88:91], v[16:31]
v_mfma_f32_32x32x16_bf16 v[32:47], v[216:219], v[92:95], v[32:47]
v_mfma_f32_32x32x16_bf16 v[48:63], v[220:223], v[88:91], v[48:63]
v_mfma_f32_32x32x16_bf16 v[64:79], v[220:223], v[92:95], v[64:79]
s_waitcnt vmcnt(10)
ds_read_b64_tr_b16 v[216:217], v4 offset:6144
ds_read_b64_tr_b16 v[218:219], v4 offset:7168
ds_read_b64_tr_b16 v[220:221], v5 offset:6144
ds_read_b64_tr_b16 v[222:223], v5 offset:7168
s_waitcnt lgkmcnt(4)
v_mfma_f32_32x32x16_bf16 v[16:31], v[208:211], v[96:99], v[16:31]
v_mfma_f32_32x32x16_bf16 v[32:47], v[208:211], v[100:103], v[32:47]
v_mfma_f32_32x32x16_bf16 v[48:63], v[212:215], v[96:99], v[48:63]
v_mfma_f32_32x32x16_bf16 v[64:79], v[212:215], v[100:103], v[64:79]
s_waitcnt vmcnt(6)
ds_read_b64_tr_b16 v[208:209], v4 offset:8192
ds_read_b64_tr_b16 v[210:211], v4 offset:9216
ds_read_b64_tr_b16 v[212:213], v5 offset:8192
ds_read_b64_tr_b16 v[214:215], v5 offset:9216
s_waitcnt lgkmcnt(4)
v_mfma_f32_32x32x16_bf16 v[16:31], v[216:219], v[104:107], v[16:31]
v_mfma_f32_32x32x16_bf16 v[32:47], v[216:219], v[108:111], v[32:47]
v_mfma_f32_32x32x16_bf16 v[48:63], v[220:223], v[104:107], v[48:63]
v_mfma_f32_32x32x16_bf16 v[64:79], v[220:223], v[108:111], v[64:79]
s_waitcnt vmcnt(2)
ds_read_b64_tr_b16 v[216:217], v4 offset:10240
ds_read_b64_tr_b16 v[218:219], v4 offset:11264
ds_read_b64_tr_b16 v[220:221], v5 offset:10240
ds_read_b64_tr_b16 v[222:223], v5 offset:11264
s_waitcnt lgkmcnt(4)
v_mfma_f32_32x32x16_bf16 v[16:31], v[208:211], v[112:115], v[16:31]
v_mfma_f32_32x32x16_bf16 v[32:47], v[208:211], v[116:119], v[32:47]
v_mfma_f32_32x32x16_bf16 v[48:63], v[212:215], v[112:115], v[48:63]
v_mfma_f32_32x32x16_bf16 v[64:79], v[212:215], v[116:119], v[64:79]
s_waitcnt vmcnt(3)
s_waitcnt lgkmcnt(0)
v_mfma_f32_32x32x16_bf16 v[16:31], v[216:219], v[120:123], v[16:31]
v_mfma_f32_32x32x16_bf16 v[32:47], v[216:219], v[124:127], v[32:47]
v_mfma_f32_32x32x16_bf16 v[48:63], v[220:223], v[120:123], v[48:63]
v_mfma_f32_32x32x16_bf16 v[64:79], v[220:223], v[124:127], v[64:79]
s_nop 7
s_nop 3
s_barrier
s_xor_b32 s27, s24, 1
s_lshl_b32 s27, s27, 15
v_add_u32 v8, s27, v1
ds_write_b128 v8, v[32:35] offset:0
ds_write_b128 v8, v[36:39] offset:1024
ds_write_b128 v8, v[40:43] offset:2048
ds_write_b128 v8, v[44:47] offset:3072
s_xor_b32 s27, s24, 2
s_lshl_b32 s27, s27, 15
v_add_u32 v8, s27, v1
ds_write_b128 v8, v[48:51] offset:4096
ds_write_b128 v8, v[52:55] offset:5120
ds_write_b128 v8, v[56:59] offset:6144
ds_write_b128 v8, v[60:63] offset:7168
s_xor_b32 s27, s24, 3
s_lshl_b32 s27, s27, 15
v_add_u32 v8, s27, v1
ds_write_b128 v8, v[64:67] offset:8192
ds_write_b128 v8, v[68:71] offset:9216
ds_write_b128 v8, v[72:75] offset:10240
ds_write_b128 v8, v[76:79] offset:11264
v_add_u32 v8, s32, v1
s_waitcnt lgkmcnt(0)
s_barrier
ds_read_b128 v[80:83], v8 offset:0
ds_read_b128 v[84:87], v8 offset:1024
ds_read_b128 v[88:91], v8 offset:2048
ds_read_b128 v[92:95], v8 offset:3072
ds_read_b128 v[96:99], v8 offset:4096
ds_read_b128 v[100:103], v8 offset:5120
ds_read_b128 v[104:107], v8 offset:6144
ds_read_b128 v[108:111], v8 offset:7168
ds_read_b128 v[112:115], v8 offset:8192
ds_read_b128 v[116:119], v8 offset:9216
ds_read_b128 v[120:123], v8 offset:10240
ds_read_b128 v[124:127], v8 offset:11264
s_waitcnt lgkmcnt(8)
v_add_f32 v16, v16, v80
v_add_f32 v17, v17, v81
v_add_f32 v18, v18, v82
v_add_f32 v19, v19, v83
v_add_f32 v20, v20, v84
v_add_f32 v21, v21, v85
v_add_f32 v22, v22, v86
v_add_f32 v23, v23, v87
v_add_f32 v24, v24, v88
v_add_f32 v25, v25, v89
v_add_f32 v26, v26, v90
v_add_f32 v27, v27, v91
v_add_f32 v28, v28, v92
v_add_f32 v29, v29, v93
v_add_f32 v30, v30, v94
v_add_f32 v31, v31, v95
s_waitcnt lgkmcnt(0)
v_add_f32 v96, v96, v112
v_add_f32 v97, v97, v113
v_add_f32 v98, v98, v114
v_add_f32 v99, v99, v115
v_add_f32 v100, v100, v116
v_add_f32 v101, v101, v117
v_add_f32 v102, v102, v118
v_add_f32 v103, v103, v119
v_add_f32 v104, v104, v120
v_add_f32 v105, v105, v121
v_add_f32 v106, v106, v122
v_add_f32 v107, v107, v123
v_add_f32 v108, v108, v124
v_add_f32 v109, v109, v125
v_add_f32 v110, v110, v126
v_add_f32 v111, v111, v127
v_add_f32 v80, v16, v96
v_add_f32 v81, v17, v97
v_add_f32 v82, v18, v98
v_add_f32 v83, v19, v99
v_add_f32 v84, v20, v100
v_add_f32 v85, v21, v101
v_add_f32 v86, v22, v102
v_add_f32 v87, v23, v103
v_add_f32 v88, v24, v104
v_add_f32 v89, v25, v105
v_add_f32 v90, v26, v106
v_add_f32 v91, v27, v107
v_add_f32 v92, v28, v108
v_add_f32 v93, v29, v109
v_add_f32 v94, v30, v110
v_add_f32 v95, v31, v111
s_waitcnt vmcnt(0)
v_cvt_pk_bf16_f32 v16, v80, v81
v_cvt_pk_bf16_f32 v17, v82, v83
v_cvt_pk_bf16_f32 v18, v84, v85
v_cvt_pk_bf16_f32 v19, v86, v87
v_cvt_pk_bf16_f32 v20, v88, v89
v_cvt_pk_bf16_f32 v21, v90, v91
v_cvt_pk_bf16_f32 v22, v92, v93
v_cvt_pk_bf16_f32 v23, v94, v95
v_lshlrev_b32 v80, 16, v16
v_and_b32 v81, 0xffff0000, v16
v_lshlrev_b32 v96, 16, v224
v_and_b32 v97, 0xffff0000, v224
v_lshlrev_b32 v82, 16, v17
v_and_b32 v83, 0xffff0000, v17
v_lshlrev_b32 v98, 16, v225
v_and_b32 v99, 0xffff0000, v225
v_lshlrev_b32 v84, 16, v18
v_and_b32 v85, 0xffff0000, v18
v_lshlrev_b32 v100, 16, v226
v_and_b32 v101, 0xffff0000, v226
v_lshlrev_b32 v86, 16, v19
v_and_b32 v87, 0xffff0000, v19
v_lshlrev_b32 v102, 16, v227
v_and_b32 v103, 0xffff0000, v227
v_lshlrev_b32 v88, 16, v20
v_and_b32 v89, 0xffff0000, v20
v_lshlrev_b32 v104, 16, v228
v_and_b32 v105, 0xffff0000, v228
v_lshlrev_b32 v90, 16, v21
v_and_b32 v91, 0xffff0000, v21
v_lshlrev_b32 v106, 16, v229
v_and_b32 v107, 0xffff0000, v229
v_lshlrev_b32 v92, 16, v22
v_and_b32 v93, 0xffff0000, v22
v_lshlrev_b32 v108, 16, v230
v_and_b32 v109, 0xffff0000, v230
v_lshlrev_b32 v94, 16, v23
v_and_b32 v95, 0xffff0000, v23
v_lshlrev_b32 v110, 16, v231
v_and_b32 v111, 0xffff0000, v231
v_add_f32 v80, v80, v96
v_add_f32 v81, v81, v97
v_add_f32 v82, v82, v98
v_add_f32 v83, v83, v99
v_add_f32 v84, v84, v100
v_add_f32 v85, v85, v101
v_add_f32 v86, v86, v102
v_add_f32 v87, v87, v103
v_add_f32 v88, v88, v104
v_add_f32 v89, v89, v105
v_add_f32 v90, v90, v106
v_add_f32 v91, v91, v107
v_add_f32 v92, v92, v108
v_add_f32 v93, v93, v109
v_add_f32 v94, v94, v110
v_add_f32 v95, v95, v111
v_cvt_pk_bf16_f32 v16, v80, v81
v_cvt_pk_bf16_f32 v17, v82, v83
v_cvt_pk_bf16_f32 v18, v84, v85
v_cvt_pk_bf16_f32 v19, v86, v87
v_cvt_pk_bf16_f32 v20, v88, v89
v_cvt_pk_bf16_f32 v21, v90, v91
v_cvt_pk_bf16_f32 v22, v92, v93
v_cvt_pk_bf16_f32 v23, v94, v95
s_nop 1
v_permlane32_swap_b32 v16, v18
v_permlane32_swap_b32 v17, v19
v_permlane32_swap_b32 v20, v22
v_permlane32_swap_b32 v21, v23
s_lshl_b32 s36, s34, 15
s_lshl_b32 s37, s35, 6
s_add_u32 s36, s36, s37
buffer_store_dwordx4 v[16:19], v6, s[16:19], s36 offen offset:0
buffer_store_dwordx4 v[20:23], v6, s[16:19], s36 offen offset:32
L_tail_end:
s_endpgm
.section .rodata,"a"
.p2align 6
.amdhsa_kernel tail_kernel
  .amdhsa_next_free_vgpr 304
  .amdhsa_next_free_sgpr 102
  .amdhsa_accum_offset 256
  .amdhsa_group_segment_fixed_size 0
  .amdhsa_kernarg_size 104
  .amdhsa_user_sgpr_count 2
  .amdhsa_user_sgpr_kernarg_segment_ptr 1
  .amdhsa_system_sgpr_workgroup_id_x 1
  .amdhsa_float_denorm_mode_32 3
.end_amdhsa_kernel
.text
L_text_end:
s_endpgm
```
